```python
import torch

def _softmax(x, axis=-1):
    return torch.softmax(x, dim=axis)

def _gelu(x):
    return torch.nn.functional.gelu(x, approximate='tanh')

def _silu(x):
    return torch.nn.functional.silu(x)

def _sigmoid(x):
    return torch.sigmoid(x)

def _layernorm(x, axis=-1, eps=1e-05):
    m = x.mean(dim=axis, keepdim=True)
    v = x.var(dim=axis, keepdim=True, unbiased=False)
    return (x - m) / torch.sqrt(v + eps)

def _scatter_add(tgt, idx, src, axis=0):
    return tgt.clone().index_add_(axis, idx, src)

def _segment_sum(src, seg, n):
    out = torch.zeros((n,) + src.shape[1:], dtype=src.dtype)
    return out.index_add_(0, seg, src)

def _pad(x, pw):
    flat = tuple((v for pair in reversed(pw) for v in pair))
    return torch.nn.functional.pad(x, flat)
kernel_name = 'gated_mix__memory_aug_recurrent_mem_tr__glu_gated_bilinear__prompt'

def setup_inputs():

    _w = lambda a: (lambda t: t.to(torch.bfloat16) if t.is_floating_point() else t)(torch.as_tensor(a))

    def _A_setup():
        B, S, Dm = (1, 2048, 512)
        H, Dh = (32, 128)
        M, seg = (8, 32)
        seg = min(seg, S)
        S = S // seg * seg
        return {'x': _w((lambda *s: torch.randn(*s, dtype=torch.bfloat16) * 0.05)(B, S, Dm)), 'mem0': _w((lambda *s: torch.randn(*s, dtype=torch.bfloat16) * 0.4)(B, M, Dm)), 'Wq': _w((lambda *s: torch.randn(*s, dtype=torch.bfloat16) * 6.4)(Dm, H, Dh) * Dm ** (-0.5)), 'Wk': _w((lambda *s: torch.randn(*s, dtype=torch.bfloat16) * 6.4)(Dm, H, Dh) * Dm ** (-0.5)), 'Wv': _w((lambda *s: torch.randn(*s, dtype=torch.bfloat16) * 0.4)(Dm, H, Dh) * Dm ** (-0.5)), 'Wo': _w((lambda *s: torch.randn(*s, dtype=torch.bfloat16) * 0.4)(H, Dh, Dm) * (H * Dh) ** (-0.5)), 'seg_len': seg}
    _A_in = _A_setup()

    def _B_setup():
        B, S, D, F = (1, 2048, 512, 1376)
        return {'x': _w((lambda *s: torch.randn(*s, dtype=torch.bfloat16) * 0.05)(B, S, D)), 'w_gate': _w((lambda *s: torch.randn(*s, dtype=torch.bfloat16) * 1.6)(D, F) * D ** (-0.5)), 'w_up': _w((lambda *s: torch.randn(*s, dtype=torch.bfloat16) * 1.6)(D, F) * D ** (-0.5)), 'w_down': _w((lambda *s: torch.randn(*s, dtype=torch.bfloat16) * 1.6)(F, D) * F ** (-0.5))}
    _B_in = _B_setup()
    return {'A_x': _A_in['x'], 'A_mem0': _A_in['mem0'], 'A_Wq': _A_in['Wq'], 'A_Wk': _A_in['Wk'], 'A_Wv': _A_in['Wv'], 'A_Wo': _A_in['Wo'], 'A_seg_len': _A_in['seg_len'], 'B_x': _B_in['x'], 'B_w_gate': _B_in['w_gate'], 'B_w_up': _B_in['w_up'], 'B_w_down': _B_in['w_down'], 'gate_w': _w((lambda *s: torch.randn(*s, dtype=torch.bfloat16) * 0.05)(512) * 16.0)}

def reference(A_x, A_mem0, A_Wq, A_Wk, A_Wv, A_Wo, A_seg_len, B_x, B_w_gate, B_w_up, B_w_down, gate_w):

    def _A_ref(x, mem0, Wq, Wk, Wv, Wo, seg_len):
        B, S, Dm = x.shape
        H, Dh = (Wq.shape[1], Wq.shape[2])
        M = mem0.shape[1]
        scale = Dh ** (-0.5)
        n_seg = S // seg_len
        L = M + seg_len
        idx = torch.arange(L)
        mask = (idx[:, None] < M) | (idx[:, None] >= idx[None, :])
        mem = mem0
        outs = []
        for s in range(n_seg):
            xs = x[:, s * seg_len:(s + 1) * seg_len, :].clone()
            h = torch.concatenate([mem, xs], axis=1)
            q = torch.einsum('btd,dhe->bhte', h, Wq)
            k = torch.einsum('btd,dhe->bhte', h, Wk)
            v = torch.einsum('btd,dhe->bhte', h, Wv)
            scores = torch.einsum('bhqe,bhke->bhqk', q, k) * scale
            scores = torch.where(mask[None, None], scores, -1000000000.0)
            p = _softmax(scores, axis=-1)
            o = torch.einsum('bhqk,bhke->bhqe', p, v)
            o = torch.einsum('bhte,hed->btd', o, Wo)
            mem = o[:, :M, :].clone()
            outs.append(o[:, M:, :])
        return torch.concatenate(outs, axis=1)

    def _B_ref(x, w_gate, w_up, w_down):
        g = torch.einsum('bsd,df->bsf', x, w_gate)
        u = torch.einsum('bsd,df->bsf', x, w_up)
        h = g * u
        return torch.einsum('bsf,fd->bsd', h, w_down)
    x = A_x
    g = _sigmoid((x * gate_w).sum(-1, keepdims=True))
    a = _A_ref(x, A_mem0, A_Wq, A_Wk, A_Wv, A_Wo, A_seg_len)
    b = _B_ref(x, B_w_gate, B_w_up, B_w_down)
    return g * a + (1 - g) * b
```

```asm
; @launch grid=(256,1,1) block=(256,1,1) lds=163840
.amdgcn_target "amdgcn-amd-amdhsa--gfx950"
.text
.globl gated_mix__memory_aug_recurrent_mem_tr__glu_gated_bilinear__prompt_kernel
.p2align 8
.type gated_mix__memory_aug_recurrent_mem_tr__glu_gated_bilinear__prompt_kernel,@function
gated_mix__memory_aug_recurrent_mem_tr__glu_gated_bilinear__prompt_kernel:
  s_cmp_ge_u32 s2, 256
  s_cbranch_scc1 L_exit
  s_and_b32 s3, s2, 7
  s_lshr_b32 s22, s2, 3
  s_mov_b32 s82, 0
  s_cmp_eq_u32 s3, 0
  s_cbranch_scc1 L_rec
  s_load_dwordx2 s[6:7], s[0:1], 24
  s_sub_u32 s3, s3, 1
  s_lshl_b32 s3, s3, 5
  s_mul_i32 s5, s3, 9363
  s_lshr_b32 s5, s5, 16
  s_lshl_b32 s5, s5, 8
  s_lshl_b32 s4, s22, 17
  s_add_u32 s5, s5, s4
  s_add_u32 s3, s3, s22
  s_mul_i32 s22, s3, 9363
  s_lshr_b32 s22, s22, 16
  s_mul_i32 s4, s22, 7
  s_sub_u32 s4, s3, s4
  v_lshrrev_b32 v1, 4, v0
  v_and_b32 v2, 15, v0
  v_min_u32 v2, 11, v2
  v_lshlrev_b32 v2, 7, v2
  v_lshl_add_u32 v1, v1, 13, v2
  v_add_u32 v1, s5, v1
  v_min_u32 v1, 4194176, v1
  s_waitcnt lgkmcnt(0)
  global_load_dword v255, v1, s[6:7]
  s_mov_b32 s82, 1
  s_mov_b32 s3, 0
  s_cmp_eq_u32 s4, 6
  s_cbranch_scc1 L_rec
L_par:
  v_lshrrev_b32 v2, 6, v0
  v_and_b32 v0, 63, v0
  s_load_dwordx2 s[8:9], s[0:1], 112
  s_load_dwordx2 s[12:13], s[0:1], 104
  s_load_dwordx2 s[16:17], s[0:1], 96
  s_load_dwordx2 s[36:37], s[0:1], 0
  s_load_dwordx8 s[40:47], s[0:1], 16
  s_load_dwordx8 s[48:55], s[0:1], 64
  v_readfirstlane_b32 s20, v2
  s_mov_b32 s10, 0x10000000
  s_mov_b32 s11, 0x20000
  s_mov_b32 s14, 256
  s_mov_b32 s15, 0x20000
  s_mov_b32 s18, 0x200000
  s_mov_b32 s19, 0x20000
  s_mov_b32 s35, 0x20000
  s_mov_b32 s38, 0x200000
  s_mov_b32 s39, 0x20000
  s_and_b32 s21, s2, 7
  s_sub_u32 s21, s21, 1
  s_lshl_b32 s21, s21, 5
  s_lshr_b32 s24, s2, 3
  s_add_u32 s21, s21, s24
  s_lshl_b32 s22, s20, 15
  v_lshlrev_b32 v1, 4, v0
  v_mov_b32 v7, 0
  v_mov_b32 v8, 1
  v_lshrrev_b32 v9, 4, v0
  v_bfe_u32 v10, v0, 2, 2
  v_lshrrev_b32 v11, 5, v0
  v_lshl_add_u32 v10, v11, 3, v10
  v_lshlrev_b32 v10, 6, v10
  v_and_b32 v11, 3, v0
  v_lshl_add_u32 v10, v11, 3, v10
  v_and_b32 v11, 1, v9
  v_mul_u32_u24 v11, 16416, v11
  v_add3_u32 v2, s22, v10, v11
  v_and_b32 v10, 15, v0
  v_lshlrev_b32 v10, 10, v10
  v_lshl_add_u32 v10, v9, 4, v10
  s_lshl_b32 s24, s20, 8
  v_add_u32 v5, s24, v10
  s_waitcnt lgkmcnt(0)
  s_mov_b32 s79, 0
  s_cmp_eq_u32 s3, 1
  s_cbranch_scc1 P1_end
  s_mul_i32 s56, s21, 9363
  s_lshr_b32 s56, s56, 16
  s_mul_i32 s24, s56, 7
  s_sub_u32 s57, s21, s24
  s_mov_b32 s23, s57
  s_mov_b32 s28, 131072
  s_cmp_lt_u32 s57, 2
  s_cbranch_scc1 P1_go
  s_cmp_eq_u32 s57, 2
  s_cbranch_scc0 P1_help
  s_load_dwordx2 s[6:7], s[0:1], 8
  s_lshr_b32 s24, s56, 3
  s_lshl_b32 s24, s24, 1
  s_lshr_b32 s25, s20, 1
  s_add_u32 s24, s24, s25
  s_lshl_b32 s24, s24, 1
  s_bfe_u32 s25, s56, 0x10002
  s_add_u32 s24, s24, s25
  s_lshl_b32 s27, s24, 6
  s_lshl_b32 s24, s24, 2
  s_and_b32 s25, s56, 1
  s_lshl_b32 s25, s25, 1
  s_and_b32 s26, s20, 1
  s_add_u32 s25, s25, s26
  s_lshl_b32 s26, s25, 3
  s_add_u32 s27, s27, s26
  s_add_u32 s24, s24, s25
  s_lshl_b32 s24, s24, 1
  s_bfe_u32 s25, s56, 0x10001
  s_add_u32 s24, s24, s25
  s_lshl_b32 s24, s24, 6
  s_lshl_b32 s25, s25, 12
  s_add_u32 s27, s27, s25
  s_and_b32 s24, s24, 0x3ff
  s_lshr_b32 s25, s56, 3
  s_lshl_b32 s25, s25, 10
  s_or_b32 s24, s24, s25
  s_lshr_b32 s25, s20, 1
  s_lshl_b32 s25, s25, 12
  s_or_b32 s24, s24, s25
  v_and_b32 v16, 3, v0
  v_lshrrev_b32 v17, 4, v0
  v_lshlrev_b32 v18, 2, v16
  v_lshl_add_u32 v18, v17, 4, v18
  v_lshlrev_b32 v16, 1, v16
  v_lshl_add_u32 v16, v17, 10, v16
  v_add_u32 v16, s27, v16
  s_waitcnt lgkmcnt(0)
  global_load_ushort v19, v16, s[6:7]
  global_load_ushort v20, v16, s[6:7] offset:32
  s_add_u32 s24, s24, 33554432
  v_mov_b64 v[24:25], 0
  v_mov_b64 v[26:27], 0
  v_mov_b64 v[28:29], -1
  v_mov_b64 v[30:31], -1
  s_lshl_b32 s25, s56, 11
  s_and_b32 s26, s20, 1
  s_lshl_b32 s26, s26, 10
  s_add_u32 s25, s25, s26
  s_add_u32 s25, s25, 51380224
  buffer_store_dwordx4 v[24:27], v1, s[8:11], s25 offen sc1
  s_lshl_b32 s27, s56, 2
  s_add_u32 s27, s27, s20
  s_lshl_b32 s25, s27, 12
  s_add_u32 s25, s25, 33562624
  buffer_store_dwordx4 v[28:31], v1, s[8:11], s25 offen offset:0 sc1
  buffer_store_dwordx4 v[28:31], v1, s[8:11], s25 offen offset:1024 sc1
  buffer_store_dwordx4 v[28:31], v1, s[8:11], s25 offen offset:2048 sc1
  buffer_store_dwordx4 v[28:31], v1, s[8:11], s25 offen offset:3072 sc1
  s_xor_b32 s25, s27, 64
  s_lshl_b32 s25, s25, 11
  s_add_u32 s26, s25, 54525952
  buffer_store_dwordx4 v[28:31], v1, s[8:11], s26 offen offset:0 sc1
  buffer_store_dwordx4 v[28:31], v1, s[8:11], s26 offen offset:1024 sc1
  s_add_u32 s26, s25, 54788096
  buffer_store_dwordx4 v[28:31], v1, s[8:11], s26 offen offset:0 sc1
  buffer_store_dwordx4 v[28:31], v1, s[8:11], s26 offen offset:1024 sc1
  s_waitcnt vmcnt(9)
  v_lshl_add_u32 v19, v20, 16, v19
  s_mov_b32 s26, 0x207
  v_cmp_class_f32 vcc, v19, s26
  v_mov_b32 v20, 32704
  s_nop 0
  v_cndmask_b32 v19, v19, v20, vcc
  buffer_store_dword v19, v18, s[8:11], s24 offen sc1
  v_mov_b32 v16, 0x80
  s_waitcnt vmcnt(0)
  buffer_store_byte v16, off, s[12:15], s27 sc1
  s_branch P1_go
P1_help:
  s_and_b32 s24, s21, -32
  s_mul_i32 s25, s24, 9363
  s_lshr_b32 s25, s25, 16
  s_mul_i32 s26, s25, 7
  s_sub_u32 s26, s24, s26
  s_sub_u32 s27, s26, 3
  s_max_i32 s27, s27, 0
  s_mul_i32 s31, s25, 3
  s_add_u32 s27, s27, s31
  s_sub_u32 s29, s57, 3
  s_max_i32 s29, s29, 0
  s_mul_i32 s31, s56, 3
  s_add_u32 s29, s29, s31
  s_sub_u32 s27, s29, s27
  s_cmp_ge_u32 s27, 12
  s_cbranch_scc1 P1_go
  s_lshl_b32 s27, s27, 2
  s_add_u32 s27, s27, s20
  s_lshl_b32 s27, s27, 6
  v_add_u32 v16, s27, v0
  s_lshl_b32 s26, s25, 17
  v_lshl_add_u32 v18, v16, 7, s26
  v_add_u32 v19, 393216, v18
  v_min_u32 v19, 4194176, v19
  v_mul_u32_u24 v17, 43691, v16
  v_lshrrev_b32 v17, 19, v17
  v_mul_u32_u24 v20, 12, v17
  v_sub_u32 v16, v16, v20
  s_lshl_b32 s26, s25, 8
  v_lshl_add_u32 v16, v16, 7, s26
  v_lshl_add_u32 v16, v17, 13, v16
  v_add_u32 v17, 2097152, v16
  v_min_u32 v17, 4194176, v17
  global_load_dword v21, v16, s[44:45]
  global_load_dword v22, v17, s[44:45]
  s_waitcnt vmcnt(2)
  global_load_dword v21, v16, s[40:41]
  global_load_dword v22, v17, s[40:41]
  s_waitcnt vmcnt(2)
  global_load_dword v21, v18, s[46:47]
  global_load_dword v22, v19, s[46:47]
P1_go:
  s_lshl_b32 s24, s23, 15
  s_lshl_b32 s25, s20, 13
  s_add_u32 s25, s25, s28
  s_add_u32 m0, s25, 0
  s_add_u32 s31, s24, 0
  buffer_load_dwordx4 v5, s[36:39], s31 offen lds
  s_add_u32 m0, s25, 1024
  s_add_u32 s31, s24, 16384
  buffer_load_dwordx4 v5, s[36:39], s31 offen lds
  s_add_u32 m0, s25, 2048
  s_add_u32 s31, s24, 64
  buffer_load_dwordx4 v5, s[36:39], s31 offen lds
  s_add_u32 m0, s25, 3072
  s_add_u32 s31, s24, 16448
  buffer_load_dwordx4 v5, s[36:39], s31 offen lds
  s_add_u32 m0, s25, 4096
  s_add_u32 s31, s24, 128
  buffer_load_dwordx4 v5, s[36:39], s31 offen lds
  s_add_u32 m0, s25, 5120
  s_add_u32 s31, s24, 16512
  buffer_load_dwordx4 v5, s[36:39], s31 offen lds
  s_add_u32 m0, s25, 6144
  s_add_u32 s31, s24, 192
  buffer_load_dwordx4 v5, s[36:39], s31 offen lds
  s_add_u32 m0, s25, 7168
  s_add_u32 s31, s24, 16576
  buffer_load_dwordx4 v5, s[36:39], s31 offen lds
  s_lshl_b32 s24, s56, 8
  s_lshl_b32 s25, s20, 6
  s_add_u32 s24, s24, s25
  v_bfe_u32 v9, v0, 2, 3
  v_lshrrev_b32 v11, 5, v0
  v_lshl_add_u32 v9, v11, 4, v9
  v_mul_u32_u24 v9, 8192, v9
  v_and_b32 v11, 3, v0
  v_lshl_add_u32 v9, v11, 4, v9
  v_add_u32 v4, s24, v9
  s_lshl_b32 s27, s56, 2
  s_add_u32 s27, s27, s20
  s_lshl_b32 s27, s27, 3
  s_add_u32 s27, s27, s57
  s_lshl_b32 s27, s27, 2
  s_add_u32 s27, s27, 51380224
  v_add_u32 v6, 131072, v1
  v_and_b32 v10, 31, v0
  v_lshlrev_b32 v10, 2, v10
  s_mov_b32 s32, s42
  s_mov_b32 s33, s43
  s_mov_b32 s34, 4194304
  s_add_u32 m0, s22, 0
  s_mov_b32 s31, 0
  buffer_load_dwordx4 v4, s[32:35], s31 offen lds
  s_add_u32 m0, s22, 16416
  s_mov_b32 s31, 65536
  buffer_load_dwordx4 v4, s[32:35], s31 offen lds
  s_add_u32 m0, s22, 1024
  s_mov_b32 s31, 262144
  buffer_load_dwordx4 v4, s[32:35], s31 offen lds
  s_add_u32 m0, s22, 17440
  s_mov_b32 s31, 327680
  buffer_load_dwordx4 v4, s[32:35], s31 offen lds
  s_add_u32 m0, s22, 2048
  s_mov_b32 s31, 524288
  buffer_load_dwordx4 v4, s[32:35], s31 offen lds
  s_add_u32 m0, s22, 18464
  s_mov_b32 s31, 589824
  buffer_load_dwordx4 v4, s[32:35], s31 offen lds
  s_add_u32 m0, s22, 3072
  s_mov_b32 s31, 786432
  buffer_load_dwordx4 v4, s[32:35], s31 offen lds
  s_add_u32 m0, s22, 19488
  s_mov_b32 s31, 851968
  buffer_load_dwordx4 v4, s[32:35], s31 offen lds
  s_add_u32 m0, s22, 4096
  s_mov_b32 s31, 1048576
  buffer_load_dwordx4 v4, s[32:35], s31 offen lds
  s_add_u32 m0, s22, 20512
  s_mov_b32 s31, 1114112
  buffer_load_dwordx4 v4, s[32:35], s31 offen lds
  s_add_u32 m0, s22, 5120
  s_mov_b32 s31, 1310720
  buffer_load_dwordx4 v4, s[32:35], s31 offen lds
  s_add_u32 m0, s22, 21536
  s_mov_b32 s31, 1376256
  buffer_load_dwordx4 v4, s[32:35], s31 offen lds
  s_add_u32 m0, s22, 6144
  s_mov_b32 s31, 1572864
  buffer_load_dwordx4 v4, s[32:35], s31 offen lds
  s_add_u32 m0, s22, 22560
  s_mov_b32 s31, 1638400
  buffer_load_dwordx4 v4, s[32:35], s31 offen lds
  s_add_u32 m0, s22, 7168
  s_mov_b32 s31, 1835008
  buffer_load_dwordx4 v4, s[32:35], s31 offen lds
  s_add_u32 m0, s22, 23584
  s_mov_b32 s31, 1900544
  buffer_load_dwordx4 v4, s[32:35], s31 offen lds
  s_add_u32 m0, s22, 8192
  s_mov_b32 s31, 2097152
  buffer_load_dwordx4 v4, s[32:35], s31 offen lds
  s_add_u32 m0, s22, 24608
  s_mov_b32 s31, 2162688
  buffer_load_dwordx4 v4, s[32:35], s31 offen lds
  s_add_u32 m0, s22, 9216
  s_mov_b32 s31, 2359296
  buffer_load_dwordx4 v4, s[32:35], s31 offen lds
  s_add_u32 m0, s22, 25632
  s_mov_b32 s31, 2424832
  buffer_load_dwordx4 v4, s[32:35], s31 offen lds
  s_add_u32 m0, s22, 10240
  s_mov_b32 s31, 2621440
  buffer_load_dwordx4 v4, s[32:35], s31 offen lds
  s_add_u32 m0, s22, 26656
  s_mov_b32 s31, 2686976
  buffer_load_dwordx4 v4, s[32:35], s31 offen lds
  s_add_u32 m0, s22, 11264
  s_mov_b32 s31, 2883584
  buffer_load_dwordx4 v4, s[32:35], s31 offen lds
  s_add_u32 m0, s22, 27680
  s_mov_b32 s31, 2949120
  buffer_load_dwordx4 v4, s[32:35], s31 offen lds
  s_add_u32 m0, s22, 12288
  s_mov_b32 s31, 3145728
  buffer_load_dwordx4 v4, s[32:35], s31 offen lds
  s_add_u32 m0, s22, 28704
  s_mov_b32 s31, 3211264
  buffer_load_dwordx4 v4, s[32:35], s31 offen lds
  s_add_u32 m0, s22, 13312
  s_mov_b32 s31, 3407872
  buffer_load_dwordx4 v4, s[32:35], s31 offen lds
  s_add_u32 m0, s22, 29728
  s_mov_b32 s31, 3473408
  buffer_load_dwordx4 v4, s[32:35], s31 offen lds
  s_add_u32 m0, s22, 14336
  s_mov_b32 s31, 3670016
  buffer_load_dwordx4 v4, s[32:35], s31 offen lds
  s_add_u32 m0, s22, 30752
  s_mov_b32 s31, 3735552
  buffer_load_dwordx4 v4, s[32:35], s31 offen lds
  s_waitcnt vmcnt(28)
  ds_read_b64_tr_b16 a[0:1], v2 offset:0
  ds_read_b64_tr_b16 a[2:3], v2 offset:256
  ds_read_b64_tr_b16 a[4:5], v2 offset:32
  ds_read_b64_tr_b16 a[6:7], v2 offset:288
  s_barrier
  ds_read_b128 v[16:19], v6 offset:0
  ds_read_b128 v[20:23], v6 offset:1024
  s_waitcnt vmcnt(26)
  ds_read_b64_tr_b16 a[8:9], v2 offset:1024
  ds_read_b64_tr_b16 a[10:11], v2 offset:1280
  ds_read_b64_tr_b16 a[12:13], v2 offset:1056
  ds_read_b64_tr_b16 a[14:15], v2 offset:1312
  s_waitcnt lgkmcnt(6)
  s_add_u32 m0, s22, 0
  s_mov_b32 s31, 3932160
  buffer_load_dwordx4 v4, s[32:35], s31 offen lds
  s_add_u32 m0, s22, 16416
  s_mov_b32 s31, 3997696
  buffer_load_dwordx4 v4, s[32:35], s31 offen lds
  ds_read_b128 v[24:27], v6 offset:2048
  ds_read_b128 v[28:31], v6 offset:3072
  s_waitcnt lgkmcnt(7)
  v_mfma_f32_16x16x32_bf16 v[48:51], a[0:3], v[16:19], 0
  v_mfma_f32_16x16x32_bf16 v[52:55], a[4:7], v[16:19], 0
  s_waitcnt lgkmcnt(6)
  v_mfma_f32_16x16x32_bf16 v[56:59], a[0:3], v[20:23], 0
  v_mfma_f32_16x16x32_bf16 v[60:63], a[4:7], v[20:23], 0
  s_waitcnt vmcnt(26)
  ds_read_b64_tr_b16 a[16:17], v2 offset:2048
  ds_read_b64_tr_b16 a[18:19], v2 offset:2304
  ds_read_b64_tr_b16 a[20:21], v2 offset:2080
  ds_read_b64_tr_b16 a[22:23], v2 offset:2336
  s_waitcnt lgkmcnt(6)
  s_mov_b32 s32, s44
  s_mov_b32 s33, s45
  s_mov_b32 s34, 4194304
  s_add_u32 m0, s22, 1024
  s_mov_b32 s31, 0
  buffer_load_dwordx4 v4, s[32:35], s31 offen lds
  s_add_u32 m0, s22, 17440
  s_mov_b32 s31, 65536
  buffer_load_dwordx4 v4, s[32:35], s31 offen lds
  ds_read_b128 v[32:35], v6 offset:4096
  ds_read_b128 v[36:39], v6 offset:5120
  s_waitcnt lgkmcnt(7)
  v_mfma_f32_16x16x32_bf16 v[48:51], a[8:11], v[24:27], v[48:51]
  v_mfma_f32_16x16x32_bf16 v[52:55], a[12:15], v[24:27], v[52:55]
  s_waitcnt lgkmcnt(6)
  v_mfma_f32_16x16x32_bf16 v[56:59], a[8:11], v[28:31], v[56:59]
  v_mfma_f32_16x16x32_bf16 v[60:63], a[12:15], v[28:31], v[60:63]
  s_waitcnt vmcnt(26)
  ds_read_b64_tr_b16 a[24:25], v2 offset:3072
  ds_read_b64_tr_b16 a[26:27], v2 offset:3328
  ds_read_b64_tr_b16 a[28:29], v2 offset:3104
  ds_read_b64_tr_b16 a[30:31], v2 offset:3360
  s_waitcnt lgkmcnt(6)
  s_add_u32 m0, s22, 2048
  s_mov_b32 s31, 262144
  buffer_load_dwordx4 v4, s[32:35], s31 offen lds
  s_add_u32 m0, s22, 18464
  s_mov_b32 s31, 327680
  buffer_load_dwordx4 v4, s[32:35], s31 offen lds
  ds_read_b128 v[40:43], v6 offset:6144
  ds_read_b128 v[44:47], v6 offset:7168
  s_waitcnt lgkmcnt(7)
  v_mfma_f32_16x16x32_bf16 v[48:51], a[16:19], v[32:35], v[48:51]
  v_mfma_f32_16x16x32_bf16 v[52:55], a[20:23], v[32:35], v[52:55]
  s_waitcnt lgkmcnt(6)
  v_mfma_f32_16x16x32_bf16 v[56:59], a[16:19], v[36:39], v[56:59]
  v_mfma_f32_16x16x32_bf16 v[60:63], a[20:23], v[36:39], v[60:63]
  s_waitcnt vmcnt(26)
  ds_read_b64_tr_b16 a[32:33], v2 offset:4096
  ds_read_b64_tr_b16 a[34:35], v2 offset:4352
  ds_read_b64_tr_b16 a[36:37], v2 offset:4128
  ds_read_b64_tr_b16 a[38:39], v2 offset:4384
  s_waitcnt lgkmcnt(6)
  s_add_u32 m0, s22, 3072
  s_mov_b32 s31, 524288
  buffer_load_dwordx4 v4, s[32:35], s31 offen lds
  s_add_u32 m0, s22, 19488
  s_mov_b32 s31, 589824
  buffer_load_dwordx4 v4, s[32:35], s31 offen lds
  ds_read_b128 v[16:19], v6 offset:8192
  ds_read_b128 v[20:23], v6 offset:9216
  s_waitcnt lgkmcnt(7)
  v_mfma_f32_16x16x32_bf16 v[48:51], a[24:27], v[40:43], v[48:51]
  v_mfma_f32_16x16x32_bf16 v[52:55], a[28:31], v[40:43], v[52:55]
  s_waitcnt lgkmcnt(6)
  v_mfma_f32_16x16x32_bf16 v[56:59], a[24:27], v[44:47], v[56:59]
  v_mfma_f32_16x16x32_bf16 v[60:63], a[28:31], v[44:47], v[60:63]
  s_waitcnt vmcnt(26)
  ds_read_b64_tr_b16 a[40:41], v2 offset:5120
  ds_read_b64_tr_b16 a[42:43], v2 offset:5376
  ds_read_b64_tr_b16 a[44:45], v2 offset:5152
  ds_read_b64_tr_b16 a[46:47], v2 offset:5408
  s_waitcnt lgkmcnt(6)
  s_add_u32 m0, s22, 4096
  s_mov_b32 s31, 786432
  buffer_load_dwordx4 v4, s[32:35], s31 offen lds
  s_add_u32 m0, s22, 20512
  s_mov_b32 s31, 851968
  buffer_load_dwordx4 v4, s[32:35], s31 offen lds
  ds_read_b128 v[24:27], v6 offset:10240
  ds_read_b128 v[28:31], v6 offset:11264
  s_waitcnt lgkmcnt(7)
  v_mfma_f32_16x16x32_bf16 v[48:51], a[32:35], v[16:19], v[48:51]
  v_mfma_f32_16x16x32_bf16 v[52:55], a[36:39], v[16:19], v[52:55]
  s_waitcnt lgkmcnt(6)
  v_mfma_f32_16x16x32_bf16 v[56:59], a[32:35], v[20:23], v[56:59]
  v_mfma_f32_16x16x32_bf16 v[60:63], a[36:39], v[20:23], v[60:63]
  s_waitcnt vmcnt(26)
  ds_read_b64_tr_b16 a[48:49], v2 offset:6144
  ds_read_b64_tr_b16 a[50:51], v2 offset:6400
  ds_read_b64_tr_b16 a[52:53], v2 offset:6176
  ds_read_b64_tr_b16 a[54:55], v2 offset:6432
  s_waitcnt lgkmcnt(6)
  s_add_u32 m0, s22, 5120
  s_mov_b32 s31, 1048576
  buffer_load_dwordx4 v4, s[32:35], s31 offen lds
  s_add_u32 m0, s22, 21536
  s_mov_b32 s31, 1114112
  buffer_load_dwordx4 v4, s[32:35], s31 offen lds
  ds_read_b128 v[32:35], v6 offset:12288
  ds_read_b128 v[36:39], v6 offset:13312
  s_waitcnt lgkmcnt(7)
  v_mfma_f32_16x16x32_bf16 v[48:51], a[40:43], v[24:27], v[48:51]
  v_mfma_f32_16x16x32_bf16 v[52:55], a[44:47], v[24:27], v[52:55]
  s_waitcnt lgkmcnt(6)
  v_mfma_f32_16x16x32_bf16 v[56:59], a[40:43], v[28:31], v[56:59]
  v_mfma_f32_16x16x32_bf16 v[60:63], a[44:47], v[28:31], v[60:63]
  s_waitcnt vmcnt(26)
  ds_read_b64_tr_b16 a[56:57], v2 offset:7168
  ds_read_b64_tr_b16 a[58:59], v2 offset:7424
  ds_read_b64_tr_b16 a[60:61], v2 offset:7200
  ds_read_b64_tr_b16 a[62:63], v2 offset:7456
  s_waitcnt lgkmcnt(6)
  s_add_u32 m0, s22, 6144
  s_mov_b32 s31, 1310720
  buffer_load_dwordx4 v4, s[32:35], s31 offen lds
  s_add_u32 m0, s22, 22560
  s_mov_b32 s31, 1376256
  buffer_load_dwordx4 v4, s[32:35], s31 offen lds
  ds_read_b128 v[40:43], v6 offset:14336
  ds_read_b128 v[44:47], v6 offset:15360
  s_waitcnt lgkmcnt(7)
  v_mfma_f32_16x16x32_bf16 v[48:51], a[48:51], v[32:35], v[48:51]
  v_mfma_f32_16x16x32_bf16 v[52:55], a[52:55], v[32:35], v[52:55]
  s_waitcnt lgkmcnt(6)
  v_mfma_f32_16x16x32_bf16 v[56:59], a[48:51], v[36:39], v[56:59]
  v_mfma_f32_16x16x32_bf16 v[60:63], a[52:55], v[36:39], v[60:63]
  s_waitcnt vmcnt(26)
  ds_read_b64_tr_b16 a[64:65], v2 offset:8192
  ds_read_b64_tr_b16 a[66:67], v2 offset:8448
  ds_read_b64_tr_b16 a[68:69], v2 offset:8224
  ds_read_b64_tr_b16 a[70:71], v2 offset:8480
  s_waitcnt lgkmcnt(6)
  s_add_u32 m0, s22, 7168
  s_mov_b32 s31, 1572864
  buffer_load_dwordx4 v4, s[32:35], s31 offen lds
  s_add_u32 m0, s22, 23584
  s_mov_b32 s31, 1638400
  buffer_load_dwordx4 v4, s[32:35], s31 offen lds
  ds_read_b128 v[16:19], v6 offset:16384
  ds_read_b128 v[20:23], v6 offset:17408
  s_waitcnt lgkmcnt(7)
  v_mfma_f32_16x16x32_bf16 v[48:51], a[56:59], v[40:43], v[48:51]
  v_mfma_f32_16x16x32_bf16 v[52:55], a[60:63], v[40:43], v[52:55]
  s_waitcnt lgkmcnt(6)
  v_mfma_f32_16x16x32_bf16 v[56:59], a[56:59], v[44:47], v[56:59]
  v_mfma_f32_16x16x32_bf16 v[60:63], a[60:63], v[44:47], v[60:63]
  s_waitcnt vmcnt(26)
  ds_read_b64_tr_b16 a[72:73], v2 offset:9216
  ds_read_b64_tr_b16 a[74:75], v2 offset:9472
  ds_read_b64_tr_b16 a[76:77], v2 offset:9248
  ds_read_b64_tr_b16 a[78:79], v2 offset:9504
  s_waitcnt lgkmcnt(6)
  s_add_u32 m0, s22, 8192
  s_mov_b32 s31, 1835008
  buffer_load_dwordx4 v4, s[32:35], s31 offen lds
  s_add_u32 m0, s22, 24608
  s_mov_b32 s31, 1900544
  buffer_load_dwordx4 v4, s[32:35], s31 offen lds
  ds_read_b128 v[24:27], v6 offset:18432
  ds_read_b128 v[28:31], v6 offset:19456
  s_waitcnt lgkmcnt(7)
  v_mfma_f32_16x16x32_bf16 v[48:51], a[64:67], v[16:19], v[48:51]
  v_mfma_f32_16x16x32_bf16 v[52:55], a[68:71], v[16:19], v[52:55]
  s_waitcnt lgkmcnt(6)
  v_mfma_f32_16x16x32_bf16 v[56:59], a[64:67], v[20:23], v[56:59]
  v_mfma_f32_16x16x32_bf16 v[60:63], a[68:71], v[20:23], v[60:63]
  s_waitcnt vmcnt(26)
  ds_read_b64_tr_b16 a[80:81], v2 offset:10240
  ds_read_b64_tr_b16 a[82:83], v2 offset:10496
  ds_read_b64_tr_b16 a[84:85], v2 offset:10272
  ds_read_b64_tr_b16 a[86:87], v2 offset:10528
  s_waitcnt lgkmcnt(6)
  s_add_u32 m0, s22, 9216
  s_mov_b32 s31, 2097152
  buffer_load_dwordx4 v4, s[32:35], s31 offen lds
  s_add_u32 m0, s22, 25632
  s_mov_b32 s31, 2162688
  buffer_load_dwordx4 v4, s[32:35], s31 offen lds
  ds_read_b128 v[32:35], v6 offset:20480
  ds_read_b128 v[36:39], v6 offset:21504
  s_waitcnt lgkmcnt(7)
  v_mfma_f32_16x16x32_bf16 v[48:51], a[72:75], v[24:27], v[48:51]
  v_mfma_f32_16x16x32_bf16 v[52:55], a[76:79], v[24:27], v[52:55]
  s_waitcnt lgkmcnt(6)
  v_mfma_f32_16x16x32_bf16 v[56:59], a[72:75], v[28:31], v[56:59]
  v_mfma_f32_16x16x32_bf16 v[60:63], a[76:79], v[28:31], v[60:63]
  s_waitcnt vmcnt(26)
  ds_read_b64_tr_b16 a[88:89], v2 offset:11264
  ds_read_b64_tr_b16 a[90:91], v2 offset:11520
  ds_read_b64_tr_b16 a[92:93], v2 offset:11296
  ds_read_b64_tr_b16 a[94:95], v2 offset:11552
  s_waitcnt lgkmcnt(6)
  s_add_u32 m0, s22, 10240
  s_mov_b32 s31, 2359296
  buffer_load_dwordx4 v4, s[32:35], s31 offen lds
  s_add_u32 m0, s22, 26656
  s_mov_b32 s31, 2424832
  buffer_load_dwordx4 v4, s[32:35], s31 offen lds
  ds_read_b128 v[40:43], v6 offset:22528
  ds_read_b128 v[44:47], v6 offset:23552
  s_waitcnt lgkmcnt(7)
  v_mfma_f32_16x16x32_bf16 v[48:51], a[80:83], v[32:35], v[48:51]
  v_mfma_f32_16x16x32_bf16 v[52:55], a[84:87], v[32:35], v[52:55]
  s_waitcnt lgkmcnt(6)
  v_mfma_f32_16x16x32_bf16 v[56:59], a[80:83], v[36:39], v[56:59]
  v_mfma_f32_16x16x32_bf16 v[60:63], a[84:87], v[36:39], v[60:63]
  s_waitcnt vmcnt(26)
  ds_read_b64_tr_b16 a[96:97], v2 offset:12288
  ds_read_b64_tr_b16 a[98:99], v2 offset:12544
  ds_read_b64_tr_b16 a[100:101], v2 offset:12320
  ds_read_b64_tr_b16 a[102:103], v2 offset:12576
  s_waitcnt lgkmcnt(6)
  s_add_u32 m0, s22, 11264
  s_mov_b32 s31, 2621440
  buffer_load_dwordx4 v4, s[32:35], s31 offen lds
  s_add_u32 m0, s22, 27680
  s_mov_b32 s31, 2686976
  buffer_load_dwordx4 v4, s[32:35], s31 offen lds
  ds_read_b128 v[16:19], v6 offset:24576
  ds_read_b128 v[20:23], v6 offset:25600
  s_waitcnt lgkmcnt(7)
  v_mfma_f32_16x16x32_bf16 v[48:51], a[88:91], v[40:43], v[48:51]
  v_mfma_f32_16x16x32_bf16 v[52:55], a[92:95], v[40:43], v[52:55]
  s_waitcnt lgkmcnt(6)
  v_mfma_f32_16x16x32_bf16 v[56:59], a[88:91], v[44:47], v[56:59]
  v_mfma_f32_16x16x32_bf16 v[60:63], a[92:95], v[44:47], v[60:63]
  s_waitcnt vmcnt(26)
  ds_read_b64_tr_b16 a[104:105], v2 offset:13312
  ds_read_b64_tr_b16 a[106:107], v2 offset:13568
  ds_read_b64_tr_b16 a[108:109], v2 offset:13344
  ds_read_b64_tr_b16 a[110:111], v2 offset:13600
  s_waitcnt lgkmcnt(6)
  s_add_u32 m0, s22, 12288
  s_mov_b32 s31, 2883584
  buffer_load_dwordx4 v4, s[32:35], s31 offen lds
  s_add_u32 m0, s22, 28704
  s_mov_b32 s31, 2949120
  buffer_load_dwordx4 v4, s[32:35], s31 offen lds
  ds_read_b128 v[24:27], v6 offset:26624
  ds_read_b128 v[28:31], v6 offset:27648
  s_waitcnt lgkmcnt(7)
  v_mfma_f32_16x16x32_bf16 v[48:51], a[96:99], v[16:19], v[48:51]
  v_mfma_f32_16x16x32_bf16 v[52:55], a[100:103], v[16:19], v[52:55]
  s_waitcnt lgkmcnt(6)
  v_mfma_f32_16x16x32_bf16 v[56:59], a[96:99], v[20:23], v[56:59]
  v_mfma_f32_16x16x32_bf16 v[60:63], a[100:103], v[20:23], v[60:63]
  s_waitcnt vmcnt(26)
  ds_read_b64_tr_b16 a[112:113], v2 offset:14336
  ds_read_b64_tr_b16 a[114:115], v2 offset:14592
  ds_read_b64_tr_b16 a[116:117], v2 offset:14368
  ds_read_b64_tr_b16 a[118:119], v2 offset:14624
  s_waitcnt lgkmcnt(6)
  s_add_u32 m0, s22, 13312
  s_mov_b32 s31, 3145728
  buffer_load_dwordx4 v4, s[32:35], s31 offen lds
  s_add_u32 m0, s22, 29728
  s_mov_b32 s31, 3211264
  buffer_load_dwordx4 v4, s[32:35], s31 offen lds
  ds_read_b128 v[32:35], v6 offset:28672
  ds_read_b128 v[36:39], v6 offset:29696
  s_waitcnt lgkmcnt(7)
  v_mfma_f32_16x16x32_bf16 v[48:51], a[104:107], v[24:27], v[48:51]
  v_mfma_f32_16x16x32_bf16 v[52:55], a[108:111], v[24:27], v[52:55]
  s_waitcnt lgkmcnt(6)
  v_mfma_f32_16x16x32_bf16 v[56:59], a[104:107], v[28:31], v[56:59]
  v_mfma_f32_16x16x32_bf16 v[60:63], a[108:111], v[28:31], v[60:63]
  s_waitcnt vmcnt(26)
  ds_read_b64_tr_b16 a[120:121], v2 offset:0
  ds_read_b64_tr_b16 a[122:123], v2 offset:256
  ds_read_b64_tr_b16 a[124:125], v2 offset:32
  ds_read_b64_tr_b16 a[126:127], v2 offset:288
  s_waitcnt lgkmcnt(6)
  s_add_u32 m0, s22, 14336
  s_mov_b32 s31, 3407872
  buffer_load_dwordx4 v4, s[32:35], s31 offen lds
  s_add_u32 m0, s22, 30752
  s_mov_b32 s31, 3473408
  buffer_load_dwordx4 v4, s[32:35], s31 offen lds
  ds_read_b128 v[40:43], v6 offset:30720
  ds_read_b128 v[44:47], v6 offset:31744
  s_waitcnt lgkmcnt(7)
  v_mfma_f32_16x16x32_bf16 v[48:51], a[112:115], v[32:35], v[48:51]
  v_mfma_f32_16x16x32_bf16 v[52:55], a[116:119], v[32:35], v[52:55]
  s_waitcnt lgkmcnt(6)
  v_mfma_f32_16x16x32_bf16 v[56:59], a[112:115], v[36:39], v[56:59]
  v_mfma_f32_16x16x32_bf16 v[60:63], a[116:119], v[36:39], v[60:63]
  s_waitcnt vmcnt(26)
  ds_read_b64_tr_b16 a[128:129], v2 offset:1024
  ds_read_b64_tr_b16 a[130:131], v2 offset:1280
  ds_read_b64_tr_b16 a[132:133], v2 offset:1056
  ds_read_b64_tr_b16 a[134:135], v2 offset:1312
  s_waitcnt lgkmcnt(6)
  s_add_u32 m0, s22, 0
  s_mov_b32 s31, 3670016
  buffer_load_dwordx4 v4, s[32:35], s31 offen lds
  s_add_u32 m0, s22, 16416
  s_mov_b32 s31, 3735552
  buffer_load_dwordx4 v4, s[32:35], s31 offen lds
  ds_read_b128 v[16:19], v6 offset:0
  ds_read_b128 v[20:23], v6 offset:1024
  s_waitcnt lgkmcnt(7)
  v_mfma_f32_16x16x32_bf16 v[48:51], a[120:123], v[40:43], v[48:51]
  v_mfma_f32_16x16x32_bf16 v[52:55], a[124:127], v[40:43], v[52:55]
  s_waitcnt lgkmcnt(6)
  v_mfma_f32_16x16x32_bf16 v[56:59], a[120:123], v[44:47], v[56:59]
  v_mfma_f32_16x16x32_bf16 v[60:63], a[124:127], v[44:47], v[60:63]
  s_waitcnt vmcnt(26)
  ds_read_b64_tr_b16 a[136:137], v2 offset:2048
  ds_read_b64_tr_b16 a[138:139], v2 offset:2304
  ds_read_b64_tr_b16 a[140:141], v2 offset:2080
  ds_read_b64_tr_b16 a[142:143], v2 offset:2336
  s_waitcnt lgkmcnt(6)
  s_add_u32 m0, s22, 1024
  s_mov_b32 s31, 3932160
  buffer_load_dwordx4 v4, s[32:35], s31 offen lds
  s_add_u32 m0, s22, 17440
  s_mov_b32 s31, 3997696
  buffer_load_dwordx4 v4, s[32:35], s31 offen lds
  ds_read_b128 v[24:27], v6 offset:2048
  ds_read_b128 v[28:31], v6 offset:3072
  s_waitcnt lgkmcnt(7)
  v_mfma_f32_16x16x32_bf16 v[64:67], v[16:19], a[128:131], 0
  v_mfma_f32_16x16x32_bf16 v[68:71], v[16:19], a[132:135], 0
  s_waitcnt lgkmcnt(6)
  v_mfma_f32_16x16x32_bf16 v[72:75], v[20:23], a[128:131], 0
  v_mfma_f32_16x16x32_bf16 v[76:79], v[20:23], a[132:135], 0
  s_waitcnt vmcnt(26)
  ds_read_b64_tr_b16 a[144:145], v2 offset:3072
  ds_read_b64_tr_b16 a[146:147], v2 offset:3328
  ds_read_b64_tr_b16 a[148:149], v2 offset:3104
  ds_read_b64_tr_b16 a[150:151], v2 offset:3360
  ds_read_b128 v[32:35], v6 offset:4096
  ds_read_b128 v[36:39], v6 offset:5120
  s_waitcnt lgkmcnt(7)
  v_mfma_f32_16x16x32_bf16 v[64:67], v[24:27], a[136:139], v[64:67]
  v_mfma_f32_16x16x32_bf16 v[68:71], v[24:27], a[140:143], v[68:71]
  s_waitcnt lgkmcnt(6)
  v_mfma_f32_16x16x32_bf16 v[72:75], v[28:31], a[136:139], v[72:75]
  v_mfma_f32_16x16x32_bf16 v[76:79], v[28:31], a[140:143], v[76:79]
  s_waitcnt vmcnt(24)
  ds_read_b64_tr_b16 a[152:153], v2 offset:4096
  ds_read_b64_tr_b16 a[154:155], v2 offset:4352
  ds_read_b64_tr_b16 a[156:157], v2 offset:4128
  ds_read_b64_tr_b16 a[158:159], v2 offset:4384
  ds_read_b128 v[40:43], v6 offset:6144
  ds_read_b128 v[44:47], v6 offset:7168
  s_waitcnt lgkmcnt(7)
  v_mfma_f32_16x16x32_bf16 v[64:67], v[32:35], a[144:147], v[64:67]
  v_mfma_f32_16x16x32_bf16 v[68:71], v[32:35], a[148:151], v[68:71]
  s_waitcnt lgkmcnt(6)
  v_mfma_f32_16x16x32_bf16 v[72:75], v[36:39], a[144:147], v[72:75]
  v_mfma_f32_16x16x32_bf16 v[76:79], v[36:39], a[148:151], v[76:79]
  s_waitcnt vmcnt(22)
  ds_read_b64_tr_b16 a[160:161], v2 offset:5120
  ds_read_b64_tr_b16 a[162:163], v2 offset:5376
  ds_read_b64_tr_b16 a[164:165], v2 offset:5152
  ds_read_b64_tr_b16 a[166:167], v2 offset:5408
  ds_read_b128 v[16:19], v6 offset:8192
  ds_read_b128 v[20:23], v6 offset:9216
  s_waitcnt lgkmcnt(7)
  v_mfma_f32_16x16x32_bf16 v[64:67], v[40:43], a[152:155], v[64:67]
  v_mfma_f32_16x16x32_bf16 v[68:71], v[40:43], a[156:159], v[68:71]
  s_waitcnt lgkmcnt(6)
  v_mfma_f32_16x16x32_bf16 v[72:75], v[44:47], a[152:155], v[72:75]
  v_mfma_f32_16x16x32_bf16 v[76:79], v[44:47], a[156:159], v[76:79]
  s_waitcnt vmcnt(20)
  ds_read_b64_tr_b16 a[168:169], v2 offset:6144
  ds_read_b64_tr_b16 a[170:171], v2 offset:6400
  ds_read_b64_tr_b16 a[172:173], v2 offset:6176
  ds_read_b64_tr_b16 a[174:175], v2 offset:6432
  ds_read_b128 v[24:27], v6 offset:10240
  ds_read_b128 v[28:31], v6 offset:11264
  s_waitcnt lgkmcnt(7)
  v_mfma_f32_16x16x32_bf16 v[64:67], v[16:19], a[160:163], v[64:67]
  v_mfma_f32_16x16x32_bf16 v[68:71], v[16:19], a[164:167], v[68:71]
  s_waitcnt lgkmcnt(6)
  v_mfma_f32_16x16x32_bf16 v[72:75], v[20:23], a[160:163], v[72:75]
  v_mfma_f32_16x16x32_bf16 v[76:79], v[20:23], a[164:167], v[76:79]
  s_waitcnt vmcnt(18)
  ds_read_b64_tr_b16 a[176:177], v2 offset:7168
  ds_read_b64_tr_b16 a[178:179], v2 offset:7424
  ds_read_b64_tr_b16 a[180:181], v2 offset:7200
  ds_read_b64_tr_b16 a[182:183], v2 offset:7456
  ds_read_b128 v[32:35], v6 offset:12288
  ds_read_b128 v[36:39], v6 offset:13312
  s_waitcnt lgkmcnt(7)
  v_mfma_f32_16x16x32_bf16 v[64:67], v[24:27], a[168:171], v[64:67]
  v_mfma_f32_16x16x32_bf16 v[68:71], v[24:27], a[172:175], v[68:71]
  s_waitcnt lgkmcnt(6)
  v_mfma_f32_16x16x32_bf16 v[72:75], v[28:31], a[168:171], v[72:75]
  v_mfma_f32_16x16x32_bf16 v[76:79], v[28:31], a[172:175], v[76:79]
  s_waitcnt vmcnt(16)
  ds_read_b64_tr_b16 a[184:185], v2 offset:8192
  ds_read_b64_tr_b16 a[186:187], v2 offset:8448
  ds_read_b64_tr_b16 a[188:189], v2 offset:8224
  ds_read_b64_tr_b16 a[190:191], v2 offset:8480
  ds_read_b128 v[40:43], v6 offset:14336
  ds_read_b128 v[44:47], v6 offset:15360
  s_waitcnt lgkmcnt(7)
  v_mfma_f32_16x16x32_bf16 v[64:67], v[32:35], a[176:179], v[64:67]
  v_mfma_f32_16x16x32_bf16 v[68:71], v[32:35], a[180:183], v[68:71]
  s_waitcnt lgkmcnt(6)
  v_mfma_f32_16x16x32_bf16 v[72:75], v[36:39], a[176:179], v[72:75]
  v_mfma_f32_16x16x32_bf16 v[76:79], v[36:39], a[180:183], v[76:79]
  s_waitcnt vmcnt(14)
  ds_read_b64_tr_b16 a[192:193], v2 offset:9216
  ds_read_b64_tr_b16 a[194:195], v2 offset:9472
  ds_read_b64_tr_b16 a[196:197], v2 offset:9248
  ds_read_b64_tr_b16 a[198:199], v2 offset:9504
  ds_read_b128 v[16:19], v6 offset:16384
  ds_read_b128 v[20:23], v6 offset:17408
  s_waitcnt lgkmcnt(7)
  v_mfma_f32_16x16x32_bf16 v[64:67], v[40:43], a[184:187], v[64:67]
  v_mfma_f32_16x16x32_bf16 v[68:71], v[40:43], a[188:191], v[68:71]
  s_waitcnt lgkmcnt(6)
  v_mfma_f32_16x16x32_bf16 v[72:75], v[44:47], a[184:187], v[72:75]
  v_mfma_f32_16x16x32_bf16 v[76:79], v[44:47], a[188:191], v[76:79]
  buffer_load_dword v9, v10, s[12:15], 0 offen sc1
  s_waitcnt vmcnt(13)
  ds_read_b64_tr_b16 a[200:201], v2 offset:10240
  ds_read_b64_tr_b16 a[202:203], v2 offset:10496
  ds_read_b64_tr_b16 a[204:205], v2 offset:10272
  ds_read_b64_tr_b16 a[206:207], v2 offset:10528
  ds_read_b128 v[24:27], v6 offset:18432
  ds_read_b128 v[28:31], v6 offset:19456
  s_waitcnt lgkmcnt(7)
  v_mfma_f32_16x16x32_bf16 v[64:67], v[16:19], a[192:195], v[64:67]
  v_mfma_f32_16x16x32_bf16 v[68:71], v[16:19], a[196:199], v[68:71]
  s_waitcnt lgkmcnt(6)
  v_mfma_f32_16x16x32_bf16 v[72:75], v[20:23], a[192:195], v[72:75]
  v_mfma_f32_16x16x32_bf16 v[76:79], v[20:23], a[196:199], v[76:79]
  s_waitcnt vmcnt(11)
  ds_read_b64_tr_b16 a[208:209], v2 offset:11264
  ds_read_b64_tr_b16 a[210:211], v2 offset:11520
  ds_read_b64_tr_b16 a[212:213], v2 offset:11296
  ds_read_b64_tr_b16 a[214:215], v2 offset:11552
  ds_read_b128 v[32:35], v6 offset:20480
  ds_read_b128 v[36:39], v6 offset:21504
  s_waitcnt lgkmcnt(7)
  v_mfma_f32_16x16x32_bf16 v[64:67], v[24:27], a[200:203], v[64:67]
  v_mfma_f32_16x16x32_bf16 v[68:71], v[24:27], a[204:207], v[68:71]
  s_waitcnt lgkmcnt(6)
  v_mfma_f32_16x16x32_bf16 v[72:75], v[28:31], a[200:203], v[72:75]
  v_mfma_f32_16x16x32_bf16 v[76:79], v[28:31], a[204:207], v[76:79]
  s_waitcnt vmcnt(9)
  ds_read_b64_tr_b16 a[216:217], v2 offset:12288
  ds_read_b64_tr_b16 a[218:219], v2 offset:12544
  ds_read_b64_tr_b16 a[220:221], v2 offset:12320
  ds_read_b64_tr_b16 a[222:223], v2 offset:12576
  ds_read_b128 v[40:43], v6 offset:22528
  ds_read_b128 v[44:47], v6 offset:23552
  s_waitcnt lgkmcnt(7)
  v_mfma_f32_16x16x32_bf16 v[64:67], v[32:35], a[208:211], v[64:67]
  v_mfma_f32_16x16x32_bf16 v[68:71], v[32:35], a[212:215], v[68:71]
  s_waitcnt lgkmcnt(6)
  v_mfma_f32_16x16x32_bf16 v[72:75], v[36:39], a[208:211], v[72:75]
  v_mfma_f32_16x16x32_bf16 v[76:79], v[36:39], a[212:215], v[76:79]
  s_waitcnt vmcnt(7)
  ds_read_b64_tr_b16 a[224:225], v2 offset:13312
  ds_read_b64_tr_b16 a[226:227], v2 offset:13568
  ds_read_b64_tr_b16 a[228:229], v2 offset:13344
  ds_read_b64_tr_b16 a[230:231], v2 offset:13600
  ds_read_b128 v[16:19], v6 offset:24576
  ds_read_b128 v[20:23], v6 offset:25600
  s_waitcnt lgkmcnt(7)
  v_mfma_f32_16x16x32_bf16 v[64:67], v[40:43], a[216:219], v[64:67]
  v_mfma_f32_16x16x32_bf16 v[68:71], v[40:43], a[220:223], v[68:71]
  s_waitcnt lgkmcnt(6)
  v_mfma_f32_16x16x32_bf16 v[72:75], v[44:47], a[216:219], v[72:75]
  v_mfma_f32_16x16x32_bf16 v[76:79], v[44:47], a[220:223], v[76:79]
  s_waitcnt vmcnt(5)
  ds_read_b64_tr_b16 a[232:233], v2 offset:14336
  ds_read_b64_tr_b16 a[234:235], v2 offset:14592
  ds_read_b64_tr_b16 a[236:237], v2 offset:14368
  ds_read_b64_tr_b16 a[238:239], v2 offset:14624
  ds_read_b128 v[24:27], v6 offset:26624
  ds_read_b128 v[28:31], v6 offset:27648
  s_waitcnt lgkmcnt(7)
  v_mfma_f32_16x16x32_bf16 v[64:67], v[16:19], a[224:227], v[64:67]
  v_mfma_f32_16x16x32_bf16 v[68:71], v[16:19], a[228:231], v[68:71]
  s_waitcnt lgkmcnt(6)
  v_mfma_f32_16x16x32_bf16 v[72:75], v[20:23], a[224:227], v[72:75]
  v_mfma_f32_16x16x32_bf16 v[76:79], v[20:23], a[228:231], v[76:79]
  s_waitcnt vmcnt(3)
  ds_read_b64_tr_b16 a[240:241], v2 offset:0
  ds_read_b64_tr_b16 a[242:243], v2 offset:256
  ds_read_b64_tr_b16 a[244:245], v2 offset:32
  ds_read_b64_tr_b16 a[246:247], v2 offset:288
  ds_read_b128 v[32:35], v6 offset:28672
  ds_read_b128 v[36:39], v6 offset:29696
  s_waitcnt lgkmcnt(7)
  v_mfma_f32_16x16x32_bf16 v[64:67], v[24:27], a[232:235], v[64:67]
  v_mfma_f32_16x16x32_bf16 v[68:71], v[24:27], a[236:239], v[68:71]
  s_waitcnt lgkmcnt(6)
  v_mfma_f32_16x16x32_bf16 v[72:75], v[28:31], a[232:235], v[72:75]
  v_mfma_f32_16x16x32_bf16 v[76:79], v[28:31], a[236:239], v[76:79]
  s_waitcnt vmcnt(1)
  ds_read_b64_tr_b16 a[248:249], v2 offset:1024
  ds_read_b64_tr_b16 a[250:251], v2 offset:1280
  ds_read_b64_tr_b16 a[252:253], v2 offset:1056
  ds_read_b64_tr_b16 a[254:255], v2 offset:1312
  ds_read_b128 v[40:43], v6 offset:30720
  ds_read_b128 v[44:47], v6 offset:31744
  s_waitcnt lgkmcnt(7)
  v_mfma_f32_16x16x32_bf16 v[64:67], v[32:35], a[240:243], v[64:67]
  v_mfma_f32_16x16x32_bf16 v[68:71], v[32:35], a[244:247], v[68:71]
  s_waitcnt lgkmcnt(6)
  v_mfma_f32_16x16x32_bf16 v[72:75], v[36:39], a[240:243], v[72:75]
  v_mfma_f32_16x16x32_bf16 v[76:79], v[36:39], a[244:247], v[76:79]
  s_lshl_b32 s24, s23, 5
  s_add_u32 s24, s24, s56
  s_lshl_b32 s24, s24, 2
  s_add_u32 s24, s24, s20
  s_lshl_b32 s25, s24, 11
  s_add_u32 s25, s25, 67108864
  s_lshl_b32 s24, s24, 12
  v_cvt_pk_bf16_f32 v96, v48, v49
  v_cvt_pk_bf16_f32 v97, v50, v51
  v_cvt_pk_bf16_f32 v98, v52, v53
  v_cvt_pk_bf16_f32 v99, v54, v55
  buffer_store_dwordx4 v[96:99], v1, s[8:11], s24 offen offset:0 sc1
  v_cvt_pk_bf16_f32 v100, v56, v57
  v_cvt_pk_bf16_f32 v101, v58, v59
  v_cvt_pk_bf16_f32 v102, v60, v61
  v_cvt_pk_bf16_f32 v103, v62, v63
  buffer_store_dwordx4 v[100:103], v1, s[8:11], s24 offen offset:1024 sc1
  s_waitcnt lgkmcnt(1)
  v_mfma_f32_16x16x32_bf16 v[64:67], v[40:43], a[248:251], v[64:67]
  v_mfma_f32_16x16x32_bf16 v[68:71], v[40:43], a[252:255], v[68:71]
  s_waitcnt lgkmcnt(0)
  v_mfma_f32_16x16x32_bf16 v[72:75], v[44:47], a[248:251], v[72:75]
  v_mfma_f32_16x16x32_bf16 v[76:79], v[44:47], a[252:255], v[76:79]
  v_cvt_pk_bf16_f32 v112, v64, v65
  v_cvt_pk_bf16_f32 v113, v66, v67
  s_nop 1
  v_cvt_pk_bf16_f32 v114, v72, v73
  v_cvt_pk_bf16_f32 v115, v74, v75
  buffer_store_dwordx4 v[112:115], v1, s[8:11], s24 offen offset:2048 sc1
  v_cvt_pk_bf16_f32 v116, v68, v69
  v_cvt_pk_bf16_f32 v117, v70, v71
  v_cvt_pk_bf16_f32 v118, v76, v77
  v_cvt_pk_bf16_f32 v119, v78, v79
  buffer_store_dwordx4 v[116:119], v1, s[8:11], s24 offen offset:3072 sc1
  s_waitcnt vmcnt(4)
  v_and_b32 v9, 0x80808080, v9
  v_cmp_ne_u32 vcc, 0x80808080, v9
  s_mov_b32 s30, 1
  s_cbranch_vccz P_hsok
  v_and_b32 v10, 31, v0
  v_lshlrev_b32 v10, 2, v10
P_hs:
  s_add_u32 s79, s79, 1
  s_cmp_gt_u32 s79, 524288
  s_cbranch_scc1 L_exit
  buffer_load_dword v9, v10, s[12:15], 0 offen sc1
  s_waitcnt vmcnt(0)
  v_and_b32 v9, 0x80808080, v9
  v_cmp_ne_u32 vcc, 0x80808080, v9
  s_cbranch_vccnz P_hs
P_hsok:
  s_waitcnt vmcnt(0)
  v_mov_b32 v9, s30
  s_mov_b64 exec, 1
  buffer_store_dword v9, v7, s[8:11], s27 offen sc1
  s_mov_b64 exec, -1
  s_mov_b32 s32, s40
  s_mov_b32 s33, s41
  s_mov_b32 s34, 4194304
  s_add_u32 m0, s22, 0
  s_mov_b32 s31, 0
  buffer_load_dwordx4 v4, s[32:35], s31 offen lds
  s_add_u32 m0, s22, 16416
  s_mov_b32 s31, 65536
  buffer_load_dwordx4 v4, s[32:35], s31 offen lds
  s_add_u32 m0, s22, 1024
  s_mov_b32 s31, 262144
  buffer_load_dwordx4 v4, s[32:35], s31 offen lds
  s_add_u32 m0, s22, 17440
  s_mov_b32 s31, 327680
  buffer_load_dwordx4 v4, s[32:35], s31 offen lds
  s_add_u32 m0, s22, 2048
  s_mov_b32 s31, 524288
  buffer_load_dwordx4 v4, s[32:35], s31 offen lds
  s_add_u32 m0, s22, 18464
  s_mov_b32 s31, 589824
  buffer_load_dwordx4 v4, s[32:35], s31 offen lds
  s_add_u32 m0, s22, 3072
  s_mov_b32 s31, 786432
  buffer_load_dwordx4 v4, s[32:35], s31 offen lds
  s_add_u32 m0, s22, 19488
  s_mov_b32 s31, 851968
  buffer_load_dwordx4 v4, s[32:35], s31 offen lds
  s_add_u32 m0, s22, 4096
  s_mov_b32 s31, 1048576
  buffer_load_dwordx4 v4, s[32:35], s31 offen lds
  s_add_u32 m0, s22, 20512
  s_mov_b32 s31, 1114112
  buffer_load_dwordx4 v4, s[32:35], s31 offen lds
  s_add_u32 m0, s22, 5120
  s_mov_b32 s31, 1310720
  buffer_load_dwordx4 v4, s[32:35], s31 offen lds
  s_add_u32 m0, s22, 21536
  s_mov_b32 s31, 1376256
  buffer_load_dwordx4 v4, s[32:35], s31 offen lds
  s_add_u32 m0, s22, 6144
  s_mov_b32 s31, 1572864
  buffer_load_dwordx4 v4, s[32:35], s31 offen lds
  s_add_u32 m0, s22, 22560
  s_mov_b32 s31, 1638400
  buffer_load_dwordx4 v4, s[32:35], s31 offen lds
  s_add_u32 m0, s22, 7168
  s_mov_b32 s31, 1835008
  buffer_load_dwordx4 v4, s[32:35], s31 offen lds
  s_add_u32 m0, s22, 23584
  s_mov_b32 s31, 1900544
  buffer_load_dwordx4 v4, s[32:35], s31 offen lds
  s_add_u32 m0, s22, 8192
  s_mov_b32 s31, 2097152
  buffer_load_dwordx4 v4, s[32:35], s31 offen lds
  s_add_u32 m0, s22, 24608
  s_mov_b32 s31, 2162688
  buffer_load_dwordx4 v4, s[32:35], s31 offen lds
  s_add_u32 m0, s22, 9216
  s_mov_b32 s31, 2359296
  buffer_load_dwordx4 v4, s[32:35], s31 offen lds
  s_add_u32 m0, s22, 25632
  s_mov_b32 s31, 2424832
  buffer_load_dwordx4 v4, s[32:35], s31 offen lds
  s_add_u32 m0, s22, 10240
  s_mov_b32 s31, 2621440
  buffer_load_dwordx4 v4, s[32:35], s31 offen lds
  s_add_u32 m0, s22, 26656
  s_mov_b32 s31, 2686976
  buffer_load_dwordx4 v4, s[32:35], s31 offen lds
  s_add_u32 m0, s22, 11264
  s_mov_b32 s31, 2883584
  buffer_load_dwordx4 v4, s[32:35], s31 offen lds
  s_add_u32 m0, s22, 27680
  s_mov_b32 s31, 2949120
  buffer_load_dwordx4 v4, s[32:35], s31 offen lds
  s_add_u32 m0, s22, 12288
  s_mov_b32 s31, 3145728
  buffer_load_dwordx4 v4, s[32:35], s31 offen lds
  s_add_u32 m0, s22, 28704
  s_mov_b32 s31, 3211264
  buffer_load_dwordx4 v4, s[32:35], s31 offen lds
  s_add_u32 m0, s22, 13312
  s_mov_b32 s31, 3407872
  buffer_load_dwordx4 v4, s[32:35], s31 offen lds
  s_add_u32 m0, s22, 29728
  s_mov_b32 s31, 3473408
  buffer_load_dwordx4 v4, s[32:35], s31 offen lds
  s_add_u32 m0, s22, 14336
  s_mov_b32 s31, 3670016
  buffer_load_dwordx4 v4, s[32:35], s31 offen lds
  s_add_u32 m0, s22, 30752
  s_mov_b32 s31, 3735552
  buffer_load_dwordx4 v4, s[32:35], s31 offen lds
  s_waitcnt vmcnt(28)
  ds_read_b64_tr_b16 v[128:129], v2 offset:0
  ds_read_b64_tr_b16 v[130:131], v2 offset:256
  ds_read_b64_tr_b16 v[132:133], v2 offset:32
  ds_read_b64_tr_b16 v[134:135], v2 offset:288
  s_waitcnt vmcnt(26)
  ds_read_b64_tr_b16 v[136:137], v2 offset:1024
  ds_read_b64_tr_b16 v[138:139], v2 offset:1280
  ds_read_b64_tr_b16 v[140:141], v2 offset:1056
  ds_read_b64_tr_b16 v[142:143], v2 offset:1312
  s_waitcnt lgkmcnt(4)
  s_add_u32 m0, s22, 0
  s_mov_b32 s31, 3932160
  buffer_load_dwordx4 v4, s[32:35], s31 offen lds
  s_add_u32 m0, s22, 16416
  s_mov_b32 s31, 3997696
  buffer_load_dwordx4 v4, s[32:35], s31 offen lds
  s_waitcnt vmcnt(26)
  ds_read_b64_tr_b16 v[144:145], v2 offset:2048
  ds_read_b64_tr_b16 v[146:147], v2 offset:2304
  ds_read_b64_tr_b16 v[148:149], v2 offset:2080
  ds_read_b64_tr_b16 v[150:151], v2 offset:2336
  s_waitcnt vmcnt(24)
  ds_read_b64_tr_b16 v[152:153], v2 offset:3072
  ds_read_b64_tr_b16 v[154:155], v2 offset:3328
  ds_read_b64_tr_b16 v[156:157], v2 offset:3104
  ds_read_b64_tr_b16 v[158:159], v2 offset:3360
  s_waitcnt vmcnt(22)
  ds_read_b64_tr_b16 v[160:161], v2 offset:4096
  ds_read_b64_tr_b16 v[162:163], v2 offset:4352
  ds_read_b64_tr_b16 v[164:165], v2 offset:4128
  ds_read_b64_tr_b16 v[166:167], v2 offset:4384
  s_waitcnt vmcnt(20)
  ds_read_b64_tr_b16 v[168:169], v2 offset:5120
  ds_read_b64_tr_b16 v[170:171], v2 offset:5376
  ds_read_b64_tr_b16 v[172:173], v2 offset:5152
  ds_read_b64_tr_b16 v[174:175], v2 offset:5408
  s_waitcnt vmcnt(18)
  ds_read_b64_tr_b16 v[176:177], v2 offset:6144
  ds_read_b64_tr_b16 v[178:179], v2 offset:6400
  ds_read_b64_tr_b16 v[180:181], v2 offset:6176
  ds_read_b64_tr_b16 v[182:183], v2 offset:6432
  s_waitcnt vmcnt(16)
  ds_read_b64_tr_b16 v[184:185], v2 offset:7168
  ds_read_b64_tr_b16 v[186:187], v2 offset:7424
  ds_read_b64_tr_b16 v[188:189], v2 offset:7200
  ds_read_b64_tr_b16 v[190:191], v2 offset:7456
  s_waitcnt vmcnt(14)
  ds_read_b64_tr_b16 v[192:193], v2 offset:8192
  ds_read_b64_tr_b16 v[194:195], v2 offset:8448
  ds_read_b64_tr_b16 v[196:197], v2 offset:8224
  ds_read_b64_tr_b16 v[198:199], v2 offset:8480
  s_waitcnt vmcnt(12)
  ds_read_b64_tr_b16 v[200:201], v2 offset:9216
  ds_read_b64_tr_b16 v[202:203], v2 offset:9472
  ds_read_b64_tr_b16 v[204:205], v2 offset:9248
  ds_read_b64_tr_b16 v[206:207], v2 offset:9504
  s_waitcnt vmcnt(10)
  ds_read_b64_tr_b16 v[208:209], v2 offset:10240
  ds_read_b64_tr_b16 v[210:211], v2 offset:10496
  ds_read_b64_tr_b16 v[212:213], v2 offset:10272
  ds_read_b64_tr_b16 v[214:215], v2 offset:10528
  s_waitcnt vmcnt(8)
  ds_read_b64_tr_b16 v[216:217], v2 offset:11264
  ds_read_b64_tr_b16 v[218:219], v2 offset:11520
  ds_read_b64_tr_b16 v[220:221], v2 offset:11296
  ds_read_b64_tr_b16 v[222:223], v2 offset:11552
  s_waitcnt vmcnt(6)
  ds_read_b64_tr_b16 v[224:225], v2 offset:12288
  ds_read_b64_tr_b16 v[226:227], v2 offset:12544
  ds_read_b64_tr_b16 v[228:229], v2 offset:12320
  ds_read_b64_tr_b16 v[230:231], v2 offset:12576
  s_waitcnt vmcnt(4)
  ds_read_b64_tr_b16 v[232:233], v2 offset:13312
  ds_read_b64_tr_b16 v[234:235], v2 offset:13568
  ds_read_b64_tr_b16 v[236:237], v2 offset:13344
  ds_read_b64_tr_b16 v[238:239], v2 offset:13600
  s_waitcnt vmcnt(2)
  ds_read_b64_tr_b16 v[240:241], v2 offset:14336
  ds_read_b64_tr_b16 v[242:243], v2 offset:14592
  ds_read_b64_tr_b16 v[244:245], v2 offset:14368
  ds_read_b64_tr_b16 v[246:247], v2 offset:14624
  s_waitcnt vmcnt(0)
  ds_read_b64_tr_b16 v[248:249], v2 offset:0
  ds_read_b64_tr_b16 v[250:251], v2 offset:256
  ds_read_b64_tr_b16 v[252:253], v2 offset:32
  ds_read_b64_tr_b16 v[254:255], v2 offset:288
  v_add_u32 v6, 131072, v1
  s_mov_b32 s28, 0
  s_mov_b32 s30, 0
  s_waitcnt vmcnt(0) lgkmcnt(0)
P1_top:
  s_waitcnt vmcnt(6)
  s_barrier
  s_add_u32 s29, s23, 6
  s_min_u32 s29, s29, 63
  ds_read_b128 v[16:19], v6 offset:0
  ds_read_b128 v[20:23], v6 offset:1024
  ds_read_b128 v[24:27], v6 offset:2048
  ds_read_b128 v[28:31], v6 offset:3072
  ds_read_b128 v[32:35], v6 offset:4096
  ds_read_b128 v[36:39], v6 offset:5120
  s_lshl_b32 s24, s29, 15
  s_lshl_b32 s25, s20, 13
  s_add_u32 s25, s25, s28
  s_add_u32 m0, s25, 0
  s_add_u32 s31, s24, 0
  buffer_load_dwordx4 v5, s[36:39], s31 offen lds
  s_add_u32 m0, s25, 1024
  s_add_u32 s31, s24, 16384
  buffer_load_dwordx4 v5, s[36:39], s31 offen lds
  s_add_u32 m0, s25, 2048
  s_add_u32 s31, s24, 64
  buffer_load_dwordx4 v5, s[36:39], s31 offen lds
  s_add_u32 m0, s25, 3072
  s_add_u32 s31, s24, 16448
  buffer_load_dwordx4 v5, s[36:39], s31 offen lds
  s_add_u32 m0, s25, 4096
  s_add_u32 s31, s24, 128
  buffer_load_dwordx4 v5, s[36:39], s31 offen lds
  s_add_u32 m0, s25, 5120
  s_add_u32 s31, s24, 16512
  buffer_load_dwordx4 v5, s[36:39], s31 offen lds
  s_add_u32 m0, s25, 6144
  s_add_u32 s31, s24, 192
  buffer_load_dwordx4 v5, s[36:39], s31 offen lds
  s_add_u32 m0, s25, 7168
  s_add_u32 s31, s24, 16576
  buffer_load_dwordx4 v5, s[36:39], s31 offen lds
  s_waitcnt lgkmcnt(5)
  v_mfma_f32_16x16x32_bf16 v[48:51], a[0:3], v[16:19], 0
  ds_read_b128 v[40:43], v6 offset:6144
  v_mfma_f32_16x16x32_bf16 v[52:55], a[4:7], v[16:19], 0
  ds_read_b128 v[44:47], v6 offset:7168
  v_mfma_f32_16x16x32_bf16 v[80:83], v[128:131], v[16:19], 0
  v_mfma_f32_16x16x32_bf16 v[84:87], v[132:135], v[16:19], 0
  v_mfma_f32_16x16x32_bf16 v[64:67], v[16:19], a[128:131], 0
  v_mfma_f32_16x16x32_bf16 v[68:71], v[16:19], a[132:135], 0
  s_waitcnt lgkmcnt(6)
  v_mfma_f32_16x16x32_bf16 v[56:59], a[0:3], v[20:23], 0
  v_mfma_f32_16x16x32_bf16 v[60:63], a[4:7], v[20:23], 0
  v_mfma_f32_16x16x32_bf16 v[88:91], v[128:131], v[20:23], 0
  v_mfma_f32_16x16x32_bf16 v[92:95], v[132:135], v[20:23], 0
  v_mfma_f32_16x16x32_bf16 v[72:75], v[20:23], a[128:131], 0
  v_mfma_f32_16x16x32_bf16 v[76:79], v[20:23], a[132:135], 0
  s_waitcnt lgkmcnt(5)
  v_mfma_f32_16x16x32_bf16 v[48:51], a[8:11], v[24:27], v[48:51]
  ds_read_b128 v[16:19], v6 offset:8192
  v_mfma_f32_16x16x32_bf16 v[52:55], a[12:15], v[24:27], v[52:55]
  ds_read_b128 v[20:23], v6 offset:9216
  v_mfma_f32_16x16x32_bf16 v[80:83], v[136:139], v[24:27], v[80:83]
  v_mfma_f32_16x16x32_bf16 v[84:87], v[140:143], v[24:27], v[84:87]
  v_mfma_f32_16x16x32_bf16 v[64:67], v[24:27], a[136:139], v[64:67]
  v_mfma_f32_16x16x32_bf16 v[68:71], v[24:27], a[140:143], v[68:71]
  s_waitcnt lgkmcnt(6)
  v_mfma_f32_16x16x32_bf16 v[56:59], a[8:11], v[28:31], v[56:59]
  v_mfma_f32_16x16x32_bf16 v[60:63], a[12:15], v[28:31], v[60:63]
  v_mfma_f32_16x16x32_bf16 v[88:91], v[136:139], v[28:31], v[88:91]
  v_mfma_f32_16x16x32_bf16 v[92:95], v[140:143], v[28:31], v[92:95]
  v_mfma_f32_16x16x32_bf16 v[72:75], v[28:31], a[136:139], v[72:75]
  v_mfma_f32_16x16x32_bf16 v[76:79], v[28:31], a[140:143], v[76:79]
  s_waitcnt lgkmcnt(5)
  v_mfma_f32_16x16x32_bf16 v[48:51], a[16:19], v[32:35], v[48:51]
  ds_read_b128 v[24:27], v6 offset:10240
  v_mfma_f32_16x16x32_bf16 v[52:55], a[20:23], v[32:35], v[52:55]
  ds_read_b128 v[28:31], v6 offset:11264
  v_mfma_f32_16x16x32_bf16 v[80:83], v[144:147], v[32:35], v[80:83]
  v_mfma_f32_16x16x32_bf16 v[84:87], v[148:151], v[32:35], v[84:87]
  v_mfma_f32_16x16x32_bf16 v[64:67], v[32:35], a[144:147], v[64:67]
  v_mfma_f32_16x16x32_bf16 v[68:71], v[32:35], a[148:151], v[68:71]
  s_waitcnt lgkmcnt(6)
  v_mfma_f32_16x16x32_bf16 v[56:59], a[16:19], v[36:39], v[56:59]
  v_mfma_f32_16x16x32_bf16 v[60:63], a[20:23], v[36:39], v[60:63]
  v_mfma_f32_16x16x32_bf16 v[88:91], v[144:147], v[36:39], v[88:91]
  v_mfma_f32_16x16x32_bf16 v[92:95], v[148:151], v[36:39], v[92:95]
  v_mfma_f32_16x16x32_bf16 v[72:75], v[36:39], a[144:147], v[72:75]
  v_mfma_f32_16x16x32_bf16 v[76:79], v[36:39], a[148:151], v[76:79]
  s_waitcnt lgkmcnt(5)
  v_mfma_f32_16x16x32_bf16 v[48:51], a[24:27], v[40:43], v[48:51]
  ds_read_b128 v[32:35], v6 offset:12288
  v_mfma_f32_16x16x32_bf16 v[52:55], a[28:31], v[40:43], v[52:55]
  ds_read_b128 v[36:39], v6 offset:13312
  v_mfma_f32_16x16x32_bf16 v[80:83], v[152:155], v[40:43], v[80:83]
  v_mfma_f32_16x16x32_bf16 v[84:87], v[156:159], v[40:43], v[84:87]
  v_mfma_f32_16x16x32_bf16 v[64:67], v[40:43], a[152:155], v[64:67]
  v_mfma_f32_16x16x32_bf16 v[68:71], v[40:43], a[156:159], v[68:71]
  s_waitcnt lgkmcnt(6)
  v_mfma_f32_16x16x32_bf16 v[56:59], a[24:27], v[44:47], v[56:59]
  v_mfma_f32_16x16x32_bf16 v[60:63], a[28:31], v[44:47], v[60:63]
  v_mfma_f32_16x16x32_bf16 v[88:91], v[152:155], v[44:47], v[88:91]
  v_mfma_f32_16x16x32_bf16 v[92:95], v[156:159], v[44:47], v[92:95]
  v_mfma_f32_16x16x32_bf16 v[72:75], v[44:47], a[152:155], v[72:75]
  v_mfma_f32_16x16x32_bf16 v[76:79], v[44:47], a[156:159], v[76:79]
  s_waitcnt lgkmcnt(5)
  v_mfma_f32_16x16x32_bf16 v[48:51], a[32:35], v[16:19], v[48:51]
  ds_read_b128 v[40:43], v6 offset:14336
  v_mfma_f32_16x16x32_bf16 v[52:55], a[36:39], v[16:19], v[52:55]
  ds_read_b128 v[44:47], v6 offset:15360
  v_mfma_f32_16x16x32_bf16 v[80:83], v[160:163], v[16:19], v[80:83]
  v_mfma_f32_16x16x32_bf16 v[84:87], v[164:167], v[16:19], v[84:87]
  v_mfma_f32_16x16x32_bf16 v[64:67], v[16:19], a[160:163], v[64:67]
  v_mfma_f32_16x16x32_bf16 v[68:71], v[16:19], a[164:167], v[68:71]
  s_waitcnt lgkmcnt(6)
  v_mfma_f32_16x16x32_bf16 v[56:59], a[32:35], v[20:23], v[56:59]
  v_mfma_f32_16x16x32_bf16 v[60:63], a[36:39], v[20:23], v[60:63]
  v_mfma_f32_16x16x32_bf16 v[88:91], v[160:163], v[20:23], v[88:91]
  v_mfma_f32_16x16x32_bf16 v[92:95], v[164:167], v[20:23], v[92:95]
  v_mfma_f32_16x16x32_bf16 v[72:75], v[20:23], a[160:163], v[72:75]
  v_mfma_f32_16x16x32_bf16 v[76:79], v[20:23], a[164:167], v[76:79]
  s_waitcnt lgkmcnt(5)
  v_mfma_f32_16x16x32_bf16 v[48:51], a[40:43], v[24:27], v[48:51]
  ds_read_b128 v[16:19], v6 offset:16384
  v_mfma_f32_16x16x32_bf16 v[52:55], a[44:47], v[24:27], v[52:55]
  ds_read_b128 v[20:23], v6 offset:17408
  v_mfma_f32_16x16x32_bf16 v[80:83], v[168:171], v[24:27], v[80:83]
  v_mfma_f32_16x16x32_bf16 v[84:87], v[172:175], v[24:27], v[84:87]
  v_mfma_f32_16x16x32_bf16 v[64:67], v[24:27], a[168:171], v[64:67]
  v_mfma_f32_16x16x32_bf16 v[68:71], v[24:27], a[172:175], v[68:71]
  s_waitcnt lgkmcnt(6)
  v_mfma_f32_16x16x32_bf16 v[56:59], a[40:43], v[28:31], v[56:59]
  v_mfma_f32_16x16x32_bf16 v[60:63], a[44:47], v[28:31], v[60:63]
  v_mfma_f32_16x16x32_bf16 v[88:91], v[168:171], v[28:31], v[88:91]
  v_mfma_f32_16x16x32_bf16 v[92:95], v[172:175], v[28:31], v[92:95]
  v_mfma_f32_16x16x32_bf16 v[72:75], v[28:31], a[168:171], v[72:75]
  v_mfma_f32_16x16x32_bf16 v[76:79], v[28:31], a[172:175], v[76:79]
  s_waitcnt vmcnt(8)
  s_cmp_eq_u32 s30, 0
  s_cbranch_scc1 P1_nosig
  v_mov_b32 v9, s30
  s_mov_b64 exec, 1
  buffer_store_dword v9, v7, s[8:11], s27 offen sc1
  s_mov_b64 exec, -1
P1_nosig:
  s_waitcnt lgkmcnt(5)
  v_mfma_f32_16x16x32_bf16 v[48:51], a[48:51], v[32:35], v[48:51]
  ds_read_b128 v[24:27], v6 offset:18432
  v_mfma_f32_16x16x32_bf16 v[52:55], a[52:55], v[32:35], v[52:55]
  ds_read_b128 v[28:31], v6 offset:19456
  v_mfma_f32_16x16x32_bf16 v[80:83], v[176:179], v[32:35], v[80:83]
  v_mfma_f32_16x16x32_bf16 v[84:87], v[180:183], v[32:35], v[84:87]
  v_mfma_f32_16x16x32_bf16 v[64:67], v[32:35], a[176:179], v[64:67]
  v_mfma_f32_16x16x32_bf16 v[68:71], v[32:35], a[180:183], v[68:71]
  s_waitcnt lgkmcnt(6)
  v_mfma_f32_16x16x32_bf16 v[56:59], a[48:51], v[36:39], v[56:59]
  v_mfma_f32_16x16x32_bf16 v[60:63], a[52:55], v[36:39], v[60:63]
  v_mfma_f32_16x16x32_bf16 v[88:91], v[176:179], v[36:39], v[88:91]
  v_mfma_f32_16x16x32_bf16 v[92:95], v[180:183], v[36:39], v[92:95]
  v_mfma_f32_16x16x32_bf16 v[72:75], v[36:39], a[176:179], v[72:75]
  v_mfma_f32_16x16x32_bf16 v[76:79], v[36:39], a[180:183], v[76:79]
  s_waitcnt lgkmcnt(5)
  v_mfma_f32_16x16x32_bf16 v[48:51], a[56:59], v[40:43], v[48:51]
  ds_read_b128 v[32:35], v6 offset:20480
  v_mfma_f32_16x16x32_bf16 v[52:55], a[60:63], v[40:43], v[52:55]
  ds_read_b128 v[36:39], v6 offset:21504
  v_mfma_f32_16x16x32_bf16 v[80:83], v[184:187], v[40:43], v[80:83]
  v_mfma_f32_16x16x32_bf16 v[84:87], v[188:191], v[40:43], v[84:87]
  v_mfma_f32_16x16x32_bf16 v[64:67], v[40:43], a[184:187], v[64:67]
  v_mfma_f32_16x16x32_bf16 v[68:71], v[40:43], a[188:191], v[68:71]
  s_waitcnt lgkmcnt(6)
  v_mfma_f32_16x16x32_bf16 v[56:59], a[56:59], v[44:47], v[56:59]
  v_mfma_f32_16x16x32_bf16 v[60:63], a[60:63], v[44:47], v[60:63]
  v_mfma_f32_16x16x32_bf16 v[88:91], v[184:187], v[44:47], v[88:91]
  v_mfma_f32_16x16x32_bf16 v[92:95], v[188:191], v[44:47], v[92:95]
  v_mfma_f32_16x16x32_bf16 v[72:75], v[44:47], a[184:187], v[72:75]
  v_mfma_f32_16x16x32_bf16 v[76:79], v[44:47], a[188:191], v[76:79]
  s_waitcnt lgkmcnt(5)
  v_mfma_f32_16x16x32_bf16 v[48:51], a[64:67], v[16:19], v[48:51]
  ds_read_b128 v[40:43], v6 offset:22528
  v_mfma_f32_16x16x32_bf16 v[52:55], a[68:71], v[16:19], v[52:55]
  ds_read_b128 v[44:47], v6 offset:23552
  v_mfma_f32_16x16x32_bf16 v[80:83], v[192:195], v[16:19], v[80:83]
  v_mfma_f32_16x16x32_bf16 v[84:87], v[196:199], v[16:19], v[84:87]
  v_mfma_f32_16x16x32_bf16 v[64:67], v[16:19], a[192:195], v[64:67]
  v_mfma_f32_16x16x32_bf16 v[68:71], v[16:19], a[196:199], v[68:71]
  s_waitcnt lgkmcnt(6)
  v_mfma_f32_16x16x32_bf16 v[56:59], a[64:67], v[20:23], v[56:59]
  v_mfma_f32_16x16x32_bf16 v[60:63], a[68:71], v[20:23], v[60:63]
  v_mfma_f32_16x16x32_bf16 v[88:91], v[192:195], v[20:23], v[88:91]
  v_mfma_f32_16x16x32_bf16 v[92:95], v[196:199], v[20:23], v[92:95]
  v_mfma_f32_16x16x32_bf16 v[72:75], v[20:23], a[192:195], v[72:75]
  v_mfma_f32_16x16x32_bf16 v[76:79], v[20:23], a[196:199], v[76:79]
  s_waitcnt lgkmcnt(5)
  v_mfma_f32_16x16x32_bf16 v[48:51], a[72:75], v[24:27], v[48:51]
  ds_read_b128 v[16:19], v6 offset:24576
  v_mfma_f32_16x16x32_bf16 v[52:55], a[76:79], v[24:27], v[52:55]
  ds_read_b128 v[20:23], v6 offset:25600
  v_mfma_f32_16x16x32_bf16 v[80:83], v[200:203], v[24:27], v[80:83]
  v_mfma_f32_16x16x32_bf16 v[84:87], v[204:207], v[24:27], v[84:87]
  v_mfma_f32_16x16x32_bf16 v[64:67], v[24:27], a[200:203], v[64:67]
  v_mfma_f32_16x16x32_bf16 v[68:71], v[24:27], a[204:207], v[68:71]
  s_waitcnt lgkmcnt(6)
  v_mfma_f32_16x16x32_bf16 v[56:59], a[72:75], v[28:31], v[56:59]
  v_mfma_f32_16x16x32_bf16 v[60:63], a[76:79], v[28:31], v[60:63]
  v_mfma_f32_16x16x32_bf16 v[88:91], v[200:203], v[28:31], v[88:91]
  v_mfma_f32_16x16x32_bf16 v[92:95], v[204:207], v[28:31], v[92:95]
  v_mfma_f32_16x16x32_bf16 v[72:75], v[28:31], a[200:203], v[72:75]
  v_mfma_f32_16x16x32_bf16 v[76:79], v[28:31], a[204:207], v[76:79]
  s_waitcnt lgkmcnt(5)
  v_mfma_f32_16x16x32_bf16 v[48:51], a[80:83], v[32:35], v[48:51]
  ds_read_b128 v[24:27], v6 offset:26624
  v_mfma_f32_16x16x32_bf16 v[52:55], a[84:87], v[32:35], v[52:55]
  ds_read_b128 v[28:31], v6 offset:27648
  v_mfma_f32_16x16x32_bf16 v[80:83], v[208:211], v[32:35], v[80:83]
  v_mfma_f32_16x16x32_bf16 v[84:87], v[212:215], v[32:35], v[84:87]
  v_mfma_f32_16x16x32_bf16 v[64:67], v[32:35], a[208:211], v[64:67]
  v_mfma_f32_16x16x32_bf16 v[68:71], v[32:35], a[212:215], v[68:71]
  s_waitcnt lgkmcnt(6)
  v_mfma_f32_16x16x32_bf16 v[56:59], a[80:83], v[36:39], v[56:59]
  v_mfma_f32_16x16x32_bf16 v[60:63], a[84:87], v[36:39], v[60:63]
  v_mfma_f32_16x16x32_bf16 v[88:91], v[208:211], v[36:39], v[88:91]
  v_mfma_f32_16x16x32_bf16 v[92:95], v[212:215], v[36:39], v[92:95]
  v_mfma_f32_16x16x32_bf16 v[72:75], v[36:39], a[208:211], v[72:75]
  v_mfma_f32_16x16x32_bf16 v[76:79], v[36:39], a[212:215], v[76:79]
  s_waitcnt lgkmcnt(5)
  v_mfma_f32_16x16x32_bf16 v[48:51], a[88:91], v[40:43], v[48:51]
  ds_read_b128 v[32:35], v6 offset:28672
  v_mfma_f32_16x16x32_bf16 v[52:55], a[92:95], v[40:43], v[52:55]
  ds_read_b128 v[36:39], v6 offset:29696
  v_mfma_f32_16x16x32_bf16 v[80:83], v[216:219], v[40:43], v[80:83]
  v_mfma_f32_16x16x32_bf16 v[84:87], v[220:223], v[40:43], v[84:87]
  v_mfma_f32_16x16x32_bf16 v[64:67], v[40:43], a[216:219], v[64:67]
  v_mfma_f32_16x16x32_bf16 v[68:71], v[40:43], a[220:223], v[68:71]
  s_waitcnt lgkmcnt(6)
  v_mfma_f32_16x16x32_bf16 v[56:59], a[88:91], v[44:47], v[56:59]
  v_mfma_f32_16x16x32_bf16 v[60:63], a[92:95], v[44:47], v[60:63]
  v_mfma_f32_16x16x32_bf16 v[88:91], v[216:219], v[44:47], v[88:91]
  v_mfma_f32_16x16x32_bf16 v[92:95], v[220:223], v[44:47], v[92:95]
  v_mfma_f32_16x16x32_bf16 v[72:75], v[44:47], a[216:219], v[72:75]
  v_mfma_f32_16x16x32_bf16 v[76:79], v[44:47], a[220:223], v[76:79]
  s_waitcnt lgkmcnt(5)
  v_mfma_f32_16x16x32_bf16 v[48:51], a[96:99], v[16:19], v[48:51]
  ds_read_b128 v[40:43], v6 offset:30720
  v_mfma_f32_16x16x32_bf16 v[52:55], a[100:103], v[16:19], v[52:55]
  ds_read_b128 v[44:47], v6 offset:31744
  v_mfma_f32_16x16x32_bf16 v[80:83], v[224:227], v[16:19], v[80:83]
  v_mfma_f32_16x16x32_bf16 v[84:87], v[228:231], v[16:19], v[84:87]
  v_mfma_f32_16x16x32_bf16 v[64:67], v[16:19], a[224:227], v[64:67]
  v_mfma_f32_16x16x32_bf16 v[68:71], v[16:19], a[228:231], v[68:71]
  s_waitcnt lgkmcnt(6)
  v_mfma_f32_16x16x32_bf16 v[56:59], a[96:99], v[20:23], v[56:59]
  v_mfma_f32_16x16x32_bf16 v[60:63], a[100:103], v[20:23], v[60:63]
  v_mfma_f32_16x16x32_bf16 v[88:91], v[224:227], v[20:23], v[88:91]
  v_mfma_f32_16x16x32_bf16 v[92:95], v[228:231], v[20:23], v[92:95]
  v_mfma_f32_16x16x32_bf16 v[72:75], v[20:23], a[224:227], v[72:75]
  v_mfma_f32_16x16x32_bf16 v[76:79], v[20:23], a[228:231], v[76:79]
  s_waitcnt lgkmcnt(5)
  v_mfma_f32_16x16x32_bf16 v[48:51], a[104:107], v[24:27], v[48:51]
  v_mfma_f32_16x16x32_bf16 v[52:55], a[108:111], v[24:27], v[52:55]
  v_mfma_f32_16x16x32_bf16 v[80:83], v[232:235], v[24:27], v[80:83]
  v_mfma_f32_16x16x32_bf16 v[84:87], v[236:239], v[24:27], v[84:87]
  v_mfma_f32_16x16x32_bf16 v[64:67], v[24:27], a[232:235], v[64:67]
  v_mfma_f32_16x16x32_bf16 v[68:71], v[24:27], a[236:239], v[68:71]
  s_waitcnt lgkmcnt(4)
  v_mfma_f32_16x16x32_bf16 v[56:59], a[104:107], v[28:31], v[56:59]
  v_mfma_f32_16x16x32_bf16 v[60:63], a[108:111], v[28:31], v[60:63]
  v_mfma_f32_16x16x32_bf16 v[88:91], v[232:235], v[28:31], v[88:91]
  v_mfma_f32_16x16x32_bf16 v[92:95], v[236:239], v[28:31], v[92:95]
  v_mfma_f32_16x16x32_bf16 v[72:75], v[28:31], a[232:235], v[72:75]
  v_mfma_f32_16x16x32_bf16 v[76:79], v[28:31], a[236:239], v[76:79]
  s_waitcnt lgkmcnt(3)
  v_mfma_f32_16x16x32_bf16 v[48:51], a[112:115], v[32:35], v[48:51]
  v_mfma_f32_16x16x32_bf16 v[52:55], a[116:119], v[32:35], v[52:55]
  v_mfma_f32_16x16x32_bf16 v[80:83], v[240:243], v[32:35], v[80:83]
  v_mfma_f32_16x16x32_bf16 v[84:87], v[244:247], v[32:35], v[84:87]
  v_mfma_f32_16x16x32_bf16 v[64:67], v[32:35], a[240:243], v[64:67]
  v_mfma_f32_16x16x32_bf16 v[68:71], v[32:35], a[244:247], v[68:71]
  s_waitcnt lgkmcnt(2)
  v_mfma_f32_16x16x32_bf16 v[56:59], a[112:115], v[36:39], v[56:59]
  v_mfma_f32_16x16x32_bf16 v[60:63], a[116:119], v[36:39], v[60:63]
  v_mfma_f32_16x16x32_bf16 v[88:91], v[240:243], v[36:39], v[88:91]
  v_mfma_f32_16x16x32_bf16 v[92:95], v[244:247], v[36:39], v[92:95]
  v_mfma_f32_16x16x32_bf16 v[72:75], v[36:39], a[240:243], v[72:75]
  v_mfma_f32_16x16x32_bf16 v[76:79], v[36:39], a[244:247], v[76:79]
  s_waitcnt lgkmcnt(1)
  v_mfma_f32_16x16x32_bf16 v[48:51], a[120:123], v[40:43], v[48:51]
  v_mfma_f32_16x16x32_bf16 v[52:55], a[124:127], v[40:43], v[52:55]
  v_mfma_f32_16x16x32_bf16 v[80:83], v[248:251], v[40:43], v[80:83]
  v_mfma_f32_16x16x32_bf16 v[84:87], v[252:255], v[40:43], v[84:87]
  v_mfma_f32_16x16x32_bf16 v[64:67], v[40:43], a[248:251], v[64:67]
  v_mfma_f32_16x16x32_bf16 v[68:71], v[40:43], a[252:255], v[68:71]
  s_waitcnt lgkmcnt(0)
  v_mfma_f32_16x16x32_bf16 v[56:59], a[120:123], v[44:47], v[56:59]
  v_mfma_f32_16x16x32_bf16 v[60:63], a[124:127], v[44:47], v[60:63]
  v_mfma_f32_16x16x32_bf16 v[88:91], v[248:251], v[44:47], v[88:91]
  v_mfma_f32_16x16x32_bf16 v[92:95], v[252:255], v[44:47], v[92:95]
  v_mfma_f32_16x16x32_bf16 v[72:75], v[44:47], a[248:251], v[72:75]
  v_mfma_f32_16x16x32_bf16 v[76:79], v[44:47], a[252:255], v[76:79]
  s_lshl_b32 s24, s23, 5
  s_add_u32 s24, s24, s56
  s_lshl_b32 s24, s24, 2
  s_add_u32 s24, s24, s20
  s_lshl_b32 s25, s24, 11
  s_add_u32 s25, s25, 67108864
  s_lshl_b32 s24, s24, 12
  v_cvt_pk_bf16_f32 v96, v48, v49
  v_cvt_pk_bf16_f32 v97, v50, v51
  v_cvt_pk_bf16_f32 v98, v52, v53
  v_cvt_pk_bf16_f32 v99, v54, v55
  buffer_store_dwordx4 v[96:99], v1, s[8:11], s24 offen offset:0 sc1
  v_cvt_pk_bf16_f32 v100, v56, v57
  v_cvt_pk_bf16_f32 v101, v58, v59
  v_cvt_pk_bf16_f32 v102, v60, v61
  v_cvt_pk_bf16_f32 v103, v62, v63
  buffer_store_dwordx4 v[100:103], v1, s[8:11], s24 offen offset:1024 sc1
  v_cvt_pk_bf16_f32 v104, v80, v81
  v_cvt_pk_bf16_f32 v105, v82, v83
  v_cvt_pk_bf16_f32 v106, v84, v85
  v_cvt_pk_bf16_f32 v107, v86, v87
  buffer_store_dwordx4 v[104:107], v1, s[8:11], s25 offen offset:0 sc1
  v_cvt_pk_bf16_f32 v108, v88, v89
  v_cvt_pk_bf16_f32 v109, v90, v91
  v_cvt_pk_bf16_f32 v110, v92, v93
  v_cvt_pk_bf16_f32 v111, v94, v95
  buffer_store_dwordx4 v[108:111], v1, s[8:11], s25 offen offset:1024 sc1
  v_cvt_pk_bf16_f32 v112, v64, v65
  v_cvt_pk_bf16_f32 v113, v66, v67
  v_cvt_pk_bf16_f32 v114, v72, v73
  v_cvt_pk_bf16_f32 v115, v74, v75
  buffer_store_dwordx4 v[112:115], v1, s[8:11], s24 offen offset:2048 sc1
  v_cvt_pk_bf16_f32 v116, v68, v69
  v_cvt_pk_bf16_f32 v117, v70, v71
  v_cvt_pk_bf16_f32 v118, v76, v77
  v_cvt_pk_bf16_f32 v119, v78, v79
  buffer_store_dwordx4 v[116:119], v1, s[8:11], s24 offen offset:3072 sc1
  v_xor_b32 v6, 131072, v6
  s_xor_b32 s28, s28, 131072
  s_add_u32 s30, s30, 1
  s_add_u32 s23, s23, 6
  s_cmp_lt_u32 s23, 64
  s_cbranch_scc1 P1_top
  s_waitcnt vmcnt(0)
  v_mov_b32 v9, s30
  s_mov_b64 exec, 1
  buffer_store_dword v9, v7, s[8:11], s27 offen sc1
  s_mov_b64 exec, -1
  s_barrier
P1_end:
  s_cmp_ge_u32 s21, 220
  s_cbranch_scc1 P2_end
  s_mul_i32 s26, s21, 3277
  s_lshr_b32 s26, s26, 16
  s_mul_i32 s24, s26, 20
  s_sub_u32 s23, s21, s24
  s_lshl_b32 s26, s26, 2
  s_add_u32 s26, s26, s20
  s_min_u32 s26, s26, 42
  s_mov_b32 s28, 131072
  s_lshl_b32 s24, s23, 15
  s_lshl_b32 s25, s20, 13
  s_add_u32 s25, s25, s28
  s_add_u32 m0, s25, 0
  s_add_u32 s31, s24, 0
  buffer_load_dwordx4 v5, s[36:39], s31 offen lds
  s_add_u32 m0, s25, 1024
  s_add_u32 s31, s24, 16384
  buffer_load_dwordx4 v5, s[36:39], s31 offen lds
  s_add_u32 m0, s25, 2048
  s_add_u32 s31, s24, 64
  buffer_load_dwordx4 v5, s[36:39], s31 offen lds
  s_add_u32 m0, s25, 3072
  s_add_u32 s31, s24, 16448
  buffer_load_dwordx4 v5, s[36:39], s31 offen lds
  s_add_u32 m0, s25, 4096
  s_add_u32 s31, s24, 128
  buffer_load_dwordx4 v5, s[36:39], s31 offen lds
  s_add_u32 m0, s25, 5120
  s_add_u32 s31, s24, 16512
  buffer_load_dwordx4 v5, s[36:39], s31 offen lds
  s_add_u32 m0, s25, 6144
  s_add_u32 s31, s24, 192
  buffer_load_dwordx4 v5, s[36:39], s31 offen lds
  s_add_u32 m0, s25, 7168
  s_add_u32 s31, s24, 16576
  buffer_load_dwordx4 v5, s[36:39], s31 offen lds
  s_lshl_b32 s24, s26, 6
  v_bfe_u32 v9, v0, 2, 3
  v_lshrrev_b32 v11, 5, v0
  v_lshl_add_u32 v9, v11, 4, v9
  v_mul_u32_u24 v9, 2752, v9
  v_and_b32 v11, 3, v0
  v_lshl_add_u32 v9, v11, 4, v9
  v_add_u32 v4, s24, v9
  s_mov_b32 s32, s48
  s_mov_b32 s33, s49
  s_mov_b32 s34, 1409024
  s_add_u32 m0, s22, 0
  s_mov_b32 s31, 0
  buffer_load_dwordx4 v4, s[32:35], s31 offen lds
  s_add_u32 m0, s22, 16416
  s_mov_b32 s31, 22016
  buffer_load_dwordx4 v4, s[32:35], s31 offen lds
  s_add_u32 m0, s22, 1024
  s_mov_b32 s31, 88064
  buffer_load_dwordx4 v4, s[32:35], s31 offen lds
  s_add_u32 m0, s22, 17440
  s_mov_b32 s31, 110080
  buffer_load_dwordx4 v4, s[32:35], s31 offen lds
  s_add_u32 m0, s22, 2048
  s_mov_b32 s31, 176128
  buffer_load_dwordx4 v4, s[32:35], s31 offen lds
  s_add_u32 m0, s22, 18464
  s_mov_b32 s31, 198144
  buffer_load_dwordx4 v4, s[32:35], s31 offen lds
  s_add_u32 m0, s22, 3072
  s_mov_b32 s31, 264192
  buffer_load_dwordx4 v4, s[32:35], s31 offen lds
  s_add_u32 m0, s22, 19488
  s_mov_b32 s31, 286208
  buffer_load_dwordx4 v4, s[32:35], s31 offen lds
  s_add_u32 m0, s22, 4096
  s_mov_b32 s31, 352256
  buffer_load_dwordx4 v4, s[32:35], s31 offen lds
  s_add_u32 m0, s22, 20512
  s_mov_b32 s31, 374272
  buffer_load_dwordx4 v4, s[32:35], s31 offen lds
  s_add_u32 m0, s22, 5120
  s_mov_b32 s31, 440320
  buffer_load_dwordx4 v4, s[32:35], s31 offen lds
  s_add_u32 m0, s22, 21536
  s_mov_b32 s31, 462336
  buffer_load_dwordx4 v4, s[32:35], s31 offen lds
  s_add_u32 m0, s22, 6144
  s_mov_b32 s31, 528384
  buffer_load_dwordx4 v4, s[32:35], s31 offen lds
  s_add_u32 m0, s22, 22560
  s_mov_b32 s31, 550400
  buffer_load_dwordx4 v4, s[32:35], s31 offen lds
  s_add_u32 m0, s22, 7168
  s_mov_b32 s31, 616448
  buffer_load_dwordx4 v4, s[32:35], s31 offen lds
  s_add_u32 m0, s22, 23584
  s_mov_b32 s31, 638464
  buffer_load_dwordx4 v4, s[32:35], s31 offen lds
  s_add_u32 m0, s22, 8192
  s_mov_b32 s31, 704512
  buffer_load_dwordx4 v4, s[32:35], s31 offen lds
  s_add_u32 m0, s22, 24608
  s_mov_b32 s31, 726528
  buffer_load_dwordx4 v4, s[32:35], s31 offen lds
  s_add_u32 m0, s22, 9216
  s_mov_b32 s31, 792576
  buffer_load_dwordx4 v4, s[32:35], s31 offen lds
  s_add_u32 m0, s22, 25632
  s_mov_b32 s31, 814592
  buffer_load_dwordx4 v4, s[32:35], s31 offen lds
  s_add_u32 m0, s22, 10240
  s_mov_b32 s31, 880640
  buffer_load_dwordx4 v4, s[32:35], s31 offen lds
  s_add_u32 m0, s22, 26656
  s_mov_b32 s31, 902656
  buffer_load_dwordx4 v4, s[32:35], s31 offen lds
  s_add_u32 m0, s22, 11264
  s_mov_b32 s31, 968704
  buffer_load_dwordx4 v4, s[32:35], s31 offen lds
  s_add_u32 m0, s22, 27680
  s_mov_b32 s31, 990720
  buffer_load_dwordx4 v4, s[32:35], s31 offen lds
  s_add_u32 m0, s22, 12288
  s_mov_b32 s31, 1056768
  buffer_load_dwordx4 v4, s[32:35], s31 offen lds
  s_add_u32 m0, s22, 28704
  s_mov_b32 s31, 1078784
  buffer_load_dwordx4 v4, s[32:35], s31 offen lds
  s_add_u32 m0, s22, 13312
  s_mov_b32 s31, 1144832
  buffer_load_dwordx4 v4, s[32:35], s31 offen lds
  s_add_u32 m0, s22, 29728
  s_mov_b32 s31, 1166848
  buffer_load_dwordx4 v4, s[32:35], s31 offen lds
  s_add_u32 m0, s22, 14336
  s_mov_b32 s31, 1232896
  buffer_load_dwordx4 v4, s[32:35], s31 offen lds
  s_add_u32 m0, s22, 30752
  s_mov_b32 s31, 1254912
  buffer_load_dwordx4 v4, s[32:35], s31 offen lds
  s_waitcnt vmcnt(28)
  ds_read_b64_tr_b16 a[0:1], v2 offset:0
  ds_read_b64_tr_b16 a[2:3], v2 offset:256
  ds_read_b64_tr_b16 a[4:5], v2 offset:32
  ds_read_b64_tr_b16 a[6:7], v2 offset:288
  s_waitcnt vmcnt(26)
  ds_read_b64_tr_b16 a[8:9], v2 offset:1024
  ds_read_b64_tr_b16 a[10:11], v2 offset:1280
  ds_read_b64_tr_b16 a[12:13], v2 offset:1056
  ds_read_b64_tr_b16 a[14:15], v2 offset:1312
  s_waitcnt lgkmcnt(4)
  s_add_u32 m0, s22, 0
  s_mov_b32 s31, 1320960
  buffer_load_dwordx4 v4, s[32:35], s31 offen lds
  s_add_u32 m0, s22, 16416
  s_mov_b32 s31, 1342976
  buffer_load_dwordx4 v4, s[32:35], s31 offen lds
  s_waitcnt vmcnt(26)
  ds_read_b64_tr_b16 a[16:17], v2 offset:2048
  ds_read_b64_tr_b16 a[18:19], v2 offset:2304
  ds_read_b64_tr_b16 a[20:21], v2 offset:2080
  ds_read_b64_tr_b16 a[22:23], v2 offset:2336
  s_waitcnt lgkmcnt(4)
  s_mov_b32 s32, s50
  s_mov_b32 s33, s51
  s_mov_b32 s34, 1409024
  s_add_u32 m0, s22, 1024
  s_mov_b32 s31, 0
  buffer_load_dwordx4 v4, s[32:35], s31 offen lds
  s_add_u32 m0, s22, 17440
  s_mov_b32 s31, 22016
  buffer_load_dwordx4 v4, s[32:35], s31 offen lds
  s_waitcnt vmcnt(26)
  ds_read_b64_tr_b16 a[24:25], v2 offset:3072
  ds_read_b64_tr_b16 a[26:27], v2 offset:3328
  ds_read_b64_tr_b16 a[28:29], v2 offset:3104
  ds_read_b64_tr_b16 a[30:31], v2 offset:3360
  s_waitcnt lgkmcnt(4)
  s_add_u32 m0, s22, 2048
  s_mov_b32 s31, 88064
  buffer_load_dwordx4 v4, s[32:35], s31 offen lds
  s_add_u32 m0, s22, 18464
  s_mov_b32 s31, 110080
  buffer_load_dwordx4 v4, s[32:35], s31 offen lds
  s_waitcnt vmcnt(26)
  ds_read_b64_tr_b16 a[32:33], v2 offset:4096
  ds_read_b64_tr_b16 a[34:35], v2 offset:4352
  ds_read_b64_tr_b16 a[36:37], v2 offset:4128
  ds_read_b64_tr_b16 a[38:39], v2 offset:4384
  s_waitcnt lgkmcnt(4)
  s_add_u32 m0, s22, 3072
  s_mov_b32 s31, 176128
  buffer_load_dwordx4 v4, s[32:35], s31 offen lds
  s_add_u32 m0, s22, 19488
  s_mov_b32 s31, 198144
  buffer_load_dwordx4 v4, s[32:35], s31 offen lds
  s_waitcnt vmcnt(26)
  ds_read_b64_tr_b16 a[40:41], v2 offset:5120
  ds_read_b64_tr_b16 a[42:43], v2 offset:5376
  ds_read_b64_tr_b16 a[44:45], v2 offset:5152
  ds_read_b64_tr_b16 a[46:47], v2 offset:5408
  s_waitcnt lgkmcnt(4)
  s_add_u32 m0, s22, 4096
  s_mov_b32 s31, 264192
  buffer_load_dwordx4 v4, s[32:35], s31 offen lds
  s_add_u32 m0, s22, 20512
  s_mov_b32 s31, 286208
  buffer_load_dwordx4 v4, s[32:35], s31 offen lds
  s_waitcnt vmcnt(26)
  ds_read_b64_tr_b16 a[48:49], v2 offset:6144
  ds_read_b64_tr_b16 a[50:51], v2 offset:6400
  ds_read_b64_tr_b16 a[52:53], v2 offset:6176
  ds_read_b64_tr_b16 a[54:55], v2 offset:6432
  s_waitcnt lgkmcnt(4)
  s_add_u32 m0, s22, 5120
  s_mov_b32 s31, 352256
  buffer_load_dwordx4 v4, s[32:35], s31 offen lds
  s_add_u32 m0, s22, 21536
  s_mov_b32 s31, 374272
  buffer_load_dwordx4 v4, s[32:35], s31 offen lds
  s_waitcnt vmcnt(26)
  ds_read_b64_tr_b16 a[56:57], v2 offset:7168
  ds_read_b64_tr_b16 a[58:59], v2 offset:7424
  ds_read_b64_tr_b16 a[60:61], v2 offset:7200
  ds_read_b64_tr_b16 a[62:63], v2 offset:7456
  s_waitcnt lgkmcnt(4)
  s_add_u32 m0, s22, 6144
  s_mov_b32 s31, 440320
  buffer_load_dwordx4 v4, s[32:35], s31 offen lds
  s_add_u32 m0, s22, 22560
  s_mov_b32 s31, 462336
  buffer_load_dwordx4 v4, s[32:35], s31 offen lds
  s_waitcnt vmcnt(26)
  ds_read_b64_tr_b16 a[64:65], v2 offset:8192
  ds_read_b64_tr_b16 a[66:67], v2 offset:8448
  ds_read_b64_tr_b16 a[68:69], v2 offset:8224
  ds_read_b64_tr_b16 a[70:71], v2 offset:8480
  s_waitcnt lgkmcnt(4)
  s_add_u32 m0, s22, 7168
  s_mov_b32 s31, 528384
  buffer_load_dwordx4 v4, s[32:35], s31 offen lds
  s_add_u32 m0, s22, 23584
  s_mov_b32 s31, 550400
  buffer_load_dwordx4 v4, s[32:35], s31 offen lds
  s_waitcnt vmcnt(26)
  ds_read_b64_tr_b16 a[72:73], v2 offset:9216
  ds_read_b64_tr_b16 a[74:75], v2 offset:9472
  ds_read_b64_tr_b16 a[76:77], v2 offset:9248
  ds_read_b64_tr_b16 a[78:79], v2 offset:9504
  s_waitcnt lgkmcnt(4)
  s_add_u32 m0, s22, 8192
  s_mov_b32 s31, 616448
  buffer_load_dwordx4 v4, s[32:35], s31 offen lds
  s_add_u32 m0, s22, 24608
  s_mov_b32 s31, 638464
  buffer_load_dwordx4 v4, s[32:35], s31 offen lds
  s_waitcnt vmcnt(26)
  ds_read_b64_tr_b16 a[80:81], v2 offset:10240
  ds_read_b64_tr_b16 a[82:83], v2 offset:10496
  ds_read_b64_tr_b16 a[84:85], v2 offset:10272
  ds_read_b64_tr_b16 a[86:87], v2 offset:10528
  s_waitcnt lgkmcnt(4)
  s_add_u32 m0, s22, 9216
  s_mov_b32 s31, 704512
  buffer_load_dwordx4 v4, s[32:35], s31 offen lds
  s_add_u32 m0, s22, 25632
  s_mov_b32 s31, 726528
  buffer_load_dwordx4 v4, s[32:35], s31 offen lds
  s_waitcnt vmcnt(26)
  ds_read_b64_tr_b16 a[88:89], v2 offset:11264
  ds_read_b64_tr_b16 a[90:91], v2 offset:11520
  ds_read_b64_tr_b16 a[92:93], v2 offset:11296
  ds_read_b64_tr_b16 a[94:95], v2 offset:11552
  s_waitcnt lgkmcnt(4)
  s_add_u32 m0, s22, 10240
  s_mov_b32 s31, 792576
  buffer_load_dwordx4 v4, s[32:35], s31 offen lds
  s_add_u32 m0, s22, 26656
  s_mov_b32 s31, 814592
  buffer_load_dwordx4 v4, s[32:35], s31 offen lds
  s_waitcnt vmcnt(26)
  ds_read_b64_tr_b16 a[96:97], v2 offset:12288
  ds_read_b64_tr_b16 a[98:99], v2 offset:12544
  ds_read_b64_tr_b16 a[100:101], v2 offset:12320
  ds_read_b64_tr_b16 a[102:103], v2 offset:12576
  s_waitcnt lgkmcnt(4)
  s_add_u32 m0, s22, 11264
  s_mov_b32 s31, 880640
  buffer_load_dwordx4 v4, s[32:35], s31 offen lds
  s_add_u32 m0, s22, 27680
  s_mov_b32 s31, 902656
  buffer_load_dwordx4 v4, s[32:35], s31 offen lds
  s_waitcnt vmcnt(26)
  ds_read_b64_tr_b16 a[104:105], v2 offset:13312
  ds_read_b64_tr_b16 a[106:107], v2 offset:13568
  ds_read_b64_tr_b16 a[108:109], v2 offset:13344
  ds_read_b64_tr_b16 a[110:111], v2 offset:13600
  s_waitcnt lgkmcnt(4)
  s_add_u32 m0, s22, 12288
  s_mov_b32 s31, 968704
  buffer_load_dwordx4 v4, s[32:35], s31 offen lds
  s_add_u32 m0, s22, 28704
  s_mov_b32 s31, 990720
  buffer_load_dwordx4 v4, s[32:35], s31 offen lds
  s_waitcnt vmcnt(26)
  ds_read_b64_tr_b16 a[112:113], v2 offset:14336
  ds_read_b64_tr_b16 a[114:115], v2 offset:14592
  ds_read_b64_tr_b16 a[116:117], v2 offset:14368
  ds_read_b64_tr_b16 a[118:119], v2 offset:14624
  s_waitcnt lgkmcnt(4)
  s_add_u32 m0, s22, 13312
  s_mov_b32 s31, 1056768
  buffer_load_dwordx4 v4, s[32:35], s31 offen lds
  s_add_u32 m0, s22, 29728
  s_mov_b32 s31, 1078784
  buffer_load_dwordx4 v4, s[32:35], s31 offen lds
  s_waitcnt vmcnt(26)
  ds_read_b64_tr_b16 a[120:121], v2 offset:0
  ds_read_b64_tr_b16 a[122:123], v2 offset:256
  ds_read_b64_tr_b16 a[124:125], v2 offset:32
  ds_read_b64_tr_b16 a[126:127], v2 offset:288
  s_waitcnt lgkmcnt(4)
  s_add_u32 m0, s22, 14336
  s_mov_b32 s31, 1144832
  buffer_load_dwordx4 v4, s[32:35], s31 offen lds
  s_add_u32 m0, s22, 30752
  s_mov_b32 s31, 1166848
  buffer_load_dwordx4 v4, s[32:35], s31 offen lds
  s_waitcnt vmcnt(26)
  ds_read_b64_tr_b16 a[128:129], v2 offset:1024
  ds_read_b64_tr_b16 a[130:131], v2 offset:1280
  ds_read_b64_tr_b16 a[132:133], v2 offset:1056
  ds_read_b64_tr_b16 a[134:135], v2 offset:1312
  s_waitcnt lgkmcnt(4)
  s_add_u32 m0, s22, 0
  s_mov_b32 s31, 1232896
  buffer_load_dwordx4 v4, s[32:35], s31 offen lds
  s_add_u32 m0, s22, 16416
  s_mov_b32 s31, 1254912
  buffer_load_dwordx4 v4, s[32:35], s31 offen lds
  s_waitcnt vmcnt(26)
  ds_read_b64_tr_b16 a[136:137], v2 offset:2048
  ds_read_b64_tr_b16 a[138:139], v2 offset:2304
  ds_read_b64_tr_b16 a[140:141], v2 offset:2080
  ds_read_b64_tr_b16 a[142:143], v2 offset:2336
  s_waitcnt lgkmcnt(4)
  s_add_u32 m0, s22, 1024
  s_mov_b32 s31, 1320960
  buffer_load_dwordx4 v4, s[32:35], s31 offen lds
  s_add_u32 m0, s22, 17440
  s_mov_b32 s31, 1342976
  buffer_load_dwordx4 v4, s[32:35], s31 offen lds
  s_waitcnt vmcnt(26)
  ds_read_b64_tr_b16 a[144:145], v2 offset:3072
  ds_read_b64_tr_b16 a[146:147], v2 offset:3328
  ds_read_b64_tr_b16 a[148:149], v2 offset:3104
  ds_read_b64_tr_b16 a[150:151], v2 offset:3360
  s_waitcnt vmcnt(24)
  ds_read_b64_tr_b16 a[152:153], v2 offset:4096
  ds_read_b64_tr_b16 a[154:155], v2 offset:4352
  ds_read_b64_tr_b16 a[156:157], v2 offset:4128
  ds_read_b64_tr_b16 a[158:159], v2 offset:4384
  s_waitcnt vmcnt(22)
  ds_read_b64_tr_b16 a[160:161], v2 offset:5120
  ds_read_b64_tr_b16 a[162:163], v2 offset:5376
  ds_read_b64_tr_b16 a[164:165], v2 offset:5152
  ds_read_b64_tr_b16 a[166:167], v2 offset:5408
  s_waitcnt vmcnt(20)
  ds_read_b64_tr_b16 a[168:169], v2 offset:6144
  ds_read_b64_tr_b16 a[170:171], v2 offset:6400
  ds_read_b64_tr_b16 a[172:173], v2 offset:6176
  ds_read_b64_tr_b16 a[174:175], v2 offset:6432
  s_waitcnt vmcnt(18)
  ds_read_b64_tr_b16 a[176:177], v2 offset:7168
  ds_read_b64_tr_b16 a[178:179], v2 offset:7424
  ds_read_b64_tr_b16 a[180:181], v2 offset:7200
  ds_read_b64_tr_b16 a[182:183], v2 offset:7456
  s_waitcnt vmcnt(16)
  ds_read_b64_tr_b16 a[184:185], v2 offset:8192
  ds_read_b64_tr_b16 a[186:187], v2 offset:8448
  ds_read_b64_tr_b16 a[188:189], v2 offset:8224
  ds_read_b64_tr_b16 a[190:191], v2 offset:8480
  s_waitcnt vmcnt(14)
  ds_read_b64_tr_b16 a[192:193], v2 offset:9216
  ds_read_b64_tr_b16 a[194:195], v2 offset:9472
  ds_read_b64_tr_b16 a[196:197], v2 offset:9248
  ds_read_b64_tr_b16 a[198:199], v2 offset:9504
  s_waitcnt vmcnt(12)
  ds_read_b64_tr_b16 a[200:201], v2 offset:10240
  ds_read_b64_tr_b16 a[202:203], v2 offset:10496
  ds_read_b64_tr_b16 a[204:205], v2 offset:10272
  ds_read_b64_tr_b16 a[206:207], v2 offset:10528
  s_waitcnt vmcnt(10)
  ds_read_b64_tr_b16 a[208:209], v2 offset:11264
  ds_read_b64_tr_b16 a[210:211], v2 offset:11520
  ds_read_b64_tr_b16 a[212:213], v2 offset:11296
  ds_read_b64_tr_b16 a[214:215], v2 offset:11552
  s_waitcnt vmcnt(8)
  ds_read_b64_tr_b16 a[216:217], v2 offset:12288
  ds_read_b64_tr_b16 a[218:219], v2 offset:12544
  ds_read_b64_tr_b16 a[220:221], v2 offset:12320
  ds_read_b64_tr_b16 a[222:223], v2 offset:12576
  s_waitcnt vmcnt(6)
  ds_read_b64_tr_b16 a[224:225], v2 offset:13312
  ds_read_b64_tr_b16 a[226:227], v2 offset:13568
  ds_read_b64_tr_b16 a[228:229], v2 offset:13344
  ds_read_b64_tr_b16 a[230:231], v2 offset:13600
  s_waitcnt vmcnt(4)
  ds_read_b64_tr_b16 a[232:233], v2 offset:14336
  ds_read_b64_tr_b16 a[234:235], v2 offset:14592
  ds_read_b64_tr_b16 a[236:237], v2 offset:14368
  ds_read_b64_tr_b16 a[238:239], v2 offset:14624
  s_waitcnt vmcnt(2)
  ds_read_b64_tr_b16 a[240:241], v2 offset:0
  ds_read_b64_tr_b16 a[242:243], v2 offset:256
  ds_read_b64_tr_b16 a[244:245], v2 offset:32
  ds_read_b64_tr_b16 a[246:247], v2 offset:288
  s_waitcnt vmcnt(0)
  ds_read_b64_tr_b16 a[248:249], v2 offset:1024
  ds_read_b64_tr_b16 a[250:251], v2 offset:1280
  ds_read_b64_tr_b16 a[252:253], v2 offset:1056
  ds_read_b64_tr_b16 a[254:255], v2 offset:1312
  v_add_u32 v6, 131072, v1
  s_mov_b32 s28, 0
  s_mov_b32 s30, 0
  s_waitcnt vmcnt(0) lgkmcnt(0)
P2_top:
  s_waitcnt vmcnt(2)
  s_barrier
  s_add_u32 s29, s23, 20
  s_min_u32 s29, s29, 63
  ds_read_b128 v[16:19], v6 offset:0
  ds_read_b128 v[20:23], v6 offset:1024
  ds_read_b128 v[24:27], v6 offset:2048
  ds_read_b128 v[28:31], v6 offset:3072
  ds_read_b128 v[32:35], v6 offset:4096
  ds_read_b128 v[36:39], v6 offset:5120
  s_lshl_b32 s24, s29, 15
  s_lshl_b32 s25, s20, 13
  s_add_u32 s25, s25, s28
  s_add_u32 m0, s25, 0
  s_add_u32 s31, s24, 0
  buffer_load_dwordx4 v5, s[36:39], s31 offen lds
  s_add_u32 m0, s25, 1024
  s_add_u32 s31, s24, 16384
  buffer_load_dwordx4 v5, s[36:39], s31 offen lds
  s_add_u32 m0, s25, 2048
  s_add_u32 s31, s24, 64
  buffer_load_dwordx4 v5, s[36:39], s31 offen lds
  s_add_u32 m0, s25, 3072
  s_add_u32 s31, s24, 16448
  buffer_load_dwordx4 v5, s[36:39], s31 offen lds
  s_add_u32 m0, s25, 4096
  s_add_u32 s31, s24, 128
  buffer_load_dwordx4 v5, s[36:39], s31 offen lds
  s_add_u32 m0, s25, 5120
  s_add_u32 s31, s24, 16512
  buffer_load_dwordx4 v5, s[36:39], s31 offen lds
  s_add_u32 m0, s25, 6144
  s_add_u32 s31, s24, 192
  buffer_load_dwordx4 v5, s[36:39], s31 offen lds
  s_add_u32 m0, s25, 7168
  s_add_u32 s31, s24, 16576
  buffer_load_dwordx4 v5, s[36:39], s31 offen lds
  s_waitcnt lgkmcnt(5)
  v_mfma_f32_16x16x32_bf16 v[48:51], a[0:3], v[16:19], 0
  ds_read_b128 v[40:43], v6 offset:6144
  v_mfma_f32_16x16x32_bf16 v[52:55], a[4:7], v[16:19], 0
  ds_read_b128 v[44:47], v6 offset:7168
  v_mfma_f32_16x16x32_bf16 v[64:67], a[128:131], v[16:19], 0
  v_mfma_f32_16x16x32_bf16 v[68:71], a[132:135], v[16:19], 0
  s_waitcnt lgkmcnt(6)
  v_mfma_f32_16x16x32_bf16 v[56:59], a[0:3], v[20:23], 0
  v_mfma_f32_16x16x32_bf16 v[60:63], a[4:7], v[20:23], 0
  v_mfma_f32_16x16x32_bf16 v[72:75], a[128:131], v[20:23], 0
  v_mfma_f32_16x16x32_bf16 v[76:79], a[132:135], v[20:23], 0
  s_waitcnt lgkmcnt(5)
  v_mfma_f32_16x16x32_bf16 v[48:51], a[8:11], v[24:27], v[48:51]
  ds_read_b128 v[16:19], v6 offset:8192
  v_mfma_f32_16x16x32_bf16 v[52:55], a[12:15], v[24:27], v[52:55]
  ds_read_b128 v[20:23], v6 offset:9216
  v_mfma_f32_16x16x32_bf16 v[64:67], a[136:139], v[24:27], v[64:67]
  v_mfma_f32_16x16x32_bf16 v[68:71], a[140:143], v[24:27], v[68:71]
  s_waitcnt lgkmcnt(6)
  v_mfma_f32_16x16x32_bf16 v[56:59], a[8:11], v[28:31], v[56:59]
  v_mfma_f32_16x16x32_bf16 v[60:63], a[12:15], v[28:31], v[60:63]
  v_mfma_f32_16x16x32_bf16 v[72:75], a[136:139], v[28:31], v[72:75]
  v_mfma_f32_16x16x32_bf16 v[76:79], a[140:143], v[28:31], v[76:79]
  s_waitcnt lgkmcnt(5)
  v_mfma_f32_16x16x32_bf16 v[48:51], a[16:19], v[32:35], v[48:51]
  ds_read_b128 v[24:27], v6 offset:10240
  v_mfma_f32_16x16x32_bf16 v[52:55], a[20:23], v[32:35], v[52:55]
  ds_read_b128 v[28:31], v6 offset:11264
  v_mfma_f32_16x16x32_bf16 v[64:67], a[144:147], v[32:35], v[64:67]
  v_mfma_f32_16x16x32_bf16 v[68:71], a[148:151], v[32:35], v[68:71]
  s_waitcnt lgkmcnt(6)
  v_mfma_f32_16x16x32_bf16 v[56:59], a[16:19], v[36:39], v[56:59]
  v_mfma_f32_16x16x32_bf16 v[60:63], a[20:23], v[36:39], v[60:63]
  v_mfma_f32_16x16x32_bf16 v[72:75], a[144:147], v[36:39], v[72:75]
  v_mfma_f32_16x16x32_bf16 v[76:79], a[148:151], v[36:39], v[76:79]
  s_waitcnt lgkmcnt(5)
  v_mfma_f32_16x16x32_bf16 v[48:51], a[24:27], v[40:43], v[48:51]
  ds_read_b128 v[32:35], v6 offset:12288
  v_mfma_f32_16x16x32_bf16 v[52:55], a[28:31], v[40:43], v[52:55]
  ds_read_b128 v[36:39], v6 offset:13312
  v_mfma_f32_16x16x32_bf16 v[64:67], a[152:155], v[40:43], v[64:67]
  v_mfma_f32_16x16x32_bf16 v[68:71], a[156:159], v[40:43], v[68:71]
  s_waitcnt lgkmcnt(6)
  v_mfma_f32_16x16x32_bf16 v[56:59], a[24:27], v[44:47], v[56:59]
  v_mfma_f32_16x16x32_bf16 v[60:63], a[28:31], v[44:47], v[60:63]
  v_mfma_f32_16x16x32_bf16 v[72:75], a[152:155], v[44:47], v[72:75]
  v_mfma_f32_16x16x32_bf16 v[76:79], a[156:159], v[44:47], v[76:79]
  s_waitcnt lgkmcnt(5)
  v_mfma_f32_16x16x32_bf16 v[48:51], a[32:35], v[16:19], v[48:51]
  ds_read_b128 v[40:43], v6 offset:14336
  v_mfma_f32_16x16x32_bf16 v[52:55], a[36:39], v[16:19], v[52:55]
  ds_read_b128 v[44:47], v6 offset:15360
  v_mfma_f32_16x16x32_bf16 v[64:67], a[160:163], v[16:19], v[64:67]
  v_mfma_f32_16x16x32_bf16 v[68:71], a[164:167], v[16:19], v[68:71]
  s_waitcnt lgkmcnt(6)
  v_mfma_f32_16x16x32_bf16 v[56:59], a[32:35], v[20:23], v[56:59]
  v_mfma_f32_16x16x32_bf16 v[60:63], a[36:39], v[20:23], v[60:63]
  v_mfma_f32_16x16x32_bf16 v[72:75], a[160:163], v[20:23], v[72:75]
  v_mfma_f32_16x16x32_bf16 v[76:79], a[164:167], v[20:23], v[76:79]
  s_waitcnt lgkmcnt(5)
  v_mfma_f32_16x16x32_bf16 v[48:51], a[40:43], v[24:27], v[48:51]
  ds_read_b128 v[16:19], v6 offset:16384
  v_mfma_f32_16x16x32_bf16 v[52:55], a[44:47], v[24:27], v[52:55]
  ds_read_b128 v[20:23], v6 offset:17408
  v_mfma_f32_16x16x32_bf16 v[64:67], a[168:171], v[24:27], v[64:67]
  v_mfma_f32_16x16x32_bf16 v[68:71], a[172:175], v[24:27], v[68:71]
  s_waitcnt lgkmcnt(6)
  v_mfma_f32_16x16x32_bf16 v[56:59], a[40:43], v[28:31], v[56:59]
  v_mfma_f32_16x16x32_bf16 v[60:63], a[44:47], v[28:31], v[60:63]
  v_mfma_f32_16x16x32_bf16 v[72:75], a[168:171], v[28:31], v[72:75]
  v_mfma_f32_16x16x32_bf16 v[76:79], a[172:175], v[28:31], v[76:79]
  s_waitcnt lgkmcnt(5)
  v_mfma_f32_16x16x32_bf16 v[48:51], a[48:51], v[32:35], v[48:51]
  ds_read_b128 v[24:27], v6 offset:18432
  v_mfma_f32_16x16x32_bf16 v[52:55], a[52:55], v[32:35], v[52:55]
  ds_read_b128 v[28:31], v6 offset:19456
  v_mfma_f32_16x16x32_bf16 v[64:67], a[176:179], v[32:35], v[64:67]
  v_mfma_f32_16x16x32_bf16 v[68:71], a[180:183], v[32:35], v[68:71]
  s_waitcnt lgkmcnt(6)
  v_mfma_f32_16x16x32_bf16 v[56:59], a[48:51], v[36:39], v[56:59]
  v_mfma_f32_16x16x32_bf16 v[60:63], a[52:55], v[36:39], v[60:63]
  v_mfma_f32_16x16x32_bf16 v[72:75], a[176:179], v[36:39], v[72:75]
  v_mfma_f32_16x16x32_bf16 v[76:79], a[180:183], v[36:39], v[76:79]
  s_waitcnt lgkmcnt(5)
  v_mfma_f32_16x16x32_bf16 v[48:51], a[56:59], v[40:43], v[48:51]
  ds_read_b128 v[32:35], v6 offset:20480
  v_mfma_f32_16x16x32_bf16 v[52:55], a[60:63], v[40:43], v[52:55]
  ds_read_b128 v[36:39], v6 offset:21504
  v_mfma_f32_16x16x32_bf16 v[64:67], a[184:187], v[40:43], v[64:67]
  v_mfma_f32_16x16x32_bf16 v[68:71], a[188:191], v[40:43], v[68:71]
  s_waitcnt lgkmcnt(6)
  v_mfma_f32_16x16x32_bf16 v[56:59], a[56:59], v[44:47], v[56:59]
  v_mfma_f32_16x16x32_bf16 v[60:63], a[60:63], v[44:47], v[60:63]
  v_mfma_f32_16x16x32_bf16 v[72:75], a[184:187], v[44:47], v[72:75]
  v_mfma_f32_16x16x32_bf16 v[76:79], a[188:191], v[44:47], v[76:79]
  s_waitcnt lgkmcnt(5)
  v_mfma_f32_16x16x32_bf16 v[48:51], a[64:67], v[16:19], v[48:51]
  ds_read_b128 v[40:43], v6 offset:22528
  v_mfma_f32_16x16x32_bf16 v[52:55], a[68:71], v[16:19], v[52:55]
  ds_read_b128 v[44:47], v6 offset:23552
  v_mfma_f32_16x16x32_bf16 v[64:67], a[192:195], v[16:19], v[64:67]
  v_mfma_f32_16x16x32_bf16 v[68:71], a[196:199], v[16:19], v[68:71]
  s_waitcnt lgkmcnt(6)
  v_mfma_f32_16x16x32_bf16 v[56:59], a[64:67], v[20:23], v[56:59]
  v_mfma_f32_16x16x32_bf16 v[60:63], a[68:71], v[20:23], v[60:63]
  v_mfma_f32_16x16x32_bf16 v[72:75], a[192:195], v[20:23], v[72:75]
  v_mfma_f32_16x16x32_bf16 v[76:79], a[196:199], v[20:23], v[76:79]
  s_waitcnt lgkmcnt(5)
  v_mfma_f32_16x16x32_bf16 v[48:51], a[72:75], v[24:27], v[48:51]
  ds_read_b128 v[16:19], v6 offset:24576
  v_mfma_f32_16x16x32_bf16 v[52:55], a[76:79], v[24:27], v[52:55]
  ds_read_b128 v[20:23], v6 offset:25600
  v_mfma_f32_16x16x32_bf16 v[64:67], a[200:203], v[24:27], v[64:67]
  v_mfma_f32_16x16x32_bf16 v[68:71], a[204:207], v[24:27], v[68:71]
  s_waitcnt lgkmcnt(6)
  v_mfma_f32_16x16x32_bf16 v[56:59], a[72:75], v[28:31], v[56:59]
  v_mfma_f32_16x16x32_bf16 v[60:63], a[76:79], v[28:31], v[60:63]
  v_mfma_f32_16x16x32_bf16 v[72:75], a[200:203], v[28:31], v[72:75]
  v_mfma_f32_16x16x32_bf16 v[76:79], a[204:207], v[28:31], v[76:79]
  s_waitcnt lgkmcnt(5)
  v_mfma_f32_16x16x32_bf16 v[48:51], a[80:83], v[32:35], v[48:51]
  ds_read_b128 v[24:27], v6 offset:26624
  v_mfma_f32_16x16x32_bf16 v[52:55], a[84:87], v[32:35], v[52:55]
  ds_read_b128 v[28:31], v6 offset:27648
  v_mfma_f32_16x16x32_bf16 v[64:67], a[208:211], v[32:35], v[64:67]
  v_mfma_f32_16x16x32_bf16 v[68:71], a[212:215], v[32:35], v[68:71]
  s_waitcnt lgkmcnt(6)
  v_mfma_f32_16x16x32_bf16 v[56:59], a[80:83], v[36:39], v[56:59]
  v_mfma_f32_16x16x32_bf16 v[60:63], a[84:87], v[36:39], v[60:63]
  v_mfma_f32_16x16x32_bf16 v[72:75], a[208:211], v[36:39], v[72:75]
  v_mfma_f32_16x16x32_bf16 v[76:79], a[212:215], v[36:39], v[76:79]
  s_waitcnt lgkmcnt(5)
  v_mfma_f32_16x16x32_bf16 v[48:51], a[88:91], v[40:43], v[48:51]
  ds_read_b128 v[32:35], v6 offset:28672
  v_mfma_f32_16x16x32_bf16 v[52:55], a[92:95], v[40:43], v[52:55]
  ds_read_b128 v[36:39], v6 offset:29696
  v_mfma_f32_16x16x32_bf16 v[64:67], a[216:219], v[40:43], v[64:67]
  v_mfma_f32_16x16x32_bf16 v[68:71], a[220:223], v[40:43], v[68:71]
  s_waitcnt lgkmcnt(6)
  v_mfma_f32_16x16x32_bf16 v[56:59], a[88:91], v[44:47], v[56:59]
  v_mfma_f32_16x16x32_bf16 v[60:63], a[92:95], v[44:47], v[60:63]
  v_mfma_f32_16x16x32_bf16 v[72:75], a[216:219], v[44:47], v[72:75]
  v_mfma_f32_16x16x32_bf16 v[76:79], a[220:223], v[44:47], v[76:79]
  s_waitcnt lgkmcnt(5)
  v_mfma_f32_16x16x32_bf16 v[48:51], a[96:99], v[16:19], v[48:51]
  ds_read_b128 v[40:43], v6 offset:30720
  v_mfma_f32_16x16x32_bf16 v[52:55], a[100:103], v[16:19], v[52:55]
  ds_read_b128 v[44:47], v6 offset:31744
  v_mfma_f32_16x16x32_bf16 v[64:67], a[224:227], v[16:19], v[64:67]
  v_mfma_f32_16x16x32_bf16 v[68:71], a[228:231], v[16:19], v[68:71]
  s_waitcnt lgkmcnt(6)
  v_mfma_f32_16x16x32_bf16 v[56:59], a[96:99], v[20:23], v[56:59]
  v_mfma_f32_16x16x32_bf16 v[60:63], a[100:103], v[20:23], v[60:63]
  v_mfma_f32_16x16x32_bf16 v[72:75], a[224:227], v[20:23], v[72:75]
  v_mfma_f32_16x16x32_bf16 v[76:79], a[228:231], v[20:23], v[76:79]
  s_waitcnt lgkmcnt(5)
  v_mfma_f32_16x16x32_bf16 v[48:51], a[104:107], v[24:27], v[48:51]
  v_mfma_f32_16x16x32_bf16 v[52:55], a[108:111], v[24:27], v[52:55]
  v_mfma_f32_16x16x32_bf16 v[64:67], a[232:235], v[24:27], v[64:67]
  v_mfma_f32_16x16x32_bf16 v[68:71], a[236:239], v[24:27], v[68:71]
  s_waitcnt lgkmcnt(4)
  v_mfma_f32_16x16x32_bf16 v[56:59], a[104:107], v[28:31], v[56:59]
  v_mfma_f32_16x16x32_bf16 v[60:63], a[108:111], v[28:31], v[60:63]
  v_mfma_f32_16x16x32_bf16 v[72:75], a[232:235], v[28:31], v[72:75]
  v_mfma_f32_16x16x32_bf16 v[76:79], a[236:239], v[28:31], v[76:79]
  s_waitcnt lgkmcnt(3)
  v_mfma_f32_16x16x32_bf16 v[48:51], a[112:115], v[32:35], v[48:51]
  v_mfma_f32_16x16x32_bf16 v[52:55], a[116:119], v[32:35], v[52:55]
  v_mfma_f32_16x16x32_bf16 v[64:67], a[240:243], v[32:35], v[64:67]
  v_mfma_f32_16x16x32_bf16 v[68:71], a[244:247], v[32:35], v[68:71]
  s_waitcnt lgkmcnt(2)
  v_mfma_f32_16x16x32_bf16 v[56:59], a[112:115], v[36:39], v[56:59]
  v_mfma_f32_16x16x32_bf16 v[60:63], a[116:119], v[36:39], v[60:63]
  v_mfma_f32_16x16x32_bf16 v[72:75], a[240:243], v[36:39], v[72:75]
  v_mfma_f32_16x16x32_bf16 v[76:79], a[244:247], v[36:39], v[76:79]
  s_waitcnt lgkmcnt(1)
  v_mfma_f32_16x16x32_bf16 v[48:51], a[120:123], v[40:43], v[48:51]
  v_mfma_f32_16x16x32_bf16 v[52:55], a[124:127], v[40:43], v[52:55]
  v_mfma_f32_16x16x32_bf16 v[64:67], a[248:251], v[40:43], v[64:67]
  v_mfma_f32_16x16x32_bf16 v[68:71], a[252:255], v[40:43], v[68:71]
  s_waitcnt lgkmcnt(0)
  v_mfma_f32_16x16x32_bf16 v[56:59], a[120:123], v[44:47], v[56:59]
  v_mfma_f32_16x16x32_bf16 v[60:63], a[124:127], v[44:47], v[60:63]
  v_mfma_f32_16x16x32_bf16 v[72:75], a[248:251], v[44:47], v[72:75]
  v_mfma_f32_16x16x32_bf16 v[76:79], a[252:255], v[44:47], v[76:79]
  s_mul_i32 s24, s23, 86
  s_add_u32 s24, s24, s26
  s_lshl_b32 s24, s24, 10
  s_add_u32 s24, s24, 100663296
  s_add_u32 s25, s24, 44032
  v_mul_f32 v48, v48, v64
  v_mul_f32 v49, v49, v65
  v_mul_f32 v50, v50, v66
  v_mul_f32 v51, v51, v67
  v_mul_f32 v52, v52, v68
  v_mul_f32 v53, v53, v69
  v_mul_f32 v54, v54, v70
  v_mul_f32 v55, v55, v71
  v_cvt_pk_bf16_f32 v96, v48, v49
  v_cvt_pk_bf16_f32 v97, v50, v51
  v_cvt_pk_bf16_f32 v98, v52, v53
  v_cvt_pk_bf16_f32 v99, v54, v55
  buffer_store_dwordx4 v[96:99], v1, s[8:11], s24 offen sc1
  v_mul_f32 v56, v56, v72
  v_mul_f32 v57, v57, v73
  v_mul_f32 v58, v58, v74
  v_mul_f32 v59, v59, v75
  v_mul_f32 v60, v60, v76
  v_mul_f32 v61, v61, v77
  v_mul_f32 v62, v62, v78
  v_mul_f32 v63, v63, v79
  v_cvt_pk_bf16_f32 v100, v56, v57
  v_cvt_pk_bf16_f32 v101, v58, v59
  v_cvt_pk_bf16_f32 v102, v60, v61
  v_cvt_pk_bf16_f32 v103, v62, v63
  buffer_store_dwordx4 v[100:103], v1, s[8:11], s25 offen sc1
  v_xor_b32 v6, 131072, v6
  s_xor_b32 s28, s28, 131072
  s_add_u32 s30, s30, 1
  s_add_u32 s23, s23, 20
  s_cmp_lt_u32 s23, 64
  s_cbranch_scc1 P2_top
  s_waitcnt vmcnt(0)
  s_barrier
  s_cmp_lg_u32 s20, 0
  s_cbranch_scc1 P2_end
  s_mul_i32 s26, s21, 3277
  s_lshr_b32 s26, s26, 16
  s_mul_i32 s24, s26, 20
  s_sub_u32 s24, s21, s24
  s_lshl_b32 s24, s24, 5
  s_add_u32 s24, s24, s26
  s_lshl_b32 s24, s24, 2
  s_add_u32 s24, s24, 51388416
  s_mov_b64 exec, 1
  buffer_store_dword v8, v7, s[8:11], s24 offen sc1
  s_mov_b64 exec, -1
P2_end:
  s_cmp_ge_u32 s21, 160
  s_cbranch_scc1 L_p3
  s_and_b32 s58, s21, 15
  s_lshr_b32 s59, s21, 5
  s_bfe_u32 s24, s21, 0x10004
  s_mul_i32 s24, s24, 5
  s_add_u32 s59, s59, s24
  s_lshl_b32 s24, s58, 6
  v_bfe_u32 v10, v0, 4, 1
  v_lshlrev_b32 v10, 4, v10
  v_lshrrev_b32 v11, 5, v0
  v_lshl_add_u32 v10, v11, 3, v10
  v_bfe_u32 v9, v0, 2, 2
  v_add_u32 v9, v9, v10
  v_mul_u32_u24 v9, 1024, v9
  v_and_b32 v11, 3, v0
  v_lshl_add_u32 v9, v11, 4, v9
  v_add_u32 v4, s24, v9
  v_lshrrev_b32 v9, 4, v0
  v_lshlrev_b32 v9, 4, v9
  s_lshl_b32 s24, s20, 8
  v_add_u32 v9, s24, v9
  global_load_dwordx4 v[128:131], v9, s[54:55] offset:0
  global_load_dwordx4 v[132:135], v9, s[54:55] offset:64
  global_load_dwordx4 v[136:139], v9, s[54:55] offset:128
  global_load_dwordx4 v[140:143], v9, s[54:55] offset:192
  s_mov_b32 s32, s52
  s_mov_b32 s33, s53
  s_mov_b32 s34, 1409024
  s_mul_i32 s26, s20, 11
  s_add_u32 s26, s26, 0
  s_min_u32 s26, s26, 42
  s_lshl_b32 s26, s26, 15
  s_add_u32 m0, s22, 0
  s_add_u32 s31, s26, 0
  buffer_load_dwordx4 v4, s[32:35], s31 offen lds
  s_add_u32 m0, s22, 16416
  s_add_u32 s31, s26, 4096
  buffer_load_dwordx4 v4, s[32:35], s31 offen lds
  s_mul_i32 s26, s20, 11
  s_add_u32 s26, s26, 1
  s_min_u32 s26, s26, 42
  s_lshl_b32 s26, s26, 15
  s_add_u32 m0, s22, 1024
  s_add_u32 s31, s26, 0
  buffer_load_dwordx4 v4, s[32:35], s31 offen lds
  s_add_u32 m0, s22, 17440
  s_add_u32 s31, s26, 4096
  buffer_load_dwordx4 v4, s[32:35], s31 offen lds
  s_mul_i32 s26, s20, 11
  s_add_u32 s26, s26, 2
  s_min_u32 s26, s26, 42
  s_lshl_b32 s26, s26, 15
  s_add_u32 m0, s22, 2048
  s_add_u32 s31, s26, 0
  buffer_load_dwordx4 v4, s[32:35], s31 offen lds
  s_add_u32 m0, s22, 18464
  s_add_u32 s31, s26, 4096
  buffer_load_dwordx4 v4, s[32:35], s31 offen lds
  s_mul_i32 s26, s20, 11
  s_add_u32 s26, s26, 3
  s_min_u32 s26, s26, 42
  s_lshl_b32 s26, s26, 15
  s_add_u32 m0, s22, 3072
  s_add_u32 s31, s26, 0
  buffer_load_dwordx4 v4, s[32:35], s31 offen lds
  s_add_u32 m0, s22, 19488
  s_add_u32 s31, s26, 4096
  buffer_load_dwordx4 v4, s[32:35], s31 offen lds
  s_mul_i32 s26, s20, 11
  s_add_u32 s26, s26, 4
  s_min_u32 s26, s26, 42
  s_lshl_b32 s26, s26, 15
  s_add_u32 m0, s22, 4096
  s_add_u32 s31, s26, 0
  buffer_load_dwordx4 v4, s[32:35], s31 offen lds
  s_add_u32 m0, s22, 20512
  s_add_u32 s31, s26, 4096
  buffer_load_dwordx4 v4, s[32:35], s31 offen lds
  s_mul_i32 s26, s20, 11
  s_add_u32 s26, s26, 5
  s_min_u32 s26, s26, 42
  s_lshl_b32 s26, s26, 15
  s_add_u32 m0, s22, 5120
  s_add_u32 s31, s26, 0
  buffer_load_dwordx4 v4, s[32:35], s31 offen lds
  s_add_u32 m0, s22, 21536
  s_add_u32 s31, s26, 4096
  buffer_load_dwordx4 v4, s[32:35], s31 offen lds
  s_mul_i32 s26, s20, 11
  s_add_u32 s26, s26, 6
  s_min_u32 s26, s26, 42
  s_lshl_b32 s26, s26, 15
  s_add_u32 m0, s22, 6144
  s_add_u32 s31, s26, 0
  buffer_load_dwordx4 v4, s[32:35], s31 offen lds
  s_add_u32 m0, s22, 22560
  s_add_u32 s31, s26, 4096
  buffer_load_dwordx4 v4, s[32:35], s31 offen lds
  s_mul_i32 s26, s20, 11
  s_add_u32 s26, s26, 7
  s_min_u32 s26, s26, 42
  s_lshl_b32 s26, s26, 15
  s_add_u32 m0, s22, 7168
  s_add_u32 s31, s26, 0
  buffer_load_dwordx4 v4, s[32:35], s31 offen lds
  s_add_u32 m0, s22, 23584
  s_add_u32 s31, s26, 4096
  buffer_load_dwordx4 v4, s[32:35], s31 offen lds
  s_mul_i32 s26, s20, 11
  s_add_u32 s26, s26, 8
  s_min_u32 s26, s26, 42
  s_lshl_b32 s26, s26, 15
  s_add_u32 m0, s22, 8192
  s_add_u32 s31, s26, 0
  buffer_load_dwordx4 v4, s[32:35], s31 offen lds
  s_add_u32 m0, s22, 24608
  s_add_u32 s31, s26, 4096
  buffer_load_dwordx4 v4, s[32:35], s31 offen lds
  s_mul_i32 s26, s20, 11
  s_add_u32 s26, s26, 9
  s_min_u32 s26, s26, 42
  s_lshl_b32 s26, s26, 15
  s_add_u32 m0, s22, 9216
  s_add_u32 s31, s26, 0
  buffer_load_dwordx4 v4, s[32:35], s31 offen lds
  s_add_u32 m0, s22, 25632
  s_add_u32 s31, s26, 4096
  buffer_load_dwordx4 v4, s[32:35], s31 offen lds
  s_mul_i32 s26, s20, 11
  s_add_u32 s26, s26, 10
  s_min_u32 s26, s26, 42
  s_lshl_b32 s26, s26, 15
  s_add_u32 m0, s22, 10240
  s_add_u32 s31, s26, 0
  buffer_load_dwordx4 v4, s[32:35], s31 offen lds
  s_add_u32 m0, s22, 26656
  s_add_u32 s31, s26, 4096
  buffer_load_dwordx4 v4, s[32:35], s31 offen lds
  s_mov_b32 s32, s46
  s_mov_b32 s33, s47
  s_mov_b32 s34, 4194304
  s_lshl_b32 s27, s20, 20
  s_add_u32 m0, s22, 11264
  s_add_u32 s31, s27, 0
  buffer_load_dwordx4 v4, s[32:35], s31 offen lds
  s_add_u32 m0, s22, 27680
  s_add_u32 s31, s27, 4096
  buffer_load_dwordx4 v4, s[32:35], s31 offen lds
  s_add_u32 m0, s22, 12288
  s_add_u32 s31, s27, 32768
  buffer_load_dwordx4 v4, s[32:35], s31 offen lds
  s_add_u32 m0, s22, 28704
  s_add_u32 s31, s27, 36864
  buffer_load_dwordx4 v4, s[32:35], s31 offen lds
  s_add_u32 m0, s22, 13312
  s_add_u32 s31, s27, 65536
  buffer_load_dwordx4 v4, s[32:35], s31 offen lds
  s_add_u32 m0, s22, 29728
  s_add_u32 s31, s27, 69632
  buffer_load_dwordx4 v4, s[32:35], s31 offen lds
  s_add_u32 m0, s22, 14336
  s_add_u32 s31, s27, 98304
  buffer_load_dwordx4 v4, s[32:35], s31 offen lds
  s_add_u32 m0, s22, 30752
  s_add_u32 s31, s27, 102400
  buffer_load_dwordx4 v4, s[32:35], s31 offen lds
  s_waitcnt vmcnt(28)
  ds_read_b64_tr_b16 v[160:161], v2 offset:0
  ds_read_b64_tr_b16 v[162:163], v2 offset:256
  ds_read_b64_tr_b16 v[164:165], v2 offset:32
  ds_read_b64_tr_b16 v[166:167], v2 offset:288
  s_waitcnt vmcnt(26)
  ds_read_b64_tr_b16 v[168:169], v2 offset:1024
  ds_read_b64_tr_b16 v[170:171], v2 offset:1280
  ds_read_b64_tr_b16 v[172:173], v2 offset:1056
  ds_read_b64_tr_b16 v[174:175], v2 offset:1312
  s_waitcnt lgkmcnt(4)
  s_add_u32 m0, s22, 0
  s_add_u32 s31, s27, 131072
  buffer_load_dwordx4 v4, s[32:35], s31 offen lds
  s_add_u32 m0, s22, 16416
  s_add_u32 s31, s27, 135168
  buffer_load_dwordx4 v4, s[32:35], s31 offen lds
  s_waitcnt vmcnt(26)
  ds_read_b64_tr_b16 v[176:177], v2 offset:2048
  ds_read_b64_tr_b16 v[178:179], v2 offset:2304
  ds_read_b64_tr_b16 v[180:181], v2 offset:2080
  ds_read_b64_tr_b16 v[182:183], v2 offset:2336
  s_waitcnt lgkmcnt(4)
  s_add_u32 m0, s22, 1024
  s_add_u32 s31, s27, 163840
  buffer_load_dwordx4 v4, s[32:35], s31 offen lds
  s_add_u32 m0, s22, 17440
  s_add_u32 s31, s27, 167936
  buffer_load_dwordx4 v4, s[32:35], s31 offen lds
  s_waitcnt vmcnt(26)
  ds_read_b64_tr_b16 v[184:185], v2 offset:3072
  ds_read_b64_tr_b16 v[186:187], v2 offset:3328
  ds_read_b64_tr_b16 v[188:189], v2 offset:3104
  ds_read_b64_tr_b16 v[190:191], v2 offset:3360
  s_waitcnt lgkmcnt(4)
  s_add_u32 m0, s22, 2048
  s_add_u32 s31, s27, 196608
  buffer_load_dwordx4 v4, s[32:35], s31 offen lds
  s_add_u32 m0, s22, 18464
  s_add_u32 s31, s27, 200704
  buffer_load_dwordx4 v4, s[32:35], s31 offen lds
  s_waitcnt vmcnt(26)
  ds_read_b64_tr_b16 v[192:193], v2 offset:4096
  ds_read_b64_tr_b16 v[194:195], v2 offset:4352
  ds_read_b64_tr_b16 v[196:197], v2 offset:4128
  ds_read_b64_tr_b16 v[198:199], v2 offset:4384
  s_waitcnt lgkmcnt(4)
  s_add_u32 m0, s22, 3072
  s_add_u32 s31, s27, 229376
  buffer_load_dwordx4 v4, s[32:35], s31 offen lds
  s_add_u32 m0, s22, 19488
  s_add_u32 s31, s27, 233472
  buffer_load_dwordx4 v4, s[32:35], s31 offen lds
  s_waitcnt vmcnt(26)
  ds_read_b64_tr_b16 v[200:201], v2 offset:5120
  ds_read_b64_tr_b16 v[202:203], v2 offset:5376
  ds_read_b64_tr_b16 v[204:205], v2 offset:5152
  ds_read_b64_tr_b16 v[206:207], v2 offset:5408
  s_waitcnt lgkmcnt(4)
  s_add_u32 m0, s22, 4096
  s_add_u32 s31, s27, 262144
  buffer_load_dwordx4 v4, s[32:35], s31 offen lds
  s_add_u32 m0, s22, 20512
  s_add_u32 s31, s27, 266240
  buffer_load_dwordx4 v4, s[32:35], s31 offen lds
  s_waitcnt vmcnt(26)
  ds_read_b64_tr_b16 v[208:209], v2 offset:6144
  ds_read_b64_tr_b16 v[210:211], v2 offset:6400
  ds_read_b64_tr_b16 v[212:213], v2 offset:6176
  ds_read_b64_tr_b16 v[214:215], v2 offset:6432
  s_waitcnt lgkmcnt(4)
  s_add_u32 m0, s22, 5120
  s_add_u32 s31, s27, 294912
  buffer_load_dwordx4 v4, s[32:35], s31 offen lds
  s_add_u32 m0, s22, 21536
  s_add_u32 s31, s27, 299008
  buffer_load_dwordx4 v4, s[32:35], s31 offen lds
  s_waitcnt vmcnt(26)
  ds_read_b64_tr_b16 v[216:217], v2 offset:7168
  ds_read_b64_tr_b16 v[218:219], v2 offset:7424
  ds_read_b64_tr_b16 v[220:221], v2 offset:7200
  ds_read_b64_tr_b16 v[222:223], v2 offset:7456
  s_waitcnt lgkmcnt(4)
  s_add_u32 m0, s22, 6144
  s_add_u32 s31, s27, 327680
  buffer_load_dwordx4 v4, s[32:35], s31 offen lds
  s_add_u32 m0, s22, 22560
  s_add_u32 s31, s27, 331776
  buffer_load_dwordx4 v4, s[32:35], s31 offen lds
  s_waitcnt vmcnt(26)
  ds_read_b64_tr_b16 v[224:225], v2 offset:8192
  ds_read_b64_tr_b16 v[226:227], v2 offset:8448
  ds_read_b64_tr_b16 v[228:229], v2 offset:8224
  ds_read_b64_tr_b16 v[230:231], v2 offset:8480
  s_waitcnt lgkmcnt(4)
  s_add_u32 m0, s22, 7168
  s_add_u32 s31, s27, 360448
  buffer_load_dwordx4 v4, s[32:35], s31 offen lds
  s_add_u32 m0, s22, 23584
  s_add_u32 s31, s27, 364544
  buffer_load_dwordx4 v4, s[32:35], s31 offen lds
  s_waitcnt vmcnt(26)
  ds_read_b64_tr_b16 v[232:233], v2 offset:9216
  ds_read_b64_tr_b16 v[234:235], v2 offset:9472
  ds_read_b64_tr_b16 v[236:237], v2 offset:9248
  ds_read_b64_tr_b16 v[238:239], v2 offset:9504
  s_waitcnt lgkmcnt(4)
  s_add_u32 m0, s22, 8192
  s_add_u32 s31, s27, 393216
  buffer_load_dwordx4 v4, s[32:35], s31 offen lds
  s_add_u32 m0, s22, 24608
  s_add_u32 s31, s27, 397312
  buffer_load_dwordx4 v4, s[32:35], s31 offen lds
  s_waitcnt vmcnt(26)
  ds_read_b64_tr_b16 v[240:241], v2 offset:10240
  ds_read_b64_tr_b16 v[242:243], v2 offset:10496
  ds_read_b64_tr_b16 v[244:245], v2 offset:10272
  ds_read_b64_tr_b16 v[246:247], v2 offset:10528
  s_waitcnt lgkmcnt(4)
  s_add_u32 m0, s22, 9216
  s_add_u32 s31, s27, 425984
  buffer_load_dwordx4 v4, s[32:35], s31 offen lds
  s_add_u32 m0, s22, 25632
  s_add_u32 s31, s27, 430080
  buffer_load_dwordx4 v4, s[32:35], s31 offen lds
  s_waitcnt vmcnt(26)
  ds_read_b64_tr_b16 a[0:1], v2 offset:11264
  ds_read_b64_tr_b16 a[2:3], v2 offset:11520
  ds_read_b64_tr_b16 a[4:5], v2 offset:11296
  ds_read_b64_tr_b16 a[6:7], v2 offset:11552
  s_waitcnt lgkmcnt(4)
  s_add_u32 m0, s22, 10240
  s_add_u32 s31, s27, 458752
  buffer_load_dwordx4 v4, s[32:35], s31 offen lds
  s_add_u32 m0, s22, 26656
  s_add_u32 s31, s27, 462848
  buffer_load_dwordx4 v4, s[32:35], s31 offen lds
  s_waitcnt vmcnt(26)
  ds_read_b64_tr_b16 a[8:9], v2 offset:12288
  ds_read_b64_tr_b16 a[10:11], v2 offset:12544
  ds_read_b64_tr_b16 a[12:13], v2 offset:12320
  ds_read_b64_tr_b16 a[14:15], v2 offset:12576
  s_waitcnt lgkmcnt(4)
  s_add_u32 m0, s22, 11264
  s_add_u32 s31, s27, 491520
  buffer_load_dwordx4 v4, s[32:35], s31 offen lds
  s_add_u32 m0, s22, 27680
  s_add_u32 s31, s27, 495616
  buffer_load_dwordx4 v4, s[32:35], s31 offen lds
  s_waitcnt vmcnt(26)
  ds_read_b64_tr_b16 a[16:17], v2 offset:13312
  ds_read_b64_tr_b16 a[18:19], v2 offset:13568
  ds_read_b64_tr_b16 a[20:21], v2 offset:13344
  ds_read_b64_tr_b16 a[22:23], v2 offset:13600
  s_waitcnt lgkmcnt(4)
  s_add_u32 m0, s22, 12288
  s_add_u32 s31, s27, 524288
  buffer_load_dwordx4 v4, s[32:35], s31 offen lds
  s_add_u32 m0, s22, 28704
  s_add_u32 s31, s27, 528384
  buffer_load_dwordx4 v4, s[32:35], s31 offen lds
  s_waitcnt vmcnt(26)
  ds_read_b64_tr_b16 a[24:25], v2 offset:14336
  ds_read_b64_tr_b16 a[26:27], v2 offset:14592
  ds_read_b64_tr_b16 a[28:29], v2 offset:14368
  ds_read_b64_tr_b16 a[30:31], v2 offset:14624
  s_waitcnt lgkmcnt(4)
  s_add_u32 m0, s22, 13312
  s_add_u32 s31, s27, 557056
  buffer_load_dwordx4 v4, s[32:35], s31 offen lds
  s_add_u32 m0, s22, 29728
  s_add_u32 s31, s27, 561152
  buffer_load_dwordx4 v4, s[32:35], s31 offen lds
  s_waitcnt vmcnt(26)
  ds_read_b64_tr_b16 a[32:33], v2 offset:0
  ds_read_b64_tr_b16 a[34:35], v2 offset:256
  ds_read_b64_tr_b16 a[36:37], v2 offset:32
  ds_read_b64_tr_b16 a[38:39], v2 offset:288
  s_waitcnt lgkmcnt(4)
  s_add_u32 m0, s22, 14336
  s_add_u32 s31, s27, 589824
  buffer_load_dwordx4 v4, s[32:35], s31 offen lds
  s_add_u32 m0, s22, 30752
  s_add_u32 s31, s27, 593920
  buffer_load_dwordx4 v4, s[32:35], s31 offen lds
  s_waitcnt vmcnt(26)
  ds_read_b64_tr_b16 a[40:41], v2 offset:1024
  ds_read_b64_tr_b16 a[42:43], v2 offset:1280
  ds_read_b64_tr_b16 a[44:45], v2 offset:1056
  ds_read_b64_tr_b16 a[46:47], v2 offset:1312
  s_waitcnt lgkmcnt(4)
  s_add_u32 m0, s22, 0
  s_add_u32 s31, s27, 622592
  buffer_load_dwordx4 v4, s[32:35], s31 offen lds
  s_add_u32 m0, s22, 16416
  s_add_u32 s31, s27, 626688
  buffer_load_dwordx4 v4, s[32:35], s31 offen lds
  s_waitcnt vmcnt(26)
  ds_read_b64_tr_b16 a[48:49], v2 offset:2048
  ds_read_b64_tr_b16 a[50:51], v2 offset:2304
  ds_read_b64_tr_b16 a[52:53], v2 offset:2080
  ds_read_b64_tr_b16 a[54:55], v2 offset:2336
  s_waitcnt lgkmcnt(4)
  s_add_u32 m0, s22, 1024
  s_add_u32 s31, s27, 655360
  buffer_load_dwordx4 v4, s[32:35], s31 offen lds
  s_add_u32 m0, s22, 17440
  s_add_u32 s31, s27, 659456
  buffer_load_dwordx4 v4, s[32:35], s31 offen lds
  s_waitcnt vmcnt(26)
  ds_read_b64_tr_b16 a[56:57], v2 offset:3072
  ds_read_b64_tr_b16 a[58:59], v2 offset:3328
  ds_read_b64_tr_b16 a[60:61], v2 offset:3104
  ds_read_b64_tr_b16 a[62:63], v2 offset:3360
  s_waitcnt lgkmcnt(4)
  s_add_u32 m0, s22, 2048
  s_add_u32 s31, s27, 688128
  buffer_load_dwordx4 v4, s[32:35], s31 offen lds
  s_add_u32 m0, s22, 18464
  s_add_u32 s31, s27, 692224
  buffer_load_dwordx4 v4, s[32:35], s31 offen lds
  s_waitcnt vmcnt(26)
  ds_read_b64_tr_b16 a[64:65], v2 offset:4096
  ds_read_b64_tr_b16 a[66:67], v2 offset:4352
  ds_read_b64_tr_b16 a[68:69], v2 offset:4128
  ds_read_b64_tr_b16 a[70:71], v2 offset:4384
  s_waitcnt lgkmcnt(4)
  s_add_u32 m0, s22, 3072
  s_add_u32 s31, s27, 720896
  buffer_load_dwordx4 v4, s[32:35], s31 offen lds
  s_add_u32 m0, s22, 19488
  s_add_u32 s31, s27, 724992
  buffer_load_dwordx4 v4, s[32:35], s31 offen lds
  s_waitcnt vmcnt(26)
  ds_read_b64_tr_b16 a[72:73], v2 offset:5120
  ds_read_b64_tr_b16 a[74:75], v2 offset:5376
  ds_read_b64_tr_b16 a[76:77], v2 offset:5152
  ds_read_b64_tr_b16 a[78:79], v2 offset:5408
  s_waitcnt lgkmcnt(4)
  s_add_u32 m0, s22, 4096
  s_add_u32 s31, s27, 753664
  buffer_load_dwordx4 v4, s[32:35], s31 offen lds
  s_add_u32 m0, s22, 20512
  s_add_u32 s31, s27, 757760
  buffer_load_dwordx4 v4, s[32:35], s31 offen lds
  s_waitcnt vmcnt(26)
  ds_read_b64_tr_b16 a[80:81], v2 offset:6144
  ds_read_b64_tr_b16 a[82:83], v2 offset:6400
  ds_read_b64_tr_b16 a[84:85], v2 offset:6176
  ds_read_b64_tr_b16 a[86:87], v2 offset:6432
  s_waitcnt lgkmcnt(4)
  s_add_u32 m0, s22, 5120
  s_add_u32 s31, s27, 786432
  buffer_load_dwordx4 v4, s[32:35], s31 offen lds
  s_add_u32 m0, s22, 21536
  s_add_u32 s31, s27, 790528
  buffer_load_dwordx4 v4, s[32:35], s31 offen lds
  s_waitcnt vmcnt(26)
  ds_read_b64_tr_b16 a[88:89], v2 offset:7168
  ds_read_b64_tr_b16 a[90:91], v2 offset:7424
  ds_read_b64_tr_b16 a[92:93], v2 offset:7200
  ds_read_b64_tr_b16 a[94:95], v2 offset:7456
  s_waitcnt lgkmcnt(4)
  s_add_u32 m0, s22, 6144
  s_add_u32 s31, s27, 819200
  buffer_load_dwordx4 v4, s[32:35], s31 offen lds
  s_add_u32 m0, s22, 22560
  s_add_u32 s31, s27, 823296
  buffer_load_dwordx4 v4, s[32:35], s31 offen lds
  s_waitcnt vmcnt(26)
  ds_read_b64_tr_b16 a[96:97], v2 offset:8192
  ds_read_b64_tr_b16 a[98:99], v2 offset:8448
  ds_read_b64_tr_b16 a[100:101], v2 offset:8224
  ds_read_b64_tr_b16 a[102:103], v2 offset:8480
  s_waitcnt lgkmcnt(4)
  s_add_u32 m0, s22, 7168
  s_add_u32 s31, s27, 851968
  buffer_load_dwordx4 v4, s[32:35], s31 offen lds
  s_add_u32 m0, s22, 23584
  s_add_u32 s31, s27, 856064
  buffer_load_dwordx4 v4, s[32:35], s31 offen lds
  s_waitcnt vmcnt(26)
  ds_read_b64_tr_b16 a[104:105], v2 offset:9216
  ds_read_b64_tr_b16 a[106:107], v2 offset:9472
  ds_read_b64_tr_b16 a[108:109], v2 offset:9248
  ds_read_b64_tr_b16 a[110:111], v2 offset:9504
  s_waitcnt lgkmcnt(4)
  s_add_u32 m0, s22, 8192
  s_add_u32 s31, s27, 884736
  buffer_load_dwordx4 v4, s[32:35], s31 offen lds
  s_add_u32 m0, s22, 24608
  s_add_u32 s31, s27, 888832
  buffer_load_dwordx4 v4, s[32:35], s31 offen lds
  s_waitcnt vmcnt(26)
  ds_read_b64_tr_b16 a[112:113], v2 offset:10240
  ds_read_b64_tr_b16 a[114:115], v2 offset:10496
  ds_read_b64_tr_b16 a[116:117], v2 offset:10272
  ds_read_b64_tr_b16 a[118:119], v2 offset:10528
  s_waitcnt lgkmcnt(4)
  s_add_u32 m0, s22, 9216
  s_add_u32 s31, s27, 917504
  buffer_load_dwordx4 v4, s[32:35], s31 offen lds
  s_add_u32 m0, s22, 25632
  s_add_u32 s31, s27, 921600
  buffer_load_dwordx4 v4, s[32:35], s31 offen lds
  s_waitcnt vmcnt(26)
  ds_read_b64_tr_b16 a[120:121], v2 offset:11264
  ds_read_b64_tr_b16 a[122:123], v2 offset:11520
  ds_read_b64_tr_b16 a[124:125], v2 offset:11296
  ds_read_b64_tr_b16 a[126:127], v2 offset:11552
  s_waitcnt lgkmcnt(4)
  s_add_u32 m0, s22, 10240
  s_add_u32 s31, s27, 950272
  buffer_load_dwordx4 v4, s[32:35], s31 offen lds
  s_add_u32 m0, s22, 26656
  s_add_u32 s31, s27, 954368
  buffer_load_dwordx4 v4, s[32:35], s31 offen lds
  s_waitcnt vmcnt(26)
  ds_read_b64_tr_b16 a[128:129], v2 offset:12288
  ds_read_b64_tr_b16 a[130:131], v2 offset:12544
  ds_read_b64_tr_b16 a[132:133], v2 offset:12320
  ds_read_b64_tr_b16 a[134:135], v2 offset:12576
  s_waitcnt lgkmcnt(4)
  s_add_u32 m0, s22, 11264
  s_add_u32 s31, s27, 983040
  buffer_load_dwordx4 v4, s[32:35], s31 offen lds
  s_add_u32 m0, s22, 27680
  s_add_u32 s31, s27, 987136
  buffer_load_dwordx4 v4, s[32:35], s31 offen lds
  s_waitcnt vmcnt(26)
  ds_read_b64_tr_b16 a[136:137], v2 offset:13312
  ds_read_b64_tr_b16 a[138:139], v2 offset:13568
  ds_read_b64_tr_b16 a[140:141], v2 offset:13344
  ds_read_b64_tr_b16 a[142:143], v2 offset:13600
  s_waitcnt lgkmcnt(4)
  s_add_u32 m0, s22, 12288
  s_add_u32 s31, s27, 1015808
  buffer_load_dwordx4 v4, s[32:35], s31 offen lds
  s_add_u32 m0, s22, 28704
  s_add_u32 s31, s27, 1019904
  buffer_load_dwordx4 v4, s[32:35], s31 offen lds
  s_waitcnt vmcnt(26)
  ds_read_b64_tr_b16 a[144:145], v2 offset:14336
  ds_read_b64_tr_b16 a[146:147], v2 offset:14592
  ds_read_b64_tr_b16 a[148:149], v2 offset:14368
  ds_read_b64_tr_b16 a[150:151], v2 offset:14624
  s_waitcnt vmcnt(24)
  ds_read_b64_tr_b16 a[152:153], v2 offset:0
  ds_read_b64_tr_b16 a[154:155], v2 offset:256
  ds_read_b64_tr_b16 a[156:157], v2 offset:32
  ds_read_b64_tr_b16 a[158:159], v2 offset:288
  s_waitcnt vmcnt(22)
  ds_read_b64_tr_b16 a[160:161], v2 offset:1024
  ds_read_b64_tr_b16 a[162:163], v2 offset:1280
  ds_read_b64_tr_b16 a[164:165], v2 offset:1056
  ds_read_b64_tr_b16 a[166:167], v2 offset:1312
  s_waitcnt vmcnt(20)
  ds_read_b64_tr_b16 a[168:169], v2 offset:2048
  ds_read_b64_tr_b16 a[170:171], v2 offset:2304
  ds_read_b64_tr_b16 a[172:173], v2 offset:2080
  ds_read_b64_tr_b16 a[174:175], v2 offset:2336
  s_waitcnt vmcnt(18)
  ds_read_b64_tr_b16 a[176:177], v2 offset:3072
  ds_read_b64_tr_b16 a[178:179], v2 offset:3328
  ds_read_b64_tr_b16 a[180:181], v2 offset:3104
  ds_read_b64_tr_b16 a[182:183], v2 offset:3360
  s_waitcnt vmcnt(16)
  ds_read_b64_tr_b16 a[184:185], v2 offset:4096
  ds_read_b64_tr_b16 a[186:187], v2 offset:4352
  ds_read_b64_tr_b16 a[188:189], v2 offset:4128
  ds_read_b64_tr_b16 a[190:191], v2 offset:4384
  s_waitcnt vmcnt(14)
  ds_read_b64_tr_b16 a[192:193], v2 offset:5120
  ds_read_b64_tr_b16 a[194:195], v2 offset:5376
  ds_read_b64_tr_b16 a[196:197], v2 offset:5152
  ds_read_b64_tr_b16 a[198:199], v2 offset:5408
  s_waitcnt vmcnt(12)
  ds_read_b64_tr_b16 a[200:201], v2 offset:6144
  ds_read_b64_tr_b16 a[202:203], v2 offset:6400
  ds_read_b64_tr_b16 a[204:205], v2 offset:6176
  ds_read_b64_tr_b16 a[206:207], v2 offset:6432
  s_waitcnt vmcnt(10)
  ds_read_b64_tr_b16 a[208:209], v2 offset:7168
  ds_read_b64_tr_b16 a[210:211], v2 offset:7424
  ds_read_b64_tr_b16 a[212:213], v2 offset:7200
  ds_read_b64_tr_b16 a[214:215], v2 offset:7456
  s_waitcnt vmcnt(8)
  ds_read_b64_tr_b16 a[216:217], v2 offset:8192
  ds_read_b64_tr_b16 a[218:219], v2 offset:8448
  ds_read_b64_tr_b16 a[220:221], v2 offset:8224
  ds_read_b64_tr_b16 a[222:223], v2 offset:8480
  s_waitcnt vmcnt(6)
  ds_read_b64_tr_b16 a[224:225], v2 offset:9216
  ds_read_b64_tr_b16 a[226:227], v2 offset:9472
  ds_read_b64_tr_b16 a[228:229], v2 offset:9248
  ds_read_b64_tr_b16 a[230:231], v2 offset:9504
  s_waitcnt vmcnt(4)
  ds_read_b64_tr_b16 a[232:233], v2 offset:10240
  ds_read_b64_tr_b16 a[234:235], v2 offset:10496
  ds_read_b64_tr_b16 a[236:237], v2 offset:10272
  ds_read_b64_tr_b16 a[238:239], v2 offset:10528
  s_waitcnt vmcnt(2)
  ds_read_b64_tr_b16 a[240:241], v2 offset:11264
  ds_read_b64_tr_b16 a[242:243], v2 offset:11520
  ds_read_b64_tr_b16 a[244:245], v2 offset:11296
  ds_read_b64_tr_b16 a[246:247], v2 offset:11552
  s_waitcnt vmcnt(0)
  ds_read_b64_tr_b16 a[248:249], v2 offset:12288
  ds_read_b64_tr_b16 a[250:251], v2 offset:12544
  ds_read_b64_tr_b16 a[252:253], v2 offset:12320
  ds_read_b64_tr_b16 a[254:255], v2 offset:12576
  s_waitcnt vmcnt(0) lgkmcnt(0)
  s_cmp_lg_u32 s20, 3
  s_cbranch_scc1 P4_nz
  v_mov_b32 v240, 0
  v_mov_b32 v241, 0
  v_mov_b32 v242, 0
  v_mov_b32 v243, 0
  v_mov_b32 v244, 0
  v_mov_b32 v245, 0
  v_mov_b32 v246, 0
  v_mov_b32 v247, 0
P4_nz:
  s_lshl_b32 s24, s20, 10
  v_add_u32 v248, s24, v1
  s_add_u32 s24, s24, 0x10000
  v_add_u32 v250, s24, v1
  s_and_b32 s24, s20, 1
  s_lshr_b32 s25, s20, 1
  s_lshl_b32 s26, s24, 12
  s_lshl_b32 s27, s25, 3
  s_add_u32 s26, s26, s27
  v_add_u32 v13, s26, v1
  v_and_b32 v9, 15, v0
  v_lshlrev_b32 v9, 10, v9
  v_lshrrev_b32 v10, 4, v0
  v_lshl_add_u32 v249, v10, 3, v9
  s_lshl_b32 s24, s24, 5
  s_lshl_b32 s25, s25, 2
  s_add_u32 s24, s24, s25
  s_lshl_b32 s25, s58, 6
  s_add_u32 s24, s24, s25
  v_add_u32 v249, s24, v249
  s_barrier
  s_mov_b32 s81, s59
  v_mov_b32 v14, v250
P4b_top:
  s_lshr_b32 s25, s81, 1
  s_mul_i32 s24, s25, 3277
  s_lshr_b32 s24, s24, 16
  s_mul_i32 s24, s24, 20
  s_sub_u32 s24, s25, s24
  s_lshl_b32 s24, s24, 7
  s_add_u32 s24, s24, 51388416
  v_min_u32 v11, 10, v0
  v_lshlrev_b32 v11, 2, v11
P4b_poll:
  s_add_u32 s79, s79, 1
  s_cmp_gt_u32 s79, 524288
  s_cbranch_scc1 L_exit
  buffer_load_dword v12, v11, s[8:11], s24 offen sc1
  s_waitcnt vmcnt(0)
  v_cmp_gt_u32 vcc, 1, v12
  s_cbranch_vccnz P4b_poll
  s_lshl_b32 s29, s81, 14
  s_mul_i32 s24, s81, 43
  s_mul_i32 s25, s20, 11
  s_add_u32 s26, s25, 10
  s_min_u32 s26, s26, 42
  s_add_u32 s30, s24, s25
  s_lshl_b32 s30, s30, 10
  s_add_u32 s30, s30, 100663296
  s_add_u32 s27, s24, s26
  s_lshl_b32 s27, s27, 10
  s_add_u32 s27, s27, 100663296
  buffer_load_dwordx4 v[16:19], v5, s[36:39], s29 offen offset:0
  buffer_load_dwordx4 v[20:23], v5, s[36:39], s29 offen offset:64
  buffer_load_dwordx4 v[24:27], v5, s[36:39], s29 offen offset:128
  buffer_load_dwordx4 v[28:31], v5, s[36:39], s29 offen offset:192
  s_add_u32 s31, s30, 0
  buffer_load_dwordx4 v[32:35], v1, s[8:11], s31 offen
  s_add_u32 s31, s30, 1024
  buffer_load_dwordx4 v[36:39], v1, s[8:11], s31 offen
  s_add_u32 s31, s30, 2048
  buffer_load_dwordx4 v[40:43], v1, s[8:11], s31 offen
  s_add_u32 s31, s30, 3072
  buffer_load_dwordx4 v[44:47], v1, s[8:11], s31 offen
  s_add_u32 s31, s30, 4096
  buffer_load_dwordx4 v[48:51], v1, s[8:11], s31 offen
  s_add_u32 s31, s30, 5120
  buffer_load_dwordx4 v[52:55], v1, s[8:11], s31 offen
  s_add_u32 s31, s30, 6144
  buffer_load_dwordx4 v[56:59], v1, s[8:11], s31 offen
  s_add_u32 s31, s30, 7168
  buffer_load_dwordx4 v[60:63], v1, s[8:11], s31 offen
  s_add_u32 s31, s30, 8192
  buffer_load_dwordx4 v[64:67], v1, s[8:11], s31 offen
  s_add_u32 s31, s30, 9216
  buffer_load_dwordx4 v[68:71], v1, s[8:11], s31 offen
  s_add_u32 s31, s27, 0
  buffer_load_dwordx4 v[72:75], v1, s[8:11], s31 offen
  s_waitcnt vmcnt(14)
  v_mfma_f32_16x16x32_bf16 v[156:159], v[128:131], v[16:19], 0
  s_waitcnt vmcnt(13)
  v_mfma_f32_16x16x32_bf16 v[156:159], v[132:135], v[20:23], v[156:159]
  s_waitcnt vmcnt(12)
  v_mfma_f32_16x16x32_bf16 v[156:159], v[136:139], v[24:27], v[156:159]
  s_waitcnt vmcnt(11)
  v_mfma_f32_16x16x32_bf16 v[156:159], v[140:143], v[28:31], v[156:159]
  s_waitcnt vmcnt(10)
  v_mfma_f32_16x16x32_bf16 v[148:151], v[160:163], v[32:35], 0
  v_mfma_f32_16x16x32_bf16 v[152:155], v[164:167], v[32:35], 0
  s_waitcnt vmcnt(9)
  v_mfma_f32_16x16x32_bf16 v[148:151], v[168:171], v[36:39], v[148:151]
  v_mfma_f32_16x16x32_bf16 v[152:155], v[172:175], v[36:39], v[152:155]
  s_waitcnt vmcnt(8)
  v_mfma_f32_16x16x32_bf16 v[148:151], v[176:179], v[40:43], v[148:151]
  v_mfma_f32_16x16x32_bf16 v[152:155], v[180:183], v[40:43], v[152:155]
  s_waitcnt vmcnt(7)
  v_mfma_f32_16x16x32_bf16 v[148:151], v[184:187], v[44:47], v[148:151]
  v_mfma_f32_16x16x32_bf16 v[152:155], v[188:191], v[44:47], v[152:155]
  s_waitcnt vmcnt(6)
  v_mfma_f32_16x16x32_bf16 v[148:151], v[192:195], v[48:51], v[148:151]
  v_mfma_f32_16x16x32_bf16 v[152:155], v[196:199], v[48:51], v[152:155]
  s_waitcnt vmcnt(5)
  v_mfma_f32_16x16x32_bf16 v[148:151], v[200:203], v[52:55], v[148:151]
  v_mfma_f32_16x16x32_bf16 v[152:155], v[204:207], v[52:55], v[152:155]
  s_waitcnt vmcnt(4)
  v_mfma_f32_16x16x32_bf16 v[148:151], v[208:211], v[56:59], v[148:151]
  v_mfma_f32_16x16x32_bf16 v[152:155], v[212:215], v[56:59], v[152:155]
  s_waitcnt vmcnt(3)
  v_mfma_f32_16x16x32_bf16 v[148:151], v[216:219], v[60:63], v[148:151]
  v_mfma_f32_16x16x32_bf16 v[152:155], v[220:223], v[60:63], v[152:155]
  s_waitcnt vmcnt(2)
  v_mfma_f32_16x16x32_bf16 v[148:151], v[224:227], v[64:67], v[148:151]
  v_mfma_f32_16x16x32_bf16 v[152:155], v[228:231], v[64:67], v[152:155]
  s_waitcnt vmcnt(1)
  v_mfma_f32_16x16x32_bf16 v[148:151], v[232:235], v[68:71], v[148:151]
  v_mfma_f32_16x16x32_bf16 v[152:155], v[236:239], v[68:71], v[152:155]
  s_waitcnt vmcnt(0)
  v_mfma_f32_16x16x32_bf16 v[148:151], v[240:243], v[72:75], v[148:151]
  v_mfma_f32_16x16x32_bf16 v[152:155], v[244:247], v[72:75], v[152:155]
  s_nop 3
  ds_write_b128 v248, v[148:151] offset:0
  s_nop 2
  ds_write_b128 v248, v[152:155] offset:4096
  s_mul_i32 s24, s20, 1020
  v_subrev_u32 v10, s24, v248
  ds_write_b32 v10, v156 offset:16384
  v_and_b32 v11, -16, v10
  s_waitcnt lgkmcnt(0)
  s_barrier
  ds_read_b64 v[148:149], v13 offset:0
  ds_read_b64 v[150:151], v13 offset:1024
  ds_read_b64 v[152:153], v13 offset:2048
  ds_read_b64 v[154:155], v13 offset:3072
  ds_read_b128 v[156:159], v11 offset:16384
  v_xor_b32 v248, 0x8000, v248
  v_xor_b32 v13, 0x8000, v13
  s_waitcnt lgkmcnt(3)
  v_add_f32 v148, v148, v150
  s_waitcnt lgkmcnt(1)
  v_add_f32 v152, v152, v154
  v_add_f32 v149, v149, v151
  v_add_f32 v153, v153, v155
  v_add_f32 v148, v148, v152
  v_add_f32 v149, v149, v153
  s_waitcnt lgkmcnt(0)
  v_add_f32 v156, v156, v157
  v_add_f32 v158, v158, v159
  v_add_f32 v156, v156, v158
  v_mul_f32 v156, 0xbfb8aa3b, v156
  v_exp_f32 v156, v156
  s_nop 0
  v_add_f32 v156, 1.0, v156
  v_rcp_f32 v150, v156
  s_nop 0
  v_sub_f32 v157, 1.0, v150
  v_mul_f32 v148, v148, v157
  v_mul_f32 v149, v149, v157
  ds_write_b128 v14, v[148:151]
  v_add_u32 v14, 0x1000, v14
  s_add_u32 s81, s81, 10
  s_cmp_lt_u32 s81, 126
  s_cbranch_scc1 P4b_top
  s_cmp_ge_u32 s81, 136
  s_cbranch_scc1 P4b_end
  s_sub_u32 s78, s59, 6
  s_and_b32 s81, s78, 1
  s_add_u32 s81, s81, 126
  s_cmp_ge_u32 s59, 6
  s_cbranch_scc1 P4b_top
P4b_end:
  s_mov_b32 s81, s59
P4a_top:
  s_lshl_b32 s24, s81, 8
  s_add_u32 s24, s24, 51412992
  s_lshl_b32 s29, s81, 17
  s_lshl_b32 s25, s20, 15
  s_add_u32 s29, s29, s25
  s_add_u32 s29, s29, 83886080
  s_lshl_b32 s25, s81, 13
  s_add_u32 s25, s25, 117473280
  s_cmp_ge_u32 s81, 124
  s_cselect_b32 s24, s25, s24
  s_cselect_b32 s26, 7, 2
  s_cmp_lg_u32 s20, 0
  s_cbranch_scc1 P4a_poll_b
  v_min_u32 v11, 63, v0
  v_lshlrev_b32 v11, s26, v11
P4a_poll:
  s_add_u32 s79, s79, 1
  s_cmp_gt_u32 s79, 524288
  s_cbranch_scc1 L_exit
  buffer_load_dword v12, v11, s[8:11], s24 offen sc1
  s_waitcnt vmcnt(0)
  v_cmp_gt_u32 vcc, 1, v12
  s_cbranch_vccnz P4a_poll
P4a_poll_b:
  s_barrier
  s_add_u32 s31, s29, 0
  buffer_load_dwordx4 v[16:19], v1, s[8:11], s31 offen offset:0
  buffer_load_dwordx4 v[20:23], v1, s[8:11], s31 offen offset:1024
  buffer_load_dwordx4 v[24:27], v1, s[8:11], s31 offen offset:2048
  buffer_load_dwordx4 v[28:31], v1, s[8:11], s31 offen offset:3072
  s_add_u32 s31, s29, 4096
  buffer_load_dwordx4 v[32:35], v1, s[8:11], s31 offen offset:0
  buffer_load_dwordx4 v[36:39], v1, s[8:11], s31 offen offset:1024
  buffer_load_dwordx4 v[40:43], v1, s[8:11], s31 offen offset:2048
  buffer_load_dwordx4 v[44:47], v1, s[8:11], s31 offen offset:3072
  s_add_u32 s31, s29, 8192
  buffer_load_dwordx4 v[48:51], v1, s[8:11], s31 offen offset:0
  buffer_load_dwordx4 v[52:55], v1, s[8:11], s31 offen offset:1024
  buffer_load_dwordx4 v[56:59], v1, s[8:11], s31 offen offset:2048
  buffer_load_dwordx4 v[60:63], v1, s[8:11], s31 offen offset:3072
  s_add_u32 s31, s29, 12288
  buffer_load_dwordx4 v[64:67], v1, s[8:11], s31 offen offset:0
  buffer_load_dwordx4 v[68:71], v1, s[8:11], s31 offen offset:1024
  buffer_load_dwordx4 v[72:75], v1, s[8:11], s31 offen offset:2048
  buffer_load_dwordx4 v[76:79], v1, s[8:11], s31 offen offset:3072
  s_add_u32 s31, s29, 16384
  buffer_load_dwordx4 v[80:83], v1, s[8:11], s31 offen offset:0
  buffer_load_dwordx4 v[84:87], v1, s[8:11], s31 offen offset:1024
  buffer_load_dwordx4 v[88:91], v1, s[8:11], s31 offen offset:2048
  buffer_load_dwordx4 v[92:95], v1, s[8:11], s31 offen offset:3072
  s_add_u32 s31, s29, 20480
  buffer_load_dwordx4 v[96:99], v1, s[8:11], s31 offen offset:0
  buffer_load_dwordx4 v[100:103], v1, s[8:11], s31 offen offset:1024
  buffer_load_dwordx4 v[104:107], v1, s[8:11], s31 offen offset:2048
  buffer_load_dwordx4 v[108:111], v1, s[8:11], s31 offen offset:3072
  s_add_u32 s31, s29, 24576
  buffer_load_dwordx4 v[112:115], v1, s[8:11], s31 offen offset:0
  buffer_load_dwordx4 v[116:119], v1, s[8:11], s31 offen offset:1024
  buffer_load_dwordx4 v[120:123], v1, s[8:11], s31 offen offset:2048
  buffer_load_dwordx4 v[124:127], v1, s[8:11], s31 offen offset:3072
  s_add_u32 s31, s29, 28672
  buffer_load_dwordx4 v[128:131], v1, s[8:11], s31 offen offset:0
  buffer_load_dwordx4 v[132:135], v1, s[8:11], s31 offen offset:1024
  buffer_load_dwordx4 v[136:139], v1, s[8:11], s31 offen offset:2048
  buffer_load_dwordx4 v[140:143], v1, s[8:11], s31 offen offset:3072
  s_waitcnt vmcnt(31)
  v_mfma_f32_16x16x32_bf16 v[148:151], a[0:3], v[16:19], 0
  v_mfma_f32_16x16x32_bf16 v[152:155], a[4:7], v[16:19], 0
  s_waitcnt vmcnt(30)
  v_mfma_f32_16x16x32_bf16 v[148:151], a[8:11], v[20:23], v[148:151]
  v_mfma_f32_16x16x32_bf16 v[152:155], a[12:15], v[20:23], v[152:155]
  s_waitcnt vmcnt(29)
  v_mfma_f32_16x16x32_bf16 v[148:151], a[16:19], v[24:27], v[148:151]
  v_mfma_f32_16x16x32_bf16 v[152:155], a[20:23], v[24:27], v[152:155]
  s_waitcnt vmcnt(28)
  v_mfma_f32_16x16x32_bf16 v[148:151], a[24:27], v[28:31], v[148:151]
  v_mfma_f32_16x16x32_bf16 v[152:155], a[28:31], v[28:31], v[152:155]
  s_waitcnt vmcnt(27)
  v_mfma_f32_16x16x32_bf16 v[148:151], a[32:35], v[32:35], v[148:151]
  v_mfma_f32_16x16x32_bf16 v[152:155], a[36:39], v[32:35], v[152:155]
  s_waitcnt vmcnt(26)
  v_mfma_f32_16x16x32_bf16 v[148:151], a[40:43], v[36:39], v[148:151]
  v_mfma_f32_16x16x32_bf16 v[152:155], a[44:47], v[36:39], v[152:155]
  s_waitcnt vmcnt(25)
  v_mfma_f32_16x16x32_bf16 v[148:151], a[48:51], v[40:43], v[148:151]
  v_mfma_f32_16x16x32_bf16 v[152:155], a[52:55], v[40:43], v[152:155]
  s_waitcnt vmcnt(24)
  v_mfma_f32_16x16x32_bf16 v[148:151], a[56:59], v[44:47], v[148:151]
  v_mfma_f32_16x16x32_bf16 v[152:155], a[60:63], v[44:47], v[152:155]
  s_waitcnt vmcnt(23)
  v_mfma_f32_16x16x32_bf16 v[148:151], a[64:67], v[48:51], v[148:151]
  v_mfma_f32_16x16x32_bf16 v[152:155], a[68:71], v[48:51], v[152:155]
  s_waitcnt vmcnt(22)
  v_mfma_f32_16x16x32_bf16 v[148:151], a[72:75], v[52:55], v[148:151]
  v_mfma_f32_16x16x32_bf16 v[152:155], a[76:79], v[52:55], v[152:155]
  s_waitcnt vmcnt(21)
  v_mfma_f32_16x16x32_bf16 v[148:151], a[80:83], v[56:59], v[148:151]
  v_mfma_f32_16x16x32_bf16 v[152:155], a[84:87], v[56:59], v[152:155]
  s_waitcnt vmcnt(20)
  v_mfma_f32_16x16x32_bf16 v[148:151], a[88:91], v[60:63], v[148:151]
  v_mfma_f32_16x16x32_bf16 v[152:155], a[92:95], v[60:63], v[152:155]
  s_waitcnt vmcnt(19)
  v_mfma_f32_16x16x32_bf16 v[148:151], a[96:99], v[64:67], v[148:151]
  v_mfma_f32_16x16x32_bf16 v[152:155], a[100:103], v[64:67], v[152:155]
  s_waitcnt vmcnt(18)
  v_mfma_f32_16x16x32_bf16 v[148:151], a[104:107], v[68:71], v[148:151]
  v_mfma_f32_16x16x32_bf16 v[152:155], a[108:111], v[68:71], v[152:155]
  s_waitcnt vmcnt(17)
  v_mfma_f32_16x16x32_bf16 v[148:151], a[112:115], v[72:75], v[148:151]
  v_mfma_f32_16x16x32_bf16 v[152:155], a[116:119], v[72:75], v[152:155]
  s_waitcnt vmcnt(16)
  v_mfma_f32_16x16x32_bf16 v[148:151], a[120:123], v[76:79], v[148:151]
  v_mfma_f32_16x16x32_bf16 v[152:155], a[124:127], v[76:79], v[152:155]
  s_waitcnt vmcnt(15)
  v_mfma_f32_16x16x32_bf16 v[148:151], a[128:131], v[80:83], v[148:151]
  v_mfma_f32_16x16x32_bf16 v[152:155], a[132:135], v[80:83], v[152:155]
  s_waitcnt vmcnt(14)
  v_mfma_f32_16x16x32_bf16 v[148:151], a[136:139], v[84:87], v[148:151]
  v_mfma_f32_16x16x32_bf16 v[152:155], a[140:143], v[84:87], v[152:155]
  s_waitcnt vmcnt(13)
  v_mfma_f32_16x16x32_bf16 v[148:151], a[144:147], v[88:91], v[148:151]
  v_mfma_f32_16x16x32_bf16 v[152:155], a[148:151], v[88:91], v[152:155]
  s_waitcnt vmcnt(12)
  v_mfma_f32_16x16x32_bf16 v[148:151], a[152:155], v[92:95], v[148:151]
  v_mfma_f32_16x16x32_bf16 v[152:155], a[156:159], v[92:95], v[152:155]
  s_waitcnt vmcnt(11)
  v_mfma_f32_16x16x32_bf16 v[148:151], a[160:163], v[96:99], v[148:151]
  v_mfma_f32_16x16x32_bf16 v[152:155], a[164:167], v[96:99], v[152:155]
  s_waitcnt vmcnt(10)
  v_mfma_f32_16x16x32_bf16 v[148:151], a[168:171], v[100:103], v[148:151]
  v_mfma_f32_16x16x32_bf16 v[152:155], a[172:175], v[100:103], v[152:155]
  s_waitcnt vmcnt(9)
  v_mfma_f32_16x16x32_bf16 v[148:151], a[176:179], v[104:107], v[148:151]
  v_mfma_f32_16x16x32_bf16 v[152:155], a[180:183], v[104:107], v[152:155]
  s_waitcnt vmcnt(8)
  v_mfma_f32_16x16x32_bf16 v[148:151], a[184:187], v[108:111], v[148:151]
  v_mfma_f32_16x16x32_bf16 v[152:155], a[188:191], v[108:111], v[152:155]
  s_waitcnt vmcnt(7)
  v_mfma_f32_16x16x32_bf16 v[148:151], a[192:195], v[112:115], v[148:151]
  v_mfma_f32_16x16x32_bf16 v[152:155], a[196:199], v[112:115], v[152:155]
  s_waitcnt vmcnt(6)
  v_mfma_f32_16x16x32_bf16 v[148:151], a[200:203], v[116:119], v[148:151]
  v_mfma_f32_16x16x32_bf16 v[152:155], a[204:207], v[116:119], v[152:155]
  s_waitcnt vmcnt(5)
  v_mfma_f32_16x16x32_bf16 v[148:151], a[208:211], v[120:123], v[148:151]
  v_mfma_f32_16x16x32_bf16 v[152:155], a[212:215], v[120:123], v[152:155]
  s_waitcnt vmcnt(4)
  v_mfma_f32_16x16x32_bf16 v[148:151], a[216:219], v[124:127], v[148:151]
  v_mfma_f32_16x16x32_bf16 v[152:155], a[220:223], v[124:127], v[152:155]
  s_waitcnt vmcnt(3)
  v_mfma_f32_16x16x32_bf16 v[148:151], a[224:227], v[128:131], v[148:151]
  v_mfma_f32_16x16x32_bf16 v[152:155], a[228:231], v[128:131], v[152:155]
  s_waitcnt vmcnt(2)
  v_mfma_f32_16x16x32_bf16 v[148:151], a[232:235], v[132:135], v[148:151]
  v_mfma_f32_16x16x32_bf16 v[152:155], a[236:239], v[132:135], v[152:155]
  s_waitcnt vmcnt(1)
  v_mfma_f32_16x16x32_bf16 v[148:151], a[240:243], v[136:139], v[148:151]
  v_mfma_f32_16x16x32_bf16 v[152:155], a[244:247], v[136:139], v[152:155]
  s_waitcnt vmcnt(0)
  v_mfma_f32_16x16x32_bf16 v[148:151], a[248:251], v[140:143], v[148:151]
  v_mfma_f32_16x16x32_bf16 v[152:155], a[252:255], v[140:143], v[152:155]
  s_nop 3
  ds_write_b128 v248, v[148:151] offset:0
  s_nop 2
  ds_write_b128 v248, v[152:155] offset:4096
  s_waitcnt lgkmcnt(0)
  s_barrier
  ds_read_b64 v[148:149], v13 offset:0
  ds_read_b64 v[150:151], v13 offset:1024
  ds_read_b64 v[152:153], v13 offset:2048
  ds_read_b64 v[154:155], v13 offset:3072
  ds_read_b128 v[156:159], v250
  v_xor_b32 v248, 0x8000, v248
  v_xor_b32 v13, 0x8000, v13
  s_waitcnt lgkmcnt(3)
  v_add_f32 v148, v148, v150
  s_waitcnt lgkmcnt(1)
  v_add_f32 v152, v152, v154
  v_add_f32 v149, v149, v151
  v_add_f32 v153, v153, v155
  v_add_f32 v148, v148, v152
  v_add_f32 v149, v149, v153
  v_add_u32 v250, 0x1000, v250
  s_lshl_b32 s24, s81, 14
  s_waitcnt lgkmcnt(0)
  v_fma_f32 v148, v148, v158, v156
  v_fma_f32 v149, v149, v158, v157
  v_cvt_pk_bf16_f32 v148, v148, v149
  buffer_store_dword v148, v249, s[16:19], s24 offen
  s_add_u32 s81, s81, 10
  s_cmp_lt_u32 s81, 126
  s_cbranch_scc1 P4a_top
  s_cmp_lt_u32 s59, 6
  s_cbranch_scc1 L_exit
  s_and_b32 s81, s78, 1
  s_lshr_b32 s78, s78, 1
  s_lshl_b32 s29, s81, 17
  s_lshl_b32 s25, s20, 15
  s_add_u32 s29, s29, s25
  s_lshl_b32 s25, s78, 14
  s_add_u32 s29, s29, s25
  s_add_u32 s27, s29, 100401152
  s_lshl_b32 s29, s59, 17
  s_add_u32 s29, s29, 83886080
  s_add_u32 s81, s81, 126
  s_lshl_b32 s24, s81, 13
  s_add_u32 s24, s24, 117473280
  s_lshl_b32 s25, s78, 7
  v_add_u32 v250, s25, v250
  s_lshl_b32 s25, s78, 13
  s_lshl_b32 s26, s81, 14
  s_add_u32 s26, s26, s25
  s_mov_b32 s30, 0
  s_mov_b32 s60, 0x00ff00ff
  s_mov_b32 s61, 0x00ff00ff
  ds_read_b128 v[156:159], v250
  s_waitcnt lgkmcnt(0)
P4z_top:
  s_cmp_lg_u32 s20, 0
  s_cbranch_scc1 P4z_poll_b
  v_min_u32 v11, 63, v0
  v_lshlrev_b32 v11, 7, v11
P4z_poll:
  s_add_u32 s79, s79, 1
  s_cmp_gt_u32 s79, 524288
  s_cbranch_scc1 L_exit
  buffer_load_dword v12, v11, s[8:11], s24 offen sc1
  s_waitcnt vmcnt(0)
  v_cmp_gt_u32 vcc, s30, v12
  s_cbranch_vccnz P4z_poll
P4z_poll_b:
  s_barrier
P4z_ld:
  s_add_u32 s31, s29, 0
  buffer_load_dwordx4 v[16:19], v1, s[8:11], s31 offen offset:0
  buffer_load_dwordx4 v[20:23], v1, s[8:11], s31 offen offset:1024
  buffer_load_dwordx4 v[24:27], v1, s[8:11], s31 offen offset:2048
  buffer_load_dwordx4 v[28:31], v1, s[8:11], s31 offen offset:3072
  s_add_u32 s31, s29, 4096
  buffer_load_dwordx4 v[32:35], v1, s[8:11], s31 offen offset:0
  buffer_load_dwordx4 v[36:39], v1, s[8:11], s31 offen offset:1024
  buffer_load_dwordx4 v[40:43], v1, s[8:11], s31 offen offset:2048
  buffer_load_dwordx4 v[44:47], v1, s[8:11], s31 offen offset:3072
  s_add_u32 s31, s29, 8192
  buffer_load_dwordx4 v[48:51], v1, s[8:11], s31 offen offset:0
  buffer_load_dwordx4 v[52:55], v1, s[8:11], s31 offen offset:1024
  buffer_load_dwordx4 v[56:59], v1, s[8:11], s31 offen offset:2048
  buffer_load_dwordx4 v[60:63], v1, s[8:11], s31 offen offset:3072
  s_add_u32 s31, s29, 12288
  buffer_load_dwordx4 v[64:67], v1, s[8:11], s31 offen offset:0
  buffer_load_dwordx4 v[68:71], v1, s[8:11], s31 offen offset:1024
  buffer_load_dwordx4 v[72:75], v1, s[8:11], s31 offen offset:2048
  buffer_load_dwordx4 v[76:79], v1, s[8:11], s31 offen offset:3072
  s_waitcnt vmcnt(15)
  v_mfma_f32_16x16x32_bf16 v[148:151], a[0:3], v[16:19], 0
  v_mfma_f32_16x16x32_bf16 v[96:99], a[8:11], v[16:19], 0
  v_mfma_f32_16x16x32_bf16 v[152:155], a[4:7], v[16:19], 0
  v_mfma_f32_16x16x32_bf16 v[100:103], a[12:15], v[16:19], 0
  s_waitcnt vmcnt(14)
  v_mfma_f32_16x16x32_bf16 v[148:151], a[16:19], v[20:23], v[148:151]
  v_mfma_f32_16x16x32_bf16 v[96:99], a[24:27], v[20:23], v[96:99]
  v_mfma_f32_16x16x32_bf16 v[152:155], a[20:23], v[20:23], v[152:155]
  v_mfma_f32_16x16x32_bf16 v[100:103], a[28:31], v[20:23], v[100:103]
  s_waitcnt vmcnt(13)
  v_mfma_f32_16x16x32_bf16 v[148:151], a[32:35], v[24:27], v[148:151]
  v_mfma_f32_16x16x32_bf16 v[96:99], a[40:43], v[24:27], v[96:99]
  v_mfma_f32_16x16x32_bf16 v[152:155], a[36:39], v[24:27], v[152:155]
  v_mfma_f32_16x16x32_bf16 v[100:103], a[44:47], v[24:27], v[100:103]
  s_waitcnt vmcnt(12)
  v_mfma_f32_16x16x32_bf16 v[148:151], a[48:51], v[28:31], v[148:151]
  v_mfma_f32_16x16x32_bf16 v[96:99], a[56:59], v[28:31], v[96:99]
  v_mfma_f32_16x16x32_bf16 v[152:155], a[52:55], v[28:31], v[152:155]
  v_mfma_f32_16x16x32_bf16 v[100:103], a[60:63], v[28:31], v[100:103]
  s_waitcnt vmcnt(11)
  v_mfma_f32_16x16x32_bf16 v[148:151], a[64:67], v[32:35], v[148:151]
  v_mfma_f32_16x16x32_bf16 v[96:99], a[72:75], v[32:35], v[96:99]
  v_mfma_f32_16x16x32_bf16 v[152:155], a[68:71], v[32:35], v[152:155]
  v_mfma_f32_16x16x32_bf16 v[100:103], a[76:79], v[32:35], v[100:103]
  s_waitcnt vmcnt(10)
  v_mfma_f32_16x16x32_bf16 v[148:151], a[80:83], v[36:39], v[148:151]
  v_mfma_f32_16x16x32_bf16 v[96:99], a[88:91], v[36:39], v[96:99]
  v_mfma_f32_16x16x32_bf16 v[152:155], a[84:87], v[36:39], v[152:155]
  v_mfma_f32_16x16x32_bf16 v[100:103], a[92:95], v[36:39], v[100:103]
  s_waitcnt vmcnt(9)
  v_mfma_f32_16x16x32_bf16 v[148:151], a[96:99], v[40:43], v[148:151]
  v_mfma_f32_16x16x32_bf16 v[96:99], a[104:107], v[40:43], v[96:99]
  v_mfma_f32_16x16x32_bf16 v[152:155], a[100:103], v[40:43], v[152:155]
  v_mfma_f32_16x16x32_bf16 v[100:103], a[108:111], v[40:43], v[100:103]
  s_waitcnt vmcnt(8)
  v_mfma_f32_16x16x32_bf16 v[148:151], a[112:115], v[44:47], v[148:151]
  v_mfma_f32_16x16x32_bf16 v[96:99], a[120:123], v[44:47], v[96:99]
  v_mfma_f32_16x16x32_bf16 v[152:155], a[116:119], v[44:47], v[152:155]
  v_mfma_f32_16x16x32_bf16 v[100:103], a[124:127], v[44:47], v[100:103]
  s_waitcnt vmcnt(7)
  v_mfma_f32_16x16x32_bf16 v[148:151], a[128:131], v[48:51], v[148:151]
  v_mfma_f32_16x16x32_bf16 v[96:99], a[136:139], v[48:51], v[96:99]
  v_mfma_f32_16x16x32_bf16 v[152:155], a[132:135], v[48:51], v[152:155]
  v_mfma_f32_16x16x32_bf16 v[100:103], a[140:143], v[48:51], v[100:103]
  s_waitcnt vmcnt(6)
  v_mfma_f32_16x16x32_bf16 v[148:151], a[144:147], v[52:55], v[148:151]
  v_mfma_f32_16x16x32_bf16 v[96:99], a[152:155], v[52:55], v[96:99]
  v_mfma_f32_16x16x32_bf16 v[152:155], a[148:151], v[52:55], v[152:155]
  v_mfma_f32_16x16x32_bf16 v[100:103], a[156:159], v[52:55], v[100:103]
  s_waitcnt vmcnt(5)
  v_mfma_f32_16x16x32_bf16 v[148:151], a[160:163], v[56:59], v[148:151]
  v_mfma_f32_16x16x32_bf16 v[96:99], a[168:171], v[56:59], v[96:99]
  v_mfma_f32_16x16x32_bf16 v[152:155], a[164:167], v[56:59], v[152:155]
  v_mfma_f32_16x16x32_bf16 v[100:103], a[172:175], v[56:59], v[100:103]
  s_waitcnt vmcnt(4)
  v_mfma_f32_16x16x32_bf16 v[148:151], a[176:179], v[60:63], v[148:151]
  v_mfma_f32_16x16x32_bf16 v[96:99], a[184:187], v[60:63], v[96:99]
  v_mfma_f32_16x16x32_bf16 v[152:155], a[180:183], v[60:63], v[152:155]
  v_mfma_f32_16x16x32_bf16 v[100:103], a[188:191], v[60:63], v[100:103]
  s_waitcnt vmcnt(3)
  v_mfma_f32_16x16x32_bf16 v[148:151], a[192:195], v[64:67], v[148:151]
  v_mfma_f32_16x16x32_bf16 v[96:99], a[200:203], v[64:67], v[96:99]
  v_mfma_f32_16x16x32_bf16 v[152:155], a[196:199], v[64:67], v[152:155]
  v_mfma_f32_16x16x32_bf16 v[100:103], a[204:207], v[64:67], v[100:103]
  s_waitcnt vmcnt(2)
  v_mfma_f32_16x16x32_bf16 v[148:151], a[208:211], v[68:71], v[148:151]
  v_mfma_f32_16x16x32_bf16 v[96:99], a[216:219], v[68:71], v[96:99]
  v_mfma_f32_16x16x32_bf16 v[152:155], a[212:215], v[68:71], v[152:155]
  v_mfma_f32_16x16x32_bf16 v[100:103], a[220:223], v[68:71], v[100:103]
  s_waitcnt vmcnt(1)
  v_mfma_f32_16x16x32_bf16 v[148:151], a[224:227], v[72:75], v[148:151]
  v_mfma_f32_16x16x32_bf16 v[96:99], a[232:235], v[72:75], v[96:99]
  v_mfma_f32_16x16x32_bf16 v[152:155], a[228:231], v[72:75], v[152:155]
  v_mfma_f32_16x16x32_bf16 v[100:103], a[236:239], v[72:75], v[100:103]
  s_waitcnt vmcnt(0)
  v_mfma_f32_16x16x32_bf16 v[148:151], a[240:243], v[76:79], v[148:151]
  v_mfma_f32_16x16x32_bf16 v[96:99], a[248:251], v[76:79], v[96:99]
  v_mfma_f32_16x16x32_bf16 v[152:155], a[244:247], v[76:79], v[152:155]
  v_mfma_f32_16x16x32_bf16 v[100:103], a[252:255], v[76:79], v[100:103]
  v_add_f32_dpp v148, v96, v148 row_shl:8 row_mask:0xf bank_mask:0xf
  v_add_f32_dpp v149, v97, v149 row_shl:8 row_mask:0xf bank_mask:0xf
  v_add_f32_dpp v150, v98, v150 row_shl:8 row_mask:0xf bank_mask:0xf
  v_add_f32_dpp v151, v99, v151 row_shl:8 row_mask:0xf bank_mask:0xf
  s_nop 3
  v_add_f32_dpp v152, v100, v152 row_shl:8 row_mask:0xf bank_mask:0xf
  v_add_f32_dpp v153, v101, v153 row_shl:8 row_mask:0xf bank_mask:0xf
  v_add_f32_dpp v154, v102, v154 row_shl:8 row_mask:0xf bank_mask:0xf
  v_add_f32_dpp v155, v103, v155 row_shl:8 row_mask:0xf bank_mask:0xf
  s_mov_b64 exec, s[60:61]
  ds_write_b128 v248, v[148:151] offset:0
  ds_write_b128 v248, v[152:155] offset:4096
  s_waitcnt lgkmcnt(0)
  s_barrier
  ds_read_b64 v[148:149], v13 offset:0
  ds_read_b64 v[150:151], v13 offset:1024
  ds_read_b64 v[152:153], v13 offset:2048
  ds_read_b64 v[154:155], v13 offset:3072
  v_xor_b32 v248, 0x8000, v248
  v_xor_b32 v13, 0x8000, v13
  s_waitcnt lgkmcnt(2)
  v_add_f32 v148, v148, v150
  s_waitcnt lgkmcnt(0)
  v_add_f32 v152, v152, v154
  v_add_f32 v149, v149, v151
  v_add_f32 v153, v153, v155
  v_add_f32 v148, v148, v152
  v_add_f32 v149, v149, v153
  v_fma_f32 v148, v148, v158, v156
  v_fma_f32 v149, v149, v158, v157
  s_cmp_eq_u32 s30, 0
  v_cvt_pk_bf16_f32 v148, v148, v149
  s_cbranch_scc1 P4z_go
  buffer_store_dword v148, v249, s[16:19], s26 offen
  s_endpgm
P4z_go:
  s_mov_b64 exec, -1
  s_mov_b32 s30, 1
  s_mov_b32 s29, s27
  s_branch P4z_top
L_p3:
  s_and_b32 s56, s21, 31
  s_lshl_b32 s24, s56, 8
  s_lshl_b32 s25, s20, 6
  s_add_u32 s24, s24, s25
  v_bfe_u32 v10, v0, 2, 1
  v_lshlrev_b32 v10, 4, v10
  v_lshrrev_b32 v11, 5, v0
  v_lshl_add_u32 v10, v11, 3, v10
  v_bfe_u32 v9, v0, 3, 2
  v_add_u32 v9, v9, v10
  v_mul_u32_u24 v9, 8192, v9
  v_and_b32 v11, 3, v0
  v_lshl_add_u32 v9, v11, 4, v9
  v_add_u32 v4, s24, v9
  s_mov_b32 s32, s42
  s_mov_b32 s33, s43
  s_mov_b32 s34, 4194304
  s_add_u32 m0, s22, 0
  s_mov_b32 s31, 0
  buffer_load_dwordx4 v4, s[32:35], s31 offen lds
  s_add_u32 m0, s22, 16416
  s_mov_b32 s31, 32768
  buffer_load_dwordx4 v4, s[32:35], s31 offen lds
  s_add_u32 m0, s22, 1024
  s_mov_b32 s31, 262144
  buffer_load_dwordx4 v4, s[32:35], s31 offen lds
  s_add_u32 m0, s22, 17440
  s_mov_b32 s31, 294912
  buffer_load_dwordx4 v4, s[32:35], s31 offen lds
  s_add_u32 m0, s22, 2048
  s_mov_b32 s31, 524288
  buffer_load_dwordx4 v4, s[32:35], s31 offen lds
  s_add_u32 m0, s22, 18464
  s_mov_b32 s31, 557056
  buffer_load_dwordx4 v4, s[32:35], s31 offen lds
  s_add_u32 m0, s22, 3072
  s_mov_b32 s31, 786432
  buffer_load_dwordx4 v4, s[32:35], s31 offen lds
  s_add_u32 m0, s22, 19488
  s_mov_b32 s31, 819200
  buffer_load_dwordx4 v4, s[32:35], s31 offen lds
  s_add_u32 m0, s22, 4096
  s_mov_b32 s31, 1048576
  buffer_load_dwordx4 v4, s[32:35], s31 offen lds
  s_add_u32 m0, s22, 20512
  s_mov_b32 s31, 1081344
  buffer_load_dwordx4 v4, s[32:35], s31 offen lds
  s_add_u32 m0, s22, 5120
  s_mov_b32 s31, 1310720
  buffer_load_dwordx4 v4, s[32:35], s31 offen lds
  s_add_u32 m0, s22, 21536
  s_mov_b32 s31, 1343488
  buffer_load_dwordx4 v4, s[32:35], s31 offen lds
  s_add_u32 m0, s22, 6144
  s_mov_b32 s31, 1572864
  buffer_load_dwordx4 v4, s[32:35], s31 offen lds
  s_add_u32 m0, s22, 22560
  s_mov_b32 s31, 1605632
  buffer_load_dwordx4 v4, s[32:35], s31 offen lds
  s_add_u32 m0, s22, 7168
  s_mov_b32 s31, 1835008
  buffer_load_dwordx4 v4, s[32:35], s31 offen lds
  s_add_u32 m0, s22, 23584
  s_mov_b32 s31, 1867776
  buffer_load_dwordx4 v4, s[32:35], s31 offen lds
  s_add_u32 m0, s22, 8192
  s_mov_b32 s31, 2097152
  buffer_load_dwordx4 v4, s[32:35], s31 offen lds
  s_add_u32 m0, s22, 24608
  s_mov_b32 s31, 2129920
  buffer_load_dwordx4 v4, s[32:35], s31 offen lds
  s_add_u32 m0, s22, 9216
  s_mov_b32 s31, 2359296
  buffer_load_dwordx4 v4, s[32:35], s31 offen lds
  s_add_u32 m0, s22, 25632
  s_mov_b32 s31, 2392064
  buffer_load_dwordx4 v4, s[32:35], s31 offen lds
  s_add_u32 m0, s22, 10240
  s_mov_b32 s31, 2621440
  buffer_load_dwordx4 v4, s[32:35], s31 offen lds
  s_add_u32 m0, s22, 26656
  s_mov_b32 s31, 2654208
  buffer_load_dwordx4 v4, s[32:35], s31 offen lds
  s_add_u32 m0, s22, 11264
  s_mov_b32 s31, 2883584
  buffer_load_dwordx4 v4, s[32:35], s31 offen lds
  s_add_u32 m0, s22, 27680
  s_mov_b32 s31, 2916352
  buffer_load_dwordx4 v4, s[32:35], s31 offen lds
  s_add_u32 m0, s22, 12288
  s_mov_b32 s31, 3145728
  buffer_load_dwordx4 v4, s[32:35], s31 offen lds
  s_add_u32 m0, s22, 28704
  s_mov_b32 s31, 3178496
  buffer_load_dwordx4 v4, s[32:35], s31 offen lds
  s_add_u32 m0, s22, 13312
  s_mov_b32 s31, 3407872
  buffer_load_dwordx4 v4, s[32:35], s31 offen lds
  s_add_u32 m0, s22, 29728
  s_mov_b32 s31, 3440640
  buffer_load_dwordx4 v4, s[32:35], s31 offen lds
  s_add_u32 m0, s22, 14336
  s_mov_b32 s31, 3670016
  buffer_load_dwordx4 v4, s[32:35], s31 offen lds
  s_add_u32 m0, s22, 30752
  s_mov_b32 s31, 3702784
  buffer_load_dwordx4 v4, s[32:35], s31 offen lds
  s_waitcnt vmcnt(28)
  ds_read_b64_tr_b16 a[0:1], v2 offset:0
  ds_read_b64_tr_b16 a[2:3], v2 offset:256
  ds_read_b64_tr_b16 a[4:5], v2 offset:32
  ds_read_b64_tr_b16 a[6:7], v2 offset:288
  s_waitcnt vmcnt(26)
  ds_read_b64_tr_b16 a[8:9], v2 offset:1024
  ds_read_b64_tr_b16 a[10:11], v2 offset:1280
  ds_read_b64_tr_b16 a[12:13], v2 offset:1056
  ds_read_b64_tr_b16 a[14:15], v2 offset:1312
  s_waitcnt lgkmcnt(4)
  s_add_u32 m0, s22, 0
  s_mov_b32 s31, 3932160
  buffer_load_dwordx4 v4, s[32:35], s31 offen lds
  s_add_u32 m0, s22, 16416
  s_mov_b32 s31, 3964928
  buffer_load_dwordx4 v4, s[32:35], s31 offen lds
  s_waitcnt vmcnt(26)
  ds_read_b64_tr_b16 a[16:17], v2 offset:2048
  ds_read_b64_tr_b16 a[18:19], v2 offset:2304
  ds_read_b64_tr_b16 a[20:21], v2 offset:2080
  ds_read_b64_tr_b16 a[22:23], v2 offset:2336
  s_waitcnt lgkmcnt(4)
  s_mov_b32 s32, s44
  s_mov_b32 s33, s45
  s_mov_b32 s34, 4194304
  s_add_u32 m0, s22, 1024
  s_mov_b32 s31, 0
  buffer_load_dwordx4 v4, s[32:35], s31 offen lds
  s_add_u32 m0, s22, 17440
  s_mov_b32 s31, 32768
  buffer_load_dwordx4 v4, s[32:35], s31 offen lds
  s_waitcnt vmcnt(26)
  ds_read_b64_tr_b16 a[24:25], v2 offset:3072
  ds_read_b64_tr_b16 a[26:27], v2 offset:3328
  ds_read_b64_tr_b16 a[28:29], v2 offset:3104
  ds_read_b64_tr_b16 a[30:31], v2 offset:3360
  s_waitcnt lgkmcnt(4)
  s_add_u32 m0, s22, 2048
  s_mov_b32 s31, 262144
  buffer_load_dwordx4 v4, s[32:35], s31 offen lds
  s_add_u32 m0, s22, 18464
  s_mov_b32 s31, 294912
  buffer_load_dwordx4 v4, s[32:35], s31 offen lds
  s_waitcnt vmcnt(26)
  ds_read_b64_tr_b16 a[32:33], v2 offset:4096
  ds_read_b64_tr_b16 a[34:35], v2 offset:4352
  ds_read_b64_tr_b16 a[36:37], v2 offset:4128
  ds_read_b64_tr_b16 a[38:39], v2 offset:4384
  s_waitcnt lgkmcnt(4)
  s_add_u32 m0, s22, 3072
  s_mov_b32 s31, 524288
  buffer_load_dwordx4 v4, s[32:35], s31 offen lds
  s_add_u32 m0, s22, 19488
  s_mov_b32 s31, 557056
  buffer_load_dwordx4 v4, s[32:35], s31 offen lds
  s_waitcnt vmcnt(26)
  ds_read_b64_tr_b16 a[40:41], v2 offset:5120
  ds_read_b64_tr_b16 a[42:43], v2 offset:5376
  ds_read_b64_tr_b16 a[44:45], v2 offset:5152
  ds_read_b64_tr_b16 a[46:47], v2 offset:5408
  s_waitcnt lgkmcnt(4)
  s_add_u32 m0, s22, 4096
  s_mov_b32 s31, 786432
  buffer_load_dwordx4 v4, s[32:35], s31 offen lds
  s_add_u32 m0, s22, 20512
  s_mov_b32 s31, 819200
  buffer_load_dwordx4 v4, s[32:35], s31 offen lds
  s_waitcnt vmcnt(26)
  ds_read_b64_tr_b16 a[48:49], v2 offset:6144
  ds_read_b64_tr_b16 a[50:51], v2 offset:6400
  ds_read_b64_tr_b16 a[52:53], v2 offset:6176
  ds_read_b64_tr_b16 a[54:55], v2 offset:6432
  s_waitcnt lgkmcnt(4)
  s_add_u32 m0, s22, 5120
  s_mov_b32 s31, 1048576
  buffer_load_dwordx4 v4, s[32:35], s31 offen lds
  s_add_u32 m0, s22, 21536
  s_mov_b32 s31, 1081344
  buffer_load_dwordx4 v4, s[32:35], s31 offen lds
  s_waitcnt vmcnt(26)
  ds_read_b64_tr_b16 a[56:57], v2 offset:7168
  ds_read_b64_tr_b16 a[58:59], v2 offset:7424
  ds_read_b64_tr_b16 a[60:61], v2 offset:7200
  ds_read_b64_tr_b16 a[62:63], v2 offset:7456
  s_waitcnt lgkmcnt(4)
  s_add_u32 m0, s22, 6144
  s_mov_b32 s31, 1310720
  buffer_load_dwordx4 v4, s[32:35], s31 offen lds
  s_add_u32 m0, s22, 22560
  s_mov_b32 s31, 1343488
  buffer_load_dwordx4 v4, s[32:35], s31 offen lds
  s_waitcnt vmcnt(26)
  ds_read_b64_tr_b16 a[64:65], v2 offset:8192
  ds_read_b64_tr_b16 a[66:67], v2 offset:8448
  ds_read_b64_tr_b16 a[68:69], v2 offset:8224
  ds_read_b64_tr_b16 a[70:71], v2 offset:8480
  s_waitcnt lgkmcnt(4)
  s_add_u32 m0, s22, 7168
  s_mov_b32 s31, 1572864
  buffer_load_dwordx4 v4, s[32:35], s31 offen lds
  s_add_u32 m0, s22, 23584
  s_mov_b32 s31, 1605632
  buffer_load_dwordx4 v4, s[32:35], s31 offen lds
  s_waitcnt vmcnt(26)
  ds_read_b64_tr_b16 a[72:73], v2 offset:9216
  ds_read_b64_tr_b16 a[74:75], v2 offset:9472
  ds_read_b64_tr_b16 a[76:77], v2 offset:9248
  ds_read_b64_tr_b16 a[78:79], v2 offset:9504
  s_waitcnt lgkmcnt(4)
  s_add_u32 m0, s22, 8192
  s_mov_b32 s31, 1835008
  buffer_load_dwordx4 v4, s[32:35], s31 offen lds
  s_add_u32 m0, s22, 24608
  s_mov_b32 s31, 1867776
  buffer_load_dwordx4 v4, s[32:35], s31 offen lds
  s_waitcnt vmcnt(26)
  ds_read_b64_tr_b16 a[80:81], v2 offset:10240
  ds_read_b64_tr_b16 a[82:83], v2 offset:10496
  ds_read_b64_tr_b16 a[84:85], v2 offset:10272
  ds_read_b64_tr_b16 a[86:87], v2 offset:10528
  s_waitcnt lgkmcnt(4)
  s_add_u32 m0, s22, 9216
  s_mov_b32 s31, 2097152
  buffer_load_dwordx4 v4, s[32:35], s31 offen lds
  s_add_u32 m0, s22, 25632
  s_mov_b32 s31, 2129920
  buffer_load_dwordx4 v4, s[32:35], s31 offen lds
  s_waitcnt vmcnt(26)
  ds_read_b64_tr_b16 a[88:89], v2 offset:11264
  ds_read_b64_tr_b16 a[90:91], v2 offset:11520
  ds_read_b64_tr_b16 a[92:93], v2 offset:11296
  ds_read_b64_tr_b16 a[94:95], v2 offset:11552
  s_waitcnt lgkmcnt(4)
  s_add_u32 m0, s22, 10240
  s_mov_b32 s31, 2359296
  buffer_load_dwordx4 v4, s[32:35], s31 offen lds
  s_add_u32 m0, s22, 26656
  s_mov_b32 s31, 2392064
  buffer_load_dwordx4 v4, s[32:35], s31 offen lds
  s_waitcnt vmcnt(26)
  ds_read_b64_tr_b16 a[96:97], v2 offset:12288
  ds_read_b64_tr_b16 a[98:99], v2 offset:12544
  ds_read_b64_tr_b16 a[100:101], v2 offset:12320
  ds_read_b64_tr_b16 a[102:103], v2 offset:12576
  s_waitcnt lgkmcnt(4)
  s_add_u32 m0, s22, 11264
  s_mov_b32 s31, 2621440
  buffer_load_dwordx4 v4, s[32:35], s31 offen lds
  s_add_u32 m0, s22, 27680
  s_mov_b32 s31, 2654208
  buffer_load_dwordx4 v4, s[32:35], s31 offen lds
  s_waitcnt vmcnt(26)
  ds_read_b64_tr_b16 a[104:105], v2 offset:13312
  ds_read_b64_tr_b16 a[106:107], v2 offset:13568
  ds_read_b64_tr_b16 a[108:109], v2 offset:13344
  ds_read_b64_tr_b16 a[110:111], v2 offset:13600
  s_waitcnt lgkmcnt(4)
  s_add_u32 m0, s22, 12288
  s_mov_b32 s31, 2883584
  buffer_load_dwordx4 v4, s[32:35], s31 offen lds
  s_add_u32 m0, s22, 28704
  s_mov_b32 s31, 2916352
  buffer_load_dwordx4 v4, s[32:35], s31 offen lds
  s_waitcnt vmcnt(26)
  ds_read_b64_tr_b16 a[112:113], v2 offset:14336
  ds_read_b64_tr_b16 a[114:115], v2 offset:14592
  ds_read_b64_tr_b16 a[116:117], v2 offset:14368
  ds_read_b64_tr_b16 a[118:119], v2 offset:14624
  s_waitcnt lgkmcnt(4)
  s_add_u32 m0, s22, 13312
  s_mov_b32 s31, 3145728
  buffer_load_dwordx4 v4, s[32:35], s31 offen lds
  s_add_u32 m0, s22, 29728
  s_mov_b32 s31, 3178496
  buffer_load_dwordx4 v4, s[32:35], s31 offen lds
  s_waitcnt vmcnt(26)
  ds_read_b64_tr_b16 a[120:121], v2 offset:0
  ds_read_b64_tr_b16 a[122:123], v2 offset:256
  ds_read_b64_tr_b16 a[124:125], v2 offset:32
  ds_read_b64_tr_b16 a[126:127], v2 offset:288
  s_waitcnt lgkmcnt(4)
  s_add_u32 m0, s22, 14336
  s_mov_b32 s31, 3407872
  buffer_load_dwordx4 v4, s[32:35], s31 offen lds
  s_add_u32 m0, s22, 30752
  s_mov_b32 s31, 3440640
  buffer_load_dwordx4 v4, s[32:35], s31 offen lds
  s_waitcnt vmcnt(26)
  ds_read_b64_tr_b16 a[128:129], v2 offset:1024
  ds_read_b64_tr_b16 a[130:131], v2 offset:1280
  ds_read_b64_tr_b16 a[132:133], v2 offset:1056
  ds_read_b64_tr_b16 a[134:135], v2 offset:1312
  s_waitcnt lgkmcnt(4)
  s_add_u32 m0, s22, 0
  s_mov_b32 s31, 3670016
  buffer_load_dwordx4 v4, s[32:35], s31 offen lds
  s_add_u32 m0, s22, 16416
  s_mov_b32 s31, 3702784
  buffer_load_dwordx4 v4, s[32:35], s31 offen lds
  s_waitcnt vmcnt(26)
  ds_read_b64_tr_b16 a[136:137], v2 offset:2048
  ds_read_b64_tr_b16 a[138:139], v2 offset:2304
  ds_read_b64_tr_b16 a[140:141], v2 offset:2080
  ds_read_b64_tr_b16 a[142:143], v2 offset:2336
  s_waitcnt lgkmcnt(4)
  s_add_u32 m0, s22, 1024
  s_mov_b32 s31, 3932160
  buffer_load_dwordx4 v4, s[32:35], s31 offen lds
  s_add_u32 m0, s22, 17440
  s_mov_b32 s31, 3964928
  buffer_load_dwordx4 v4, s[32:35], s31 offen lds
  s_waitcnt vmcnt(26)
  ds_read_b64_tr_b16 a[144:145], v2 offset:3072
  ds_read_b64_tr_b16 a[146:147], v2 offset:3328
  ds_read_b64_tr_b16 a[148:149], v2 offset:3104
  ds_read_b64_tr_b16 a[150:151], v2 offset:3360
  s_waitcnt vmcnt(24)
  ds_read_b64_tr_b16 a[152:153], v2 offset:4096
  ds_read_b64_tr_b16 a[154:155], v2 offset:4352
  ds_read_b64_tr_b16 a[156:157], v2 offset:4128
  ds_read_b64_tr_b16 a[158:159], v2 offset:4384
  s_waitcnt vmcnt(22)
  ds_read_b64_tr_b16 a[160:161], v2 offset:5120
  ds_read_b64_tr_b16 a[162:163], v2 offset:5376
  ds_read_b64_tr_b16 a[164:165], v2 offset:5152
  ds_read_b64_tr_b16 a[166:167], v2 offset:5408
  s_waitcnt vmcnt(20)
  ds_read_b64_tr_b16 a[168:169], v2 offset:6144
  ds_read_b64_tr_b16 a[170:171], v2 offset:6400
  ds_read_b64_tr_b16 a[172:173], v2 offset:6176
  ds_read_b64_tr_b16 a[174:175], v2 offset:6432
  s_waitcnt vmcnt(18)
  ds_read_b64_tr_b16 a[176:177], v2 offset:7168
  ds_read_b64_tr_b16 a[178:179], v2 offset:7424
  ds_read_b64_tr_b16 a[180:181], v2 offset:7200
  ds_read_b64_tr_b16 a[182:183], v2 offset:7456
  s_waitcnt vmcnt(16)
  ds_read_b64_tr_b16 a[184:185], v2 offset:8192
  ds_read_b64_tr_b16 a[186:187], v2 offset:8448
  ds_read_b64_tr_b16 a[188:189], v2 offset:8224
  ds_read_b64_tr_b16 a[190:191], v2 offset:8480
  s_waitcnt vmcnt(14)
  ds_read_b64_tr_b16 a[192:193], v2 offset:9216
  ds_read_b64_tr_b16 a[194:195], v2 offset:9472
  ds_read_b64_tr_b16 a[196:197], v2 offset:9248
  ds_read_b64_tr_b16 a[198:199], v2 offset:9504
  s_waitcnt vmcnt(12)
  ds_read_b64_tr_b16 a[200:201], v2 offset:10240
  ds_read_b64_tr_b16 a[202:203], v2 offset:10496
  ds_read_b64_tr_b16 a[204:205], v2 offset:10272
  ds_read_b64_tr_b16 a[206:207], v2 offset:10528
  s_waitcnt vmcnt(10)
  ds_read_b64_tr_b16 a[208:209], v2 offset:11264
  ds_read_b64_tr_b16 a[210:211], v2 offset:11520
  ds_read_b64_tr_b16 a[212:213], v2 offset:11296
  ds_read_b64_tr_b16 a[214:215], v2 offset:11552
  s_waitcnt vmcnt(8)
  ds_read_b64_tr_b16 a[216:217], v2 offset:12288
  ds_read_b64_tr_b16 a[218:219], v2 offset:12544
  ds_read_b64_tr_b16 a[220:221], v2 offset:12320
  ds_read_b64_tr_b16 a[222:223], v2 offset:12576
  s_waitcnt vmcnt(6)
  ds_read_b64_tr_b16 a[224:225], v2 offset:13312
  ds_read_b64_tr_b16 a[226:227], v2 offset:13568
  ds_read_b64_tr_b16 a[228:229], v2 offset:13344
  ds_read_b64_tr_b16 a[230:231], v2 offset:13600
  s_waitcnt vmcnt(4)
  ds_read_b64_tr_b16 a[232:233], v2 offset:14336
  ds_read_b64_tr_b16 a[234:235], v2 offset:14592
  ds_read_b64_tr_b16 a[236:237], v2 offset:14368
  ds_read_b64_tr_b16 a[238:239], v2 offset:14624
  s_waitcnt vmcnt(2)
  ds_read_b64_tr_b16 a[240:241], v2 offset:0
  ds_read_b64_tr_b16 a[242:243], v2 offset:256
  ds_read_b64_tr_b16 a[244:245], v2 offset:32
  ds_read_b64_tr_b16 a[246:247], v2 offset:288
  s_waitcnt vmcnt(0)
  ds_read_b64_tr_b16 a[248:249], v2 offset:1024
  ds_read_b64_tr_b16 a[250:251], v2 offset:1280
  ds_read_b64_tr_b16 a[252:253], v2 offset:1056
  ds_read_b64_tr_b16 a[254:255], v2 offset:1312
  v_lshrrev_b32 v9, 4, v0
  v_and_b32 v10, 7, v0
  v_lshlrev_b32 v10, 4, v10
  v_lshl_add_u32 v244, v9, 7, v10
  s_lshl_b32 s24, s20, 11
  v_add_u32 v245, s24, v1
  s_and_b32 s24, s20, 1
  s_lshl_b32 s24, s24, 12
  v_add_u32 v247, s24, v1
  s_waitcnt vmcnt(0) lgkmcnt(0)
  s_barrier
  v_and_b32 v9, 15, v0
  v_lshrrev_b32 v10, 4, v0
  v_lshlrev_b32 v10, 2, v10
  v_sub_u32 v9, v9, v10
  s_lshr_b32 s24, s20, 1
  s_lshl_b32 s24, s24, 4
  v_add_u32 v9, s24, v9
  s_mov_b32 s76, 0x3e0293ee
  v_mov_b32 v246, 0xff800000
  v_cmp_le_i32 s[60:61], 0, v9
  v_cmp_le_i32 s[62:63], 1, v9
  v_cmp_le_i32 s[64:65], 2, v9
  v_cmp_le_i32 s[66:67], 3, v9
  v_cmp_le_i32 s[68:69], 16, v9
  v_cmp_le_i32 s[70:71], 17, v9
  v_cmp_le_i32 s[72:73], 18, v9
  v_cmp_le_i32 s[74:75], 19, v9
  v_mov_b32 v240, 0x3f803f80
  v_mov_b32 v241, 0x3f803f80
  v_mov_b32 v242, 0x3f803f80
  v_mov_b32 v243, 0x3f803f80
  s_bfe_u32 s80, s21, 0x10005
  v_and_b32 v13, 7, v0
  v_lshrrev_b32 v14, 2, v13
  v_sub_u32 v14, 11, v14
  v_cmp_gt_u32 vcc, 6, v13
  s_nop 1
  v_cndmask_b32 v13, 0, v14, vcc
  s_lshl_b32 s24, s56, 7
  s_add_u32 s24, s24, 51380224
  s_mov_b32 s27, 53477376
  v_and_b32 v11, 31, v0
  v_lshlrev_b32 v11, 2, v11
P3_first:
  s_add_u32 s79, s79, 1
  s_cmp_gt_u32 s79, 524288
  s_cbranch_scc1 L_exit
  buffer_load_dword v12, v11, s[8:11], s24 offen sc1
  s_waitcnt vmcnt(0)
  v_cmp_gt_u32 vcc, v13, v12
  s_cbranch_vccnz P3_first
  s_lshl_b32 s24, s80, 5
  s_add_u32 s24, s24, s56
  s_lshl_b32 s25, s24, 13
  s_add_u32 s25, s25, 67108864
  s_lshl_b32 s24, s24, 14
  s_lshr_b32 s26, s20, 1
  s_lshl_b32 s26, s26, 10
  s_add_u32 s25, s25, s26
  s_add_u32 s31, s25, 0
  buffer_load_dwordx4 v[232:235], v1, s[8:11], s31 offen
  s_add_u32 s31, s24, 0
  buffer_load_dwordx4 v[120:123], v1, s[8:11], s31 offen offset:0
  buffer_load_dwordx4 v[136:139], v1, s[8:11], s31 offen offset:1024
  s_add_u32 s31, s25, 2048
  buffer_load_dwordx4 v[236:239], v1, s[8:11], s31 offen
  s_add_u32 s31, s24, 4096
  buffer_load_dwordx4 v[124:127], v1, s[8:11], s31 offen offset:0
  buffer_load_dwordx4 v[140:143], v1, s[8:11], s31 offen offset:1024
  s_add_u32 s31, s25, 4096
  buffer_load_dwordx4 v[248:251], v1, s[8:11], s31 offen
  s_add_u32 s31, s24, 8192
  buffer_load_dwordx4 v[128:131], v1, s[8:11], s31 offen offset:0
  buffer_load_dwordx4 v[144:147], v1, s[8:11], s31 offen offset:1024
  s_add_u32 s31, s25, 6144
  buffer_load_dwordx4 v[252:255], v1, s[8:11], s31 offen
  s_add_u32 s31, s24, 12288
  buffer_load_dwordx4 v[132:135], v1, s[8:11], s31 offen offset:0
  buffer_load_dwordx4 v[148:151], v1, s[8:11], s31 offen offset:1024
  v_mov_b32 v13, v1
  v_add_u32 v14, 1024, v1
  v_bfe_u32 v9, v0, 3, 1
  v_lshlrev_b32 v9, 14, v9
  v_lshrrev_b32 v10, 4, v0
  v_lshl_add_u32 v9, v10, 8, v9
  v_and_b32 v10, 7, v0
  v_lshl_add_u32 v5, v10, 4, v9
  v_add_u32 v6, 128, v5
  v_and_b32 v9, 31, v0
  v_lshlrev_b32 v9, 6, v9
  v_lshrrev_b32 v10, 5, v0
  v_lshl_add_u32 v2, v10, 12, v9
  s_lshr_b32 s24, s20, 1
  s_lshl_b32 s24, s24, 17
  s_lshr_b32 s25, s56, 3
  s_lshl_b32 s25, s25, 15
  s_add_u32 s24, s24, s25
  s_and_b32 s25, s56, 7
  s_lshl_b32 s25, s25, 11
  s_add_u32 s24, s24, s25
  s_and_b32 s25, s20, 1
  s_lshl_b32 s25, s25, 10
  s_add_u32 s24, s24, s25
  s_add_u32 s78, s24, 100401152
  s_lshl_b32 s24, s80, 1
  s_lshr_b32 s25, s20, 1
  s_add_u32 s24, s24, s25
  s_lshl_b32 s24, s24, 13
  s_lshl_b32 s25, s56, 1
  s_and_b32 s26, s20, 1
  s_add_u32 s25, s25, s26
  s_lshl_b32 s25, s25, 7
  s_add_u32 s24, s24, s25
  s_add_u32 s81, s24, 118489088
  s_mov_b64 exec, 1
  buffer_store_dword v7, v7, s[8:11], s81 offen sc1
  s_mov_b64 exec, -1
  s_waitcnt vmcnt(0)
P3_top:
  s_lshl_b32 s77, s80, 13
  s_add_u32 s77, s77, 33554432
  buffer_load_dwordx4 v[80:83], v245, s[8:11], s77 offen offset:0 sc1
  buffer_load_dwordx4 v[84:87], v245, s[8:11], s77 offen offset:1024 sc1
  s_lshl_b32 s24, s80, 5
  s_add_u32 s24, s24, s56
  s_lshl_b32 s24, s24, 14
  s_and_b32 s26, s20, 1
  s_lshl_b32 s26, s26, 13
  s_add_u32 s24, s24, s26
  s_add_u32 s31, s24, 0
  buffer_load_dwordx4 v[152:155], v1, s[8:11], s31 offen offset:2048
  buffer_load_dwordx4 v[156:159], v1, s[8:11], s31 offen offset:3072
  s_add_u32 s31, s24, 4096
  buffer_load_dwordx4 v[160:163], v1, s[8:11], s31 offen offset:2048
  buffer_load_dwordx4 v[164:167], v1, s[8:11], s31 offen offset:3072
  v_mov_b64 v[104:105], v[232:233]
  v_mov_b64 v[106:107], v[234:235]
  v_mov_b64 v[108:109], v[236:237]
  v_mov_b64 v[110:111], v[238:239]
  v_mov_b64 v[112:113], v[248:249]
  v_mov_b64 v[114:115], v[250:251]
  v_mov_b64 v[116:117], v[252:253]
  v_mov_b64 v[118:119], v[254:255]
  v_mfma_f32_16x16x32_bf16 v[192:195], v[120:123], v[104:107], 0
  v_mfma_f32_16x16x32_bf16 v[192:195], v[124:127], v[108:111], v[192:195]
  v_mfma_f32_16x16x32_bf16 v[192:195], v[128:131], v[112:115], v[192:195]
  v_mfma_f32_16x16x32_bf16 v[192:195], v[132:135], v[116:119], v[192:195]
  v_mfma_f32_16x16x32_bf16 v[196:199], v[136:139], v[104:107], 0
  v_mfma_f32_16x16x32_bf16 v[196:199], v[140:143], v[108:111], v[196:199]
  v_mfma_f32_16x16x32_bf16 v[196:199], v[144:147], v[112:115], v[196:199]
  v_mfma_f32_16x16x32_bf16 v[196:199], v[148:151], v[116:119], v[196:199]
  s_add_u32 s29, s80, 2
  s_min_u32 s29, s29, 63
  v_cndmask_b32 v192, v246, v192, s[60:61]
  v_cndmask_b32 v193, v246, v193, s[62:63]
  v_cndmask_b32 v194, v246, v194, s[64:65]
  v_cndmask_b32 v195, v246, v195, s[66:67]
  s_nop 1
  v_cndmask_b32 v196, v246, v196, s[68:69]
  v_cndmask_b32 v197, v246, v197, s[70:71]
  v_cndmask_b32 v198, v246, v198, s[72:73]
  v_cndmask_b32 v199, v246, v199, s[74:75]
  s_lshl_b32 s24, s29, 5
  s_add_u32 s24, s24, s56
  s_lshl_b32 s25, s24, 13
  s_add_u32 s25, s25, 67108864
  s_lshl_b32 s24, s24, 14
  s_lshr_b32 s26, s20, 1
  s_lshl_b32 s26, s26, 10
  s_add_u32 s25, s25, s26
  s_add_u32 s31, s25, 0
  buffer_load_dwordx4 v[232:235], v1, s[8:11], s31 offen
  s_add_u32 s31, s24, 0
  buffer_load_dwordx4 v[120:123], v1, s[8:11], s31 offen offset:0
  buffer_load_dwordx4 v[136:139], v1, s[8:11], s31 offen offset:1024
  s_add_u32 s31, s25, 2048
  buffer_load_dwordx4 v[236:239], v1, s[8:11], s31 offen
  s_add_u32 s31, s24, 4096
  buffer_load_dwordx4 v[124:127], v1, s[8:11], s31 offen offset:0
  buffer_load_dwordx4 v[140:143], v1, s[8:11], s31 offen offset:1024
  s_add_u32 s31, s25, 4096
  buffer_load_dwordx4 v[248:251], v1, s[8:11], s31 offen
  s_add_u32 s31, s24, 8192
  buffer_load_dwordx4 v[128:131], v1, s[8:11], s31 offen offset:0
  buffer_load_dwordx4 v[144:147], v1, s[8:11], s31 offen offset:1024
  s_add_u32 s31, s25, 6144
  buffer_load_dwordx4 v[252:255], v1, s[8:11], s31 offen
  s_add_u32 s31, s24, 12288
  buffer_load_dwordx4 v[132:135], v1, s[8:11], s31 offen offset:0
  buffer_load_dwordx4 v[148:151], v1, s[8:11], s31 offen offset:1024
  v_max3_f32 v9, v192, v193, v194
  v_max3_f32 v10, v195, v196, v197
  v_max3_f32 v9, v9, v198, v199
  s_waitcnt vmcnt(16)
  v_fma_f32 v11, v81, v82, v83
  v_fma_f32 v12, v85, v86, v87
  v_fma_f32 v11, v80, v84, v11
  v_cmp_u_f32 vcc, v11, v12
  s_mov_b64 exec, 1
  buffer_store_dword v8, v7, s[8:11], s27 offen sc1
  s_mov_b64 exec, -1
  s_cbranch_vccnz P3_poll
P3_got:
  ds_write_b128 v245, v[80:83] offset:0
  ds_write_b128 v245, v[84:87] offset:1024
  s_waitcnt lgkmcnt(0)
  s_barrier
  ds_read_b128 v[16:19], v244 offset:0
  ds_read_b128 v[20:23], v244 offset:512
  ds_read_b128 v[24:27], v244 offset:4096
  ds_read_b128 v[28:31], v244 offset:4608
  ds_read_b128 v[32:35], v244 offset:1024
  ds_read_b128 v[36:39], v244 offset:1536
  s_waitcnt lgkmcnt(5)
  v_mfma_f32_16x16x32_bf16 v[88:91], a[0:3], v[16:19], 0
  v_mfma_f32_16x16x32_bf16 v[92:95], a[4:7], v[16:19], 0
  ds_read_b128 v[40:43], v244 offset:5120
  s_waitcnt lgkmcnt(5)
  v_mfma_f32_16x16x32_bf16 v[88:91], a[8:11], v[20:23], v[88:91]
  v_mfma_f32_16x16x32_bf16 v[92:95], a[12:15], v[20:23], v[92:95]
  ds_read_b128 v[44:47], v244 offset:5632
  s_waitcnt lgkmcnt(5)
  v_mfma_f32_16x16x32_bf16 v[88:91], a[16:19], v[24:27], v[88:91]
  v_mfma_f32_16x16x32_bf16 v[92:95], a[20:23], v[24:27], v[92:95]
  ds_read_b128 v[48:51], v244 offset:2048
  s_waitcnt lgkmcnt(5)
  v_mfma_f32_16x16x32_bf16 v[88:91], a[24:27], v[28:31], v[88:91]
  v_mfma_f32_16x16x32_bf16 v[92:95], a[28:31], v[28:31], v[92:95]
  ds_read_b128 v[52:55], v244 offset:2560
  s_waitcnt lgkmcnt(5)
  v_mfma_f32_16x16x32_bf16 v[88:91], a[32:35], v[32:35], v[88:91]
  v_mfma_f32_16x16x32_bf16 v[92:95], a[36:39], v[32:35], v[92:95]
  ds_read_b128 v[56:59], v244 offset:6144
  s_waitcnt lgkmcnt(5)
  v_mfma_f32_16x16x32_bf16 v[88:91], a[40:43], v[36:39], v[88:91]
  v_mfma_f32_16x16x32_bf16 v[92:95], a[44:47], v[36:39], v[92:95]
  ds_read_b128 v[60:63], v244 offset:6656
  s_waitcnt lgkmcnt(5)
  v_mfma_f32_16x16x32_bf16 v[88:91], a[48:51], v[40:43], v[88:91]
  v_mfma_f32_16x16x32_bf16 v[92:95], a[52:55], v[40:43], v[92:95]
  ds_read_b128 v[64:67], v244 offset:3072
  s_waitcnt lgkmcnt(5)
  v_mfma_f32_16x16x32_bf16 v[88:91], a[56:59], v[44:47], v[88:91]
  v_mfma_f32_16x16x32_bf16 v[92:95], a[60:63], v[44:47], v[92:95]
  ds_read_b128 v[68:71], v244 offset:3584
  s_waitcnt lgkmcnt(5)
  v_mfma_f32_16x16x32_bf16 v[88:91], a[64:67], v[48:51], v[88:91]
  v_mfma_f32_16x16x32_bf16 v[92:95], a[68:71], v[48:51], v[92:95]
  ds_read_b128 v[72:75], v244 offset:7168
  s_waitcnt lgkmcnt(5)
  v_mfma_f32_16x16x32_bf16 v[88:91], a[72:75], v[52:55], v[88:91]
  v_mfma_f32_16x16x32_bf16 v[92:95], a[76:79], v[52:55], v[92:95]
  ds_read_b128 v[76:79], v244 offset:7680
  s_waitcnt lgkmcnt(5)
  v_mfma_f32_16x16x32_bf16 v[88:91], a[80:83], v[56:59], v[88:91]
  v_mfma_f32_16x16x32_bf16 v[92:95], a[84:87], v[56:59], v[92:95]
  s_waitcnt lgkmcnt(4)
  v_mfma_f32_16x16x32_bf16 v[88:91], a[88:91], v[60:63], v[88:91]
  v_mfma_f32_16x16x32_bf16 v[92:95], a[92:95], v[60:63], v[92:95]
  s_waitcnt lgkmcnt(3)
  v_mfma_f32_16x16x32_bf16 v[88:91], a[96:99], v[64:67], v[88:91]
  v_mfma_f32_16x16x32_bf16 v[92:95], a[100:103], v[64:67], v[92:95]
  s_waitcnt lgkmcnt(2)
  v_mfma_f32_16x16x32_bf16 v[88:91], a[104:107], v[68:71], v[88:91]
  v_mfma_f32_16x16x32_bf16 v[92:95], a[108:111], v[68:71], v[92:95]
  s_waitcnt lgkmcnt(1)
  v_mfma_f32_16x16x32_bf16 v[88:91], a[112:115], v[72:75], v[88:91]
  v_mfma_f32_16x16x32_bf16 v[92:95], a[116:119], v[72:75], v[92:95]
  s_waitcnt lgkmcnt(0)
  v_mfma_f32_16x16x32_bf16 v[88:91], a[120:123], v[76:79], v[88:91]
  v_mfma_f32_16x16x32_bf16 v[92:95], a[124:127], v[76:79], v[92:95]
  v_mfma_f32_16x16x32_bf16 v[96:99], v[16:19], a[128:131], 0
  v_mfma_f32_16x16x32_bf16 v[100:103], v[16:19], a[132:135], 0
  v_mfma_f32_16x16x32_bf16 v[96:99], v[20:23], a[136:139], v[96:99]
  v_mfma_f32_16x16x32_bf16 v[100:103], v[20:23], a[140:143], v[100:103]
  v_cvt_pk_bf16_f32 v80, v88, v89
  v_cvt_pk_bf16_f32 v81, v90, v91
  v_cvt_pk_bf16_f32 v82, v92, v93
  v_cvt_pk_bf16_f32 v83, v94, v95
  ds_write_b128 v245, v[80:83] offset:8192
  v_mfma_f32_16x16x32_bf16 v[96:99], v[24:27], a[144:147], v[96:99]
  v_mfma_f32_16x16x32_bf16 v[100:103], v[24:27], a[148:151], v[100:103]
  v_mfma_f32_16x16x32_bf16 v[96:99], v[28:31], a[152:155], v[96:99]
  v_mfma_f32_16x16x32_bf16 v[100:103], v[28:31], a[156:159], v[100:103]
  s_waitcnt lgkmcnt(0)
  s_barrier
  ds_read_b128 v[168:171], v1 offset:8192
  ds_read_b128 v[172:175], v1 offset:10240
  ds_read_b128 v[176:179], v1 offset:12288
  ds_read_b128 v[180:183], v1 offset:14336
  v_mfma_f32_16x16x32_bf16 v[96:99], v[32:35], a[160:163], v[96:99]
  v_mfma_f32_16x16x32_bf16 v[100:103], v[32:35], a[164:167], v[100:103]
  v_mfma_f32_16x16x32_bf16 v[96:99], v[36:39], a[168:171], v[96:99]
  v_mfma_f32_16x16x32_bf16 v[100:103], v[36:39], a[172:175], v[100:103]
  s_waitcnt lgkmcnt(3)
  v_mfma_f32_16x16x32_bf16 v[200:203], v[168:171], v[104:107], 0
  s_waitcnt lgkmcnt(2)
  v_mfma_f32_16x16x32_bf16 v[200:203], v[172:175], v[108:111], v[200:203]
  s_waitcnt lgkmcnt(1)
  v_mfma_f32_16x16x32_bf16 v[200:203], v[176:179], v[112:115], v[200:203]
  s_waitcnt lgkmcnt(0)
  v_mfma_f32_16x16x32_bf16 v[200:203], v[180:183], v[116:119], v[200:203]
  v_mfma_f32_16x16x32_bf16 v[96:99], v[40:43], a[176:179], v[96:99]
  v_mfma_f32_16x16x32_bf16 v[100:103], v[40:43], a[180:183], v[100:103]
  v_mfma_f32_16x16x32_bf16 v[96:99], v[44:47], a[184:187], v[96:99]
  v_max3_f32 v10, v10, v200, v201
  v_max3_f32 v9, v9, v202, v203
  v_mfma_f32_16x16x32_bf16 v[100:103], v[44:47], a[188:191], v[100:103]
  v_max_f32 v9, v9, v10
  v_mov_b32 v10, v9
  v_mfma_f32_16x16x32_bf16 v[96:99], v[48:51], a[192:195], v[96:99]
  s_nop 0
  v_permlane32_swap_b32 v9, v10
  v_max_f32 v9, v9, v10
  v_mfma_f32_16x16x32_bf16 v[100:103], v[48:51], a[196:199], v[100:103]
  v_mov_b32 v10, v9
  s_nop 1
  v_permlane16_swap_b32 v9, v10
  v_mfma_f32_16x16x32_bf16 v[96:99], v[52:55], a[200:203], v[96:99]
  v_max_f32 v9, v9, v10
  v_mul_f32 v9, s76, v9
  v_mfma_f32_16x16x32_bf16 v[100:103], v[52:55], a[204:207], v[100:103]
  v_add_f32 v10, 1.0, v9
  v_fma_f32 v192, v192, s76, -v9
  v_mfma_f32_16x16x32_bf16 v[96:99], v[56:59], a[208:211], v[96:99]
  v_fma_f32 v193, v193, s76, -v9
  v_fma_f32 v194, v194, s76, -v9
  v_mfma_f32_16x16x32_bf16 v[100:103], v[56:59], a[212:215], v[100:103]
  v_fma_f32 v195, v195, s76, -v9
  v_fma_f32 v196, v196, s76, -v9
  v_mfma_f32_16x16x32_bf16 v[96:99], v[60:63], a[216:219], v[96:99]
  v_fma_f32 v197, v197, s76, -v9
  v_fma_f32 v198, v198, s76, -v9
  v_mfma_f32_16x16x32_bf16 v[100:103], v[60:63], a[220:223], v[100:103]
  v_fma_f32 v199, v199, s76, -v9
  v_fma_f32 v200, v200, s76, -v10
  v_mfma_f32_16x16x32_bf16 v[96:99], v[64:67], a[224:227], v[96:99]
  v_fma_f32 v201, v201, s76, -v10
  v_fma_f32 v202, v202, s76, -v10
  v_mfma_f32_16x16x32_bf16 v[100:103], v[64:67], a[228:231], v[100:103]
  v_fma_f32 v203, v203, s76, -v10
  v_exp_f32 v192, v192
  v_mfma_f32_16x16x32_bf16 v[96:99], v[68:71], a[232:235], v[96:99]
  v_exp_f32 v193, v193
  v_exp_f32 v194, v194
  v_mfma_f32_16x16x32_bf16 v[100:103], v[68:71], a[236:239], v[100:103]
  v_exp_f32 v195, v195
  v_exp_f32 v196, v196
  v_mfma_f32_16x16x32_bf16 v[96:99], v[72:75], a[240:243], v[96:99]
  v_exp_f32 v197, v197
  v_exp_f32 v198, v198
  v_mfma_f32_16x16x32_bf16 v[100:103], v[72:75], a[244:247], v[100:103]
  v_exp_f32 v199, v199
  v_exp_f32 v200, v200
  v_mfma_f32_16x16x32_bf16 v[96:99], v[76:79], a[248:251], v[96:99]
  v_exp_f32 v201, v201
  v_exp_f32 v202, v202
  v_mfma_f32_16x16x32_bf16 v[100:103], v[76:79], a[252:255], v[100:103]
  v_exp_f32 v203, v203
  v_cvt_pk_bf16_f32 v204, v192, v193
  v_cvt_pk_bf16_f32 v205, v194, v195
  v_cvt_pk_bf16_f32 v206, v196, v197
  v_cvt_pk_bf16_f32 v207, v198, v199
  v_cvt_pk_bf16_f32 v208, v200, v201
  v_cvt_pk_bf16_f32 v209, v202, v203
  v_cvt_pk_bf16_f32 v84, v96, v97
  v_cvt_pk_bf16_f32 v85, v98, v99
  v_cvt_pk_bf16_f32 v86, v100, v101
  v_cvt_pk_bf16_f32 v87, v102, v103
  ds_write_b128 v245, v[84:87] offset:9216
  s_waitcnt vmcnt(1)
  v_mfma_f32_16x16x32_bf16 v[228:231], v[240:243], v[204:207], 0
  v_mfma_f32_16x16x32_bf16 v[212:215], v[152:155], v[204:207], 0
  s_waitcnt lgkmcnt(0)
  s_barrier
  ds_read_b128 v[184:187], v247 offset:9216
  ds_read_b128 v[188:191], v247 offset:11264
  v_mfma_f32_16x16x32_bf16 v[216:219], v[156:159], v[204:207], 0
  v_mfma_f32_16x16x32_bf16 v[220:223], v[160:163], v[204:207], 0
  v_mfma_f32_16x16x32_bf16 v[224:227], v[164:167], v[204:207], 0
  v_mfma_f32_16x16x16_bf16 v[228:231], v[240:241], v[208:209], v[228:231]
  s_waitcnt lgkmcnt(1)
  v_mfma_f32_16x16x16_bf16 v[212:215], v[184:185], v[208:209], v[212:215]
  v_mfma_f32_16x16x16_bf16 v[216:219], v[186:187], v[208:209], v[216:219]
  s_waitcnt lgkmcnt(0)
  v_mfma_f32_16x16x16_bf16 v[220:223], v[188:189], v[208:209], v[220:223]
  v_mfma_f32_16x16x16_bf16 v[224:227], v[190:191], v[208:209], v[224:227]
  s_lshl_b32 s24, s80, 1
  s_lshr_b32 s26, s20, 1
  s_add_u32 s24, s24, s26
  s_lshl_b32 s24, s24, 5
  s_add_u32 s24, s24, s56
  s_lshl_b32 s24, s24, 1
  s_and_b32 s26, s20, 1
  s_add_u32 s24, s24, s26
  s_lshl_b32 s24, s24, 11
  s_add_u32 s24, s24, 83886080
  s_cmp_eq_u32 s80, 63
  s_cselect_b32 s24, s78, s24
  v_rcp_f32 v9, v228
  s_nop 0
  v_mul_f32 v212, v212, v9
  v_mul_f32 v213, v213, v9
  v_mul_f32 v214, v214, v9
  v_mul_f32 v215, v215, v9
  v_mul_f32 v216, v216, v9
  v_mul_f32 v217, v217, v9
  v_mul_f32 v218, v218, v9
  v_mul_f32 v219, v219, v9
  v_mul_f32 v220, v220, v9
  v_mul_f32 v221, v221, v9
  v_mul_f32 v222, v222, v9
  v_mul_f32 v223, v223, v9
  v_mul_f32 v224, v224, v9
  v_mul_f32 v225, v225, v9
  v_mul_f32 v226, v226, v9
  v_mul_f32 v227, v227, v9
  v_cvt_pk_bf16_f32 v192, v212, v213
  v_cvt_pk_bf16_f32 v193, v214, v215
  v_cvt_pk_bf16_f32 v194, v216, v217
  v_cvt_pk_bf16_f32 v195, v218, v219
  buffer_store_dwordx4 v[192:195], v13, s[8:11], s24 offen sc1
  v_cvt_pk_bf16_f32 v196, v220, v221
  v_cvt_pk_bf16_f32 v197, v222, v223
  v_cvt_pk_bf16_f32 v198, v224, v225
  v_cvt_pk_bf16_f32 v199, v226, v227
  buffer_store_dwordx4 v[196:199], v14, s[8:11], s24 offen sc1
  s_lshl_b32 s27, s80, 1
  s_lshr_b32 s24, s20, 1
  s_add_u32 s27, s27, s24
  s_lshl_b32 s27, s27, 5
  s_add_u32 s27, s27, s56
  s_lshl_b32 s27, s27, 1
  s_and_b32 s24, s20, 1
  s_add_u32 s27, s27, s24
  s_lshl_b32 s27, s27, 2
  s_add_u32 s27, s27, 51412992
  s_add_u32 s80, s80, 2
  s_cmp_lt_u32 s80, 63
  s_cbranch_scc1 P3_top
  v_mov_b32 v13, v5
  v_mov_b32 v14, v6
  s_cmp_eq_u32 s80, 63
  s_cbranch_scc1 P3_top
  s_mov_b32 s27, s81
  s_waitcnt vmcnt(0)
  s_mov_b64 exec, 1
  buffer_store_dword v8, v7, s[8:11], s27 offen sc1
  s_mov_b64 exec, -1
  s_endpgm
P3_poll:
  s_add_u32 s79, s79, 1
  s_cmp_gt_u32 s79, 524288
  s_cbranch_scc1 L_exit
  buffer_load_dwordx4 v[80:83], v245, s[8:11], s77 offen offset:0 sc1
  buffer_load_dwordx4 v[84:87], v245, s[8:11], s77 offen offset:1024 sc1
  s_waitcnt vmcnt(0)
  v_fma_f32 v11, v81, v82, v83
  v_fma_f32 v12, v85, v86, v87
  v_fma_f32 v11, v80, v84, v11
  v_cmp_u_f32 vcc, v11, v12
  s_cbranch_vccnz P3_poll
  s_branch P3_got
L_exit:
  s_endpgm
L_rec:
  v_lshrrev_b32 v2, 6, v0
  v_and_b32 v0, 63, v0
  v_readfirstlane_b32 s23, v2
  s_load_dwordx2 s[8:9], s[0:1], 112
  s_load_dwordx2 s[36:37], s[0:1], 104
  s_load_dwordx8 s[40:47], s[0:1], 16
  s_mov_b32 s10, 0x10000000
  s_mov_b32 s11, 0x20000
  s_mov_b32 s34, 0x400000
  s_mov_b32 s35, 0x20000
  v_lshlrev_b32 v4, 4, v0
  s_mul_i32 s48, s23, 36896
  v_add_u32 v5, s48, v4
  s_lshl_b32 s49, s23, 11
  s_add_u32 s49, s49, 147584
  v_add_u32 v6, s49, v4
  v_and_b32 v24, 7, v0
  v_mul_u32_u24 v24, 144, v24
  v_lshrrev_b32 v25, 4, v0
  v_lshl_add_u32 v24, v25, 5, v24
  v_add_u32 v18, 160896, v24
  v_bfe_u32 v26, v0, 3, 1
  v_lshlrev_b32 v24, 1, v26
  v_and_b32 v38, 7, v0
  v_xor_b32 v38, v38, v24
  v_lshlrev_b32 v24, 3, v38
  v_lshl_add_u32 v24, v25, 6, v24
  s_lshl_b32 s49, s23, 8
  s_add_u32 s49, s49, 162048
  v_add_u32 v19, s49, v24
  v_mul_u32_u24 v24, 144, v38
  v_lshl_add_u32 v24, v25, 5, v24
  v_lshl_add_u32 v24, v26, 4, v24
  s_mul_i32 s49, s23, 1280
  s_add_u32 s49, s49, 155776
  v_add_u32 v15, s49, v24
  v_lshrrev_b32 v24, 5, v0
  v_mul_u32_u24 v24, 144, v24
  s_mul_i32 s49, s23, 288
  v_add_u32 v24, s49, v24
  v_and_b32 v25, 31, v0
  v_lshl_add_u32 v16, v25, 2, v24
  v_add_u32 v16, 155776, v16
  v_bfe_u32 v25, v0, 3, 2
  v_lshl_add_u32 v24, v25, 5, v24
  v_and_b32 v25, 7, v0
  v_lshl_add_u32 v24, v25, 1, v24
  v_add_u32 v17, 160896, v24
  s_xor_b32 s49, s23, 1
  s_lshl_b32 s49, s49, 11
  s_add_u32 s49, s49, 147584
  v_add_u32 v7, s49, v4
  s_xor_b32 s49, s23, 2
  s_lshl_b32 s49, s49, 11
  s_add_u32 s49, s49, 147584
  v_add_u32 v8, s49, v4
  s_xor_b32 s49, s23, 3
  s_lshl_b32 s49, s49, 11
  s_add_u32 s49, s49, 147584
  v_add_u32 v9, s49, v4
  v_lshrrev_b32 v24, 5, v0
  v_bfe_u32 v25, v0, 2, 1
  v_bfe_u32 v26, v0, 3, 1
  v_bfe_u32 v27, v0, 4, 1
  v_and_b32 v29, 3, v0
  v_lshlrev_b32 v28, 4, v29
  v_lshl_add_u32 v88, v25, 17, v28
  v_lshl_add_u32 v88, v26, 15, v88
  v_lshl_add_u32 v88, v24, 16, v88
  v_lshl_add_u32 v88, v27, 13, v88
  s_lshl_b32 s49, s22, 8
  s_lshl_b32 s50, s23, 6
  s_add_u32 s49, s49, s50
  s_and_b32 s50, s23, 1
  s_lshl_b32 s50, s50, 14
  s_add_u32 s49, s49, s50
  v_add_u32 v88, s49, v88
  v_lshl_add_u32 v89, v24, 12, v28
  v_lshl_add_u32 v89, v27, 11, v89
  v_lshl_add_u32 v89, v25, 10, v89
  v_lshl_add_u32 v89, v26, 6, v89
  s_lshl_b32 s49, s22, 17
  s_lshl_b32 s50, s23, 8
  s_add_u32 s49, s49, s50
  v_add_u32 v89, s49, v89
  v_bfe_u32 v25, v0, 2, 2
  v_lshl_add_u32 v25, v24, 3, v25
  v_lshlrev_b32 v25, 6, v25
  v_lshl_add_u32 v25, v29, 3, v25
  v_mul_u32_u24 v27, 18464, v27
  v_add3_u32 v90, s48, v25, v27
  v_xor_b32 v91, 64, v88
  v_add_u32 v92, 0x4000, v89
  s_and_b32 s49, s23, 1
  s_mul_i32 s49, s49, 18464
  s_add_u32 s62, s48, s49
  s_xor_b32 s50, s23, 1
  s_mul_i32 s50, s50, 36896
  s_add_u32 s63, s50, s49
  s_and_b32 s50, s23, 1
  s_lshl_b32 s50, s50, 21
  s_lshr_b32 s64, s23, 1
  s_lshl_b32 s64, s64, 19
  s_or_b32 s64, s64, s50
  s_xor_b32 s65, s64, 2097152
  s_xor_b32 s66, s64, 524288
  s_xor_b32 s67, s64, 2621440
  s_cmp_eq_u32 s82, 0
  s_mov_b32 s76, 33554432
  s_mov_b32 s77, 54525952
  s_cmov_b32 s76, 50331648
  s_cmov_b32 s77, 50855936
  s_cselect_b32 s21, 2, 0
  s_cselect_b32 s83, 63, 2
  s_cselect_b32 s80, 61, 1
  s_cselect_b32 s57, 1, 1
  s_mov_b32 s81, 4275068928
  s_waitcnt lgkmcnt(0)
  s_mov_b32 s32, s42
  s_mov_b32 s33, s43
  s_add_u32 m0, s62, 17408
  s_nop 0
  buffer_load_dwordx4 v88, s[32:35], s66 offen lds
  s_add_u32 m0, s63, 6144
  s_nop 0
  buffer_load_dwordx4 v91, s[32:35], s66 offen lds
  s_add_u32 m0, s62, 6144
  s_nop 0
  buffer_load_dwordx4 v88, s[32:35], s67 offen lds
  s_add_u32 m0, s63, 17408
  s_nop 0
  buffer_load_dwordx4 v91, s[32:35], s67 offen lds
  s_add_u32 m0, s62, 0
  s_nop 0
  buffer_load_dwordx4 v88, s[32:35], s64 offen lds
  s_add_u32 m0, s63, 1024
  s_nop 0
  buffer_load_dwordx4 v91, s[32:35], s64 offen lds
  s_add_u32 m0, s62, 1024
  s_nop 0
  buffer_load_dwordx4 v88, s[32:35], s65 offen lds
  s_add_u32 m0, s63, 0
  s_nop 0
  buffer_load_dwordx4 v91, s[32:35], s65 offen lds
  s_add_u32 s50, s66, 262144
  s_add_u32 m0, s62, 9216
  s_nop 0
  buffer_load_dwordx4 v88, s[32:35], s50 offen lds
  s_add_u32 m0, s63, 12288
  s_nop 0
  buffer_load_dwordx4 v91, s[32:35], s50 offen lds
  s_add_u32 s50, s67, 262144
  s_add_u32 m0, s62, 12288
  s_nop 0
  buffer_load_dwordx4 v88, s[32:35], s50 offen lds
  s_add_u32 m0, s63, 9216
  s_nop 0
  buffer_load_dwordx4 v91, s[32:35], s50 offen lds
  s_add_u32 s50, s64, 262144
  s_add_u32 m0, s62, 2048
  s_nop 0
  buffer_load_dwordx4 v88, s[32:35], s50 offen lds
  s_add_u32 m0, s63, 3072
  s_nop 0
  buffer_load_dwordx4 v91, s[32:35], s50 offen lds
  s_add_u32 s50, s65, 262144
  s_add_u32 m0, s62, 3072
  s_nop 0
  buffer_load_dwordx4 v88, s[32:35], s50 offen lds
  s_add_u32 m0, s63, 2048
  s_nop 0
  buffer_load_dwordx4 v91, s[32:35], s50 offen lds
  v_and_b32 v30, 15, v0
  v_lshrrev_b32 v31, 4, v0
  s_lshl_b32 s49, s23, 16
  v_lshlrev_b32 v24, 14, v31
  v_add_u32 v24, s49, v24
  v_lshrrev_b32 v25, 3, v30
  v_lshl_add_u32 v24, v25, 13, v24
  v_bfe_u32 v25, v0, 2, 1
  v_lshl_add_u32 v24, v25, 11, v24
  v_lshl_add_u32 v10, v29, 4, v24
  v_lshrrev_b32 v25, 2, v0
  v_mul_u32_u24 v25, 0, v25
  s_mul_i32 s49, s23, 0
  s_add_u32 s49, s49, s22
  v_add_u32 v25, s49, v25
  v_and_b32 v25, 31, v25
  v_lshl_add_u32 v10, v25, 6, v10
  s_mov_b32 s16, s77
  s_add_u32 s17, s16, 4096
  s_lshl_b32 s14, s22, 2
  s_add_u32 s14, s14, s23
  s_lshl_b32 s18, s14, 12
  s_lshl_b32 s14, s14, 11
  s_add_u32 s14, s14, s77
  s_lshl_b32 s49, s21, 19
  s_add_u32 s18, s18, s49
  s_mov_b32 s31, s18
  s_mov_b32 s24, 0
  s_mov_b32 s25, 0x207
  s_mov_b32 s26, 0x00ff00ff
  s_mov_b32 s27, 0x00ff00ff
  s_mov_b32 s28, 0x3f803f80
  s_mov_b32 s29, 0x3f803f80
  s_mov_b32 s52, 0x3f003f00
  s_mov_b32 s53, 0x3f003f00
  s_mov_b32 s30, 0x3e0293ee
  s_lshl_b32 s49, s22, 7
  s_lshl_b32 s56, s23, 5
  s_add_u32 s56, s56, s49
  s_add_u32 s56, s56, 51380224
  s_add_u32 s58, s56, 24
  s_mov_b32 s55, 0
  s_lshl_b32 s54, s23, 11
  s_add_u32 s54, s54, s76
  s_lshr_b32 s49, s22, 3
  s_lshl_b32 s49, s49, 1
  s_lshr_b32 s50, s23, 1
  s_add_u32 s49, s49, s50
  s_lshl_b32 s49, s49, 1
  s_bfe_u32 s50, s22, 0x10002
  s_add_u32 s49, s49, s50
  s_lshl_b32 s49, s49, 2
  s_and_b32 s50, s22, 1
  s_lshl_b32 s50, s50, 1
  s_and_b32 s51, s23, 1
  s_add_u32 s50, s50, s51
  s_lshl_b32 s51, s50, 3
  s_add_u32 s49, s49, s50
  s_lshl_b32 s49, s49, 1
  s_bfe_u32 s50, s22, 0x10001
  s_add_u32 s49, s49, s50
  s_lshl_b32 s49, s49, 6
  s_lshl_b32 s50, s50, 12
  s_and_b32 s49, s49, 0x3ff
  s_lshr_b32 s50, s22, 3
  s_lshl_b32 s50, s50, 10
  s_or_b32 s49, s49, s50
  s_lshr_b32 s50, s23, 1
  s_lshl_b32 s50, s50, 12
  s_or_b32 s49, s49, s50
  s_add_u32 s20, s49, 53477376
  s_add_u32 s13, s49, s76
  s_add_u32 s59, s13, 16384
  s_add_u32 s12, s13, 8192
  v_lshlrev_b32 v26, 2, v29
  v_lshl_add_u32 v11, v31, 4, v26
  v_mov_b64 v[20:21], -1
  v_mov_b64 v[22:23], -1
  s_cmp_eq_u32 s82, 0
  s_cbranch_scc0 L_nors
  buffer_store_dwordx4 v[20:23], v4, s[8:11], s14 offen offset:0 sc1
  buffer_store_dwordx4 v[20:23], v4, s[8:11], s14 offen offset:1024 sc1
  buffer_store_dword v20, v11, s[8:11], s12 offen sc1
L_nors:
  v_mov_b32 v24, 0x4444
  v_mov_b32 v25, 0xeeee
  v_cndmask_b32 v1, v25, v24, s[26:27]
  v_and_b32 v24, 1, v31
  v_lshlrev_b32 v24, 2, v24
  v_sub_u32 v24, v38, v24
  v_mov_b32 v36, 0x3f80
  v_mov_b32 v37, 0x3f800000
  v_cmp_eq_u32 vcc, 0, v24
  s_nop 1
  v_cndmask_b32 v25, 0, v36, vcc
  v_cmp_eq_u32 vcc, 1, v24
  s_nop 1
  v_cndmask_b32 v2, v25, v37, vcc
  v_cmp_eq_u32 vcc, 2, v24
  s_nop 1
  v_cndmask_b32 v25, 0, v36, vcc
  v_cmp_eq_u32 vcc, 3, v24
  s_nop 1
  v_cndmask_b32 v3, v25, v37, vcc
  v_and_b32 v24, 5, v0
  v_cmp_eq_u32 vcc, 0, v24
  s_nop 1
  v_cndmask_b32 v12, 0, v36, vcc
  v_cmp_eq_u32 vcc, 4, v24
  s_nop 1
  v_cndmask_b32 v12, v12, v37, vcc
  v_bfe_u32 v24, v0, 1, 1
  v_bfe_u32 v25, v0, 3, 1
  v_lshl_add_u32 v24, v24, 1, v25
  v_lshrrev_b32 v25, 5, v0
  v_lshl_add_u32 v24, v24, 3, v25
  v_and_b32 v25, 1, v0
  v_lshl_add_u32 v24, v24, 1, v25
  s_lshl_b32 s49, s23, 4
  s_add_u32 s49, s49, 162048
  v_lshl_add_u32 v13, v24, 2, s49
  s_getreg_b32 s60, hwreg(HW_REG_XCC_ID)
  s_and_b32 s60, s60, 7
  s_or_b32 s60, s60, 0x80
  v_mov_b32 v24, s60
  s_mul_i32 s60, s60, 0x01010101
  s_lshl_b32 s49, s22, 2
  s_add_u32 s49, s49, s23
  v_mov_b32 v25, s49
  s_cmp_eq_u32 s82, 0
  s_cselect_b32 s49, 63, 31
  s_cselect_b32 s50, 2, 1
  v_and_b32 v33, s49, v0
  v_lshlrev_b32 v33, 2, v33
  v_min_u32 v35, s50, v0
  v_add_lshl_u32 v35, v35, s21, 2
  v_lshlrev_b32 v14, 2, v4
  s_add_u32 s19, s18, 524288
  s_waitcnt vmcnt(12)
  s_barrier
  s_add_u32 s50, s66, 1048576
  s_add_u32 m0, s62, 13312
  ds_read_b64_tr_b16 a[112:113], v90 offset:17408
  buffer_load_dwordx4 v88, s[32:35], s50 offen lds
  s_add_u32 m0, s63, 7168
  ds_read_b64_tr_b16 a[114:115], v90 offset:17664
  buffer_load_dwordx4 v91, s[32:35], s50 offen lds
  s_add_u32 s50, s67, 1048576
  s_add_u32 m0, s62, 7168
  ds_read_b64_tr_b16 a[120:121], v90 offset:17440
  buffer_load_dwordx4 v88, s[32:35], s50 offen lds
  s_add_u32 m0, s63, 13312
  ds_read_b64_tr_b16 a[122:123], v90 offset:17696
  buffer_load_dwordx4 v91, s[32:35], s50 offen lds
  ds_read_b64_tr_b16 a[128:129], v90 offset:6144
  ds_read_b64_tr_b16 a[130:131], v90 offset:6400
  ds_read_b64_tr_b16 a[136:137], v90 offset:6176
  ds_read_b64_tr_b16 a[138:139], v90 offset:6432
  s_waitcnt vmcnt(12)
  s_waitcnt lgkmcnt(0)
  s_barrier
  s_add_u32 s50, s64, 1048576
  s_add_u32 m0, s62, 10240
  ds_read_b64_tr_b16 v[72:73], v90 offset:0
  buffer_load_dwordx4 v88, s[32:35], s50 offen lds
  s_add_u32 m0, s63, 4096
  ds_read_b64_tr_b16 v[74:75], v90 offset:256
  buffer_load_dwordx4 v91, s[32:35], s50 offen lds
  s_add_u32 s50, s65, 1048576
  s_add_u32 m0, s62, 4096
  ds_read_b64_tr_b16 v[80:81], v90 offset:32
  buffer_load_dwordx4 v88, s[32:35], s50 offen lds
  s_add_u32 m0, s63, 10240
  ds_read_b64_tr_b16 v[82:83], v90 offset:288
  buffer_load_dwordx4 v91, s[32:35], s50 offen lds
  ds_read_b64_tr_b16 v[96:97], v90 offset:1024
  ds_read_b64_tr_b16 v[98:99], v90 offset:1280
  ds_read_b64_tr_b16 v[104:105], v90 offset:1056
  ds_read_b64_tr_b16 v[106:107], v90 offset:1312
  s_waitcnt lgkmcnt(0)
  ds_write_b128 v5, v[72:75] offset:0
  ds_write_b128 v5, v[80:83] offset:18464
  ds_write_b128 v5, v[96:99] offset:1024
  ds_write_b128 v5, v[104:107] offset:19488
  s_waitcnt vmcnt(12)
  s_barrier
  s_add_u32 s50, s66, 1310720
  s_add_u32 m0, s62, 14336
  ds_read_b64_tr_b16 a[116:117], v90 offset:9216
  buffer_load_dwordx4 v88, s[32:35], s50 offen lds
  s_add_u32 m0, s63, 15360
  ds_read_b64_tr_b16 a[118:119], v90 offset:9472
  buffer_load_dwordx4 v91, s[32:35], s50 offen lds
  s_add_u32 s50, s67, 1310720
  s_add_u32 m0, s62, 15360
  ds_read_b64_tr_b16 a[124:125], v90 offset:9248
  buffer_load_dwordx4 v88, s[32:35], s50 offen lds
  s_add_u32 m0, s63, 14336
  ds_read_b64_tr_b16 a[126:127], v90 offset:9504
  buffer_load_dwordx4 v91, s[32:35], s50 offen lds
  ds_read_b64_tr_b16 a[132:133], v90 offset:12288
  ds_read_b64_tr_b16 a[134:135], v90 offset:12544
  ds_read_b64_tr_b16 a[140:141], v90 offset:12320
  ds_read_b64_tr_b16 a[142:143], v90 offset:12576
  s_waitcnt vmcnt(12)
  s_waitcnt lgkmcnt(0)
  s_barrier
  s_add_u32 s50, s64, 1310720
  s_add_u32 m0, s62, 8192
  ds_read_b64_tr_b16 v[76:77], v90 offset:2048
  buffer_load_dwordx4 v88, s[32:35], s50 offen lds
  s_add_u32 m0, s63, 5120
  ds_read_b64_tr_b16 v[78:79], v90 offset:2304
  buffer_load_dwordx4 v91, s[32:35], s50 offen lds
  s_add_u32 s50, s65, 1310720
  s_add_u32 m0, s62, 5120
  ds_read_b64_tr_b16 v[84:85], v90 offset:2080
  buffer_load_dwordx4 v88, s[32:35], s50 offen lds
  s_add_u32 m0, s63, 8192
  ds_read_b64_tr_b16 v[86:87], v90 offset:2336
  buffer_load_dwordx4 v91, s[32:35], s50 offen lds
  ds_read_b64_tr_b16 v[100:101], v90 offset:3072
  ds_read_b64_tr_b16 v[102:103], v90 offset:3328
  ds_read_b64_tr_b16 v[108:109], v90 offset:3104
  ds_read_b64_tr_b16 v[110:111], v90 offset:3360
  s_waitcnt lgkmcnt(0)
  ds_write_b128 v5, v[76:79] offset:2048
  ds_write_b128 v5, v[84:87] offset:20512
  ds_write_b128 v5, v[100:103] offset:3072
  ds_write_b128 v5, v[108:111] offset:21536
  s_waitcnt vmcnt(12)
  s_barrier
  s_cmp_eq_u32 s82, 0
  s_cbranch_scc0 L_noar
  global_store_byte v25, v24, s[36:37] offset:128 sc1
L_noar:
  s_mov_b32 s32, s44
  s_mov_b32 s33, s45
  s_add_u32 m0, s62, 16384
  ds_read_b64_tr_b16 a[160:161], v90 offset:13312
  buffer_load_dwordx4 v88, s[32:35], s66 offen lds
  s_add_u32 m0, s63, 11264
  ds_read_b64_tr_b16 a[162:163], v90 offset:13568
  buffer_load_dwordx4 v91, s[32:35], s66 offen lds
  s_add_u32 m0, s62, 11264
  ds_read_b64_tr_b16 a[168:169], v90 offset:13344
  buffer_load_dwordx4 v88, s[32:35], s67 offen lds
  s_add_u32 m0, s63, 16384
  ds_read_b64_tr_b16 a[170:171], v90 offset:13600
  buffer_load_dwordx4 v91, s[32:35], s67 offen lds
  ds_read_b64_tr_b16 a[176:177], v90 offset:7168
  ds_read_b64_tr_b16 a[178:179], v90 offset:7424
  ds_read_b64_tr_b16 a[184:185], v90 offset:7200
  ds_read_b64_tr_b16 a[186:187], v90 offset:7456
  s_waitcnt vmcnt(12)
  s_waitcnt lgkmcnt(0)
  s_barrier
  s_add_u32 m0, s62, 17408
  ds_read_b64_tr_b16 a[144:145], v90 offset:10240
  buffer_load_dwordx4 v88, s[32:35], s64 offen lds
  s_add_u32 m0, s63, 6144
  ds_read_b64_tr_b16 a[146:147], v90 offset:10496
  buffer_load_dwordx4 v91, s[32:35], s64 offen lds
  s_add_u32 m0, s62, 6144
  ds_read_b64_tr_b16 a[152:153], v90 offset:10272
  buffer_load_dwordx4 v88, s[32:35], s65 offen lds
  s_add_u32 m0, s63, 17408
  ds_read_b64_tr_b16 a[154:155], v90 offset:10528
  buffer_load_dwordx4 v91, s[32:35], s65 offen lds
  ds_read_b64_tr_b16 v[96:97], v90 offset:4096
  ds_read_b64_tr_b16 v[98:99], v90 offset:4352
  ds_read_b64_tr_b16 v[104:105], v90 offset:4128
  ds_read_b64_tr_b16 v[106:107], v90 offset:4384
  s_waitcnt lgkmcnt(0)
  ds_write_b128 v5, v[96:99] offset:4096
  ds_write_b128 v5, v[104:107] offset:22560
  s_waitcnt vmcnt(12)
  s_barrier
  s_add_u32 s50, s66, 262144
  s_add_u32 m0, s62, 9216
  ds_read_b64_tr_b16 a[164:165], v90 offset:14336
  buffer_load_dwordx4 v88, s[32:35], s50 offen lds
  s_add_u32 m0, s63, 12288
  ds_read_b64_tr_b16 a[166:167], v90 offset:14592
  buffer_load_dwordx4 v91, s[32:35], s50 offen lds
  s_add_u32 s50, s67, 262144
  s_add_u32 m0, s62, 12288
  ds_read_b64_tr_b16 a[172:173], v90 offset:14368
  buffer_load_dwordx4 v88, s[32:35], s50 offen lds
  s_add_u32 m0, s63, 9216
  ds_read_b64_tr_b16 a[174:175], v90 offset:14624
  buffer_load_dwordx4 v91, s[32:35], s50 offen lds
  ds_read_b64_tr_b16 a[180:181], v90 offset:15360
  ds_read_b64_tr_b16 a[182:183], v90 offset:15616
  ds_read_b64_tr_b16 a[188:189], v90 offset:15392
  ds_read_b64_tr_b16 a[190:191], v90 offset:15648
  s_waitcnt vmcnt(12)
  s_waitcnt lgkmcnt(0)
  s_barrier
  s_add_u32 s50, s64, 262144
  s_add_u32 m0, s62, 13312
  ds_read_b64_tr_b16 a[148:149], v90 offset:8192
  buffer_load_dwordx4 v88, s[32:35], s50 offen lds
  s_add_u32 m0, s63, 7168
  ds_read_b64_tr_b16 a[150:151], v90 offset:8448
  buffer_load_dwordx4 v91, s[32:35], s50 offen lds
  s_add_u32 s50, s65, 262144
  s_add_u32 m0, s62, 7168
  ds_read_b64_tr_b16 a[156:157], v90 offset:8224
  buffer_load_dwordx4 v88, s[32:35], s50 offen lds
  s_add_u32 m0, s63, 13312
  ds_read_b64_tr_b16 a[158:159], v90 offset:8480
  buffer_load_dwordx4 v91, s[32:35], s50 offen lds
  ds_read_b64_tr_b16 v[100:101], v90 offset:5120
  ds_read_b64_tr_b16 v[102:103], v90 offset:5376
  ds_read_b64_tr_b16 v[108:109], v90 offset:5152
  ds_read_b64_tr_b16 v[110:111], v90 offset:5408
  s_waitcnt lgkmcnt(0)
  ds_write_b128 v5, v[100:103] offset:5120
  ds_write_b128 v5, v[108:111] offset:23584
  s_waitcnt vmcnt(12)
  s_barrier
  s_add_u32 s50, s66, 1048576
  s_add_u32 m0, s62, 10240
  ds_read_b64_tr_b16 a[208:209], v90 offset:16384
  buffer_load_dwordx4 v88, s[32:35], s50 offen lds
  s_add_u32 m0, s63, 14336
  ds_read_b64_tr_b16 a[210:211], v90 offset:16640
  buffer_load_dwordx4 v91, s[32:35], s50 offen lds
  s_add_u32 s50, s67, 1048576
  s_add_u32 m0, s62, 14336
  ds_read_b64_tr_b16 a[216:217], v90 offset:16416
  buffer_load_dwordx4 v88, s[32:35], s50 offen lds
  s_add_u32 m0, s63, 10240
  ds_read_b64_tr_b16 a[218:219], v90 offset:16672
  buffer_load_dwordx4 v91, s[32:35], s50 offen lds
  ds_read_b64_tr_b16 a[224:225], v90 offset:11264
  ds_read_b64_tr_b16 a[226:227], v90 offset:11520
  ds_read_b64_tr_b16 a[232:233], v90 offset:11296
  ds_read_b64_tr_b16 a[234:235], v90 offset:11552
  s_waitcnt vmcnt(12)
  s_waitcnt lgkmcnt(0)
  s_barrier
  s_add_u32 s50, s64, 1048576
  s_add_u32 m0, s62, 15360
  ds_read_b64_tr_b16 a[192:193], v90 offset:17408
  buffer_load_dwordx4 v88, s[32:35], s50 offen lds
  s_add_u32 m0, s63, 8192
  ds_read_b64_tr_b16 a[194:195], v90 offset:17664
  buffer_load_dwordx4 v91, s[32:35], s50 offen lds
  s_add_u32 s50, s65, 1048576
  s_add_u32 m0, s62, 8192
  ds_read_b64_tr_b16 a[200:201], v90 offset:17440
  buffer_load_dwordx4 v88, s[32:35], s50 offen lds
  s_add_u32 m0, s63, 15360
  ds_read_b64_tr_b16 a[202:203], v90 offset:17696
  buffer_load_dwordx4 v91, s[32:35], s50 offen lds
  ds_read_b64_tr_b16 v[96:97], v90 offset:6144
  ds_read_b64_tr_b16 v[98:99], v90 offset:6400
  ds_read_b64_tr_b16 v[104:105], v90 offset:6176
  ds_read_b64_tr_b16 v[106:107], v90 offset:6432
  s_waitcnt lgkmcnt(0)
  ds_write_b128 v5, v[96:99] offset:6144
  ds_write_b128 v5, v[104:107] offset:24608
  s_waitcnt vmcnt(12)
  s_barrier
  s_add_u32 s50, s66, 1310720
  s_add_u32 m0, s62, 16384
  ds_read_b64_tr_b16 a[212:213], v90 offset:9216
  buffer_load_dwordx4 v88, s[32:35], s50 offen lds
  s_add_u32 m0, s63, 11264
  ds_read_b64_tr_b16 a[214:215], v90 offset:9472
  buffer_load_dwordx4 v91, s[32:35], s50 offen lds
  s_add_u32 s50, s67, 1310720
  s_add_u32 m0, s62, 11264
  ds_read_b64_tr_b16 a[220:221], v90 offset:9248
  buffer_load_dwordx4 v88, s[32:35], s50 offen lds
  s_add_u32 m0, s63, 16384
  ds_read_b64_tr_b16 a[222:223], v90 offset:9504
  buffer_load_dwordx4 v91, s[32:35], s50 offen lds
  ds_read_b64_tr_b16 a[228:229], v90 offset:12288
  ds_read_b64_tr_b16 a[230:231], v90 offset:12544
  ds_read_b64_tr_b16 a[236:237], v90 offset:12320
  ds_read_b64_tr_b16 a[238:239], v90 offset:12576
  s_waitcnt vmcnt(12)
  s_waitcnt lgkmcnt(0)
  s_barrier
  s_add_u32 s50, s64, 1310720
  s_add_u32 m0, s62, 17408
  ds_read_b64_tr_b16 a[196:197], v90 offset:13312
  buffer_load_dwordx4 v88, s[32:35], s50 offen lds
  s_add_u32 m0, s63, 9216
  ds_read_b64_tr_b16 a[198:199], v90 offset:13568
  buffer_load_dwordx4 v91, s[32:35], s50 offen lds
  s_add_u32 s50, s65, 1310720
  s_add_u32 m0, s62, 9216
  ds_read_b64_tr_b16 a[204:205], v90 offset:13344
  buffer_load_dwordx4 v88, s[32:35], s50 offen lds
  s_add_u32 m0, s63, 17408
  ds_read_b64_tr_b16 a[206:207], v90 offset:13600
  buffer_load_dwordx4 v91, s[32:35], s50 offen lds
  ds_read_b64_tr_b16 v[100:101], v90 offset:7168
  ds_read_b64_tr_b16 v[102:103], v90 offset:7424
  ds_read_b64_tr_b16 v[108:109], v90 offset:7200
  ds_read_b64_tr_b16 v[110:111], v90 offset:7456
  s_waitcnt lgkmcnt(0)
  ds_write_b128 v5, v[100:103] offset:7168
  ds_write_b128 v5, v[108:111] offset:25632
  s_waitcnt vmcnt(12)
  s_barrier
  s_mov_b32 s32, s40
  s_mov_b32 s33, s41
  s_add_u32 m0, s62, 12288
  ds_read_b64_tr_b16 v[144:145], v90 offset:10240
  buffer_load_dwordx4 v88, s[32:35], s66 offen lds
  s_add_u32 m0, s63, 13312
  ds_read_b64_tr_b16 v[146:147], v90 offset:10496
  buffer_load_dwordx4 v91, s[32:35], s66 offen lds
  s_add_u32 m0, s62, 13312
  ds_read_b64_tr_b16 v[152:153], v90 offset:10272
  buffer_load_dwordx4 v88, s[32:35], s67 offen lds
  s_add_u32 m0, s63, 12288
  ds_read_b64_tr_b16 v[154:155], v90 offset:10528
  buffer_load_dwordx4 v91, s[32:35], s67 offen lds
  ds_read_b64_tr_b16 v[160:161], v90 offset:14336
  ds_read_b64_tr_b16 v[162:163], v90 offset:14592
  ds_read_b64_tr_b16 v[168:169], v90 offset:14368
  ds_read_b64_tr_b16 v[170:171], v90 offset:14624
  s_waitcnt vmcnt(12)
  s_waitcnt lgkmcnt(0)
  s_barrier
  s_add_u32 m0, s62, 10240
  ds_read_b64_tr_b16 a[240:241], v90 offset:15360
  buffer_load_dwordx4 v88, s[32:35], s64 offen lds
  s_add_u32 m0, s63, 14336
  ds_read_b64_tr_b16 a[242:243], v90 offset:15616
  buffer_load_dwordx4 v91, s[32:35], s64 offen lds
  s_add_u32 m0, s62, 14336
  ds_read_b64_tr_b16 a[248:249], v90 offset:15392
  buffer_load_dwordx4 v88, s[32:35], s65 offen lds
  s_add_u32 m0, s63, 10240
  ds_read_b64_tr_b16 a[250:251], v90 offset:15648
  buffer_load_dwordx4 v91, s[32:35], s65 offen lds
  ds_read_b64_tr_b16 v[96:97], v90 offset:8192
  ds_read_b64_tr_b16 v[98:99], v90 offset:8448
  ds_read_b64_tr_b16 v[104:105], v90 offset:8224
  ds_read_b64_tr_b16 v[106:107], v90 offset:8480
  s_waitcnt lgkmcnt(0)
  ds_write_b128 v5, v[96:99] offset:8192
  ds_write_b128 v5, v[104:107] offset:26656
  s_waitcnt vmcnt(12)
  s_barrier
  ds_read_b64_tr_b16 v[148:149], v90 offset:16384
  ds_read_b64_tr_b16 v[150:151], v90 offset:16640
  ds_read_b64_tr_b16 v[156:157], v90 offset:16416
  ds_read_b64_tr_b16 v[158:159], v90 offset:16672
  ds_read_b64_tr_b16 v[164:165], v90 offset:11264
  ds_read_b64_tr_b16 v[166:167], v90 offset:11520
  ds_read_b64_tr_b16 v[172:173], v90 offset:11296
  ds_read_b64_tr_b16 v[174:175], v90 offset:11552
  s_waitcnt vmcnt(8)
  s_waitcnt lgkmcnt(0)
  s_barrier
  s_add_u32 s50, s66, 262144
  s_add_u32 m0, s62, 15360
  ds_read_b64_tr_b16 a[244:245], v90 offset:17408
  buffer_load_dwordx4 v88, s[32:35], s50 offen lds
  s_add_u32 m0, s63, 16384
  ds_read_b64_tr_b16 a[246:247], v90 offset:17664
  buffer_load_dwordx4 v91, s[32:35], s50 offen lds
  s_add_u32 s50, s67, 262144
  s_add_u32 m0, s62, 16384
  ds_read_b64_tr_b16 a[252:253], v90 offset:17440
  buffer_load_dwordx4 v88, s[32:35], s50 offen lds
  s_add_u32 m0, s63, 15360
  ds_read_b64_tr_b16 a[254:255], v90 offset:17696
  buffer_load_dwordx4 v91, s[32:35], s50 offen lds
  ds_read_b64_tr_b16 v[100:101], v90 offset:9216
  ds_read_b64_tr_b16 v[102:103], v90 offset:9472
  ds_read_b64_tr_b16 v[108:109], v90 offset:9248
  ds_read_b64_tr_b16 v[110:111], v90 offset:9504
  s_waitcnt lgkmcnt(0)
  ds_write_b128 v5, v[100:103] offset:9216
  ds_write_b128 v5, v[108:111] offset:27680
  s_waitcnt vmcnt(8)
  s_barrier
  s_add_u32 s50, s64, 262144
  s_add_u32 m0, s62, 11264
  ds_read_b64_tr_b16 a[16:17], v90 offset:12288
  buffer_load_dwordx4 v88, s[32:35], s50 offen lds
  s_add_u32 m0, s63, 17408
  ds_read_b64_tr_b16 a[18:19], v90 offset:12544
  buffer_load_dwordx4 v91, s[32:35], s50 offen lds
  s_add_u32 s50, s65, 262144
  s_add_u32 m0, s62, 17408
  ds_read_b64_tr_b16 a[24:25], v90 offset:12320
  buffer_load_dwordx4 v88, s[32:35], s50 offen lds
  s_add_u32 m0, s63, 11264
  ds_read_b64_tr_b16 a[26:27], v90 offset:12576
  buffer_load_dwordx4 v91, s[32:35], s50 offen lds
  ds_read_b64_tr_b16 a[32:33], v90 offset:13312
  ds_read_b64_tr_b16 a[34:35], v90 offset:13568
  ds_read_b64_tr_b16 a[40:41], v90 offset:13344
  ds_read_b64_tr_b16 a[42:43], v90 offset:13600
  s_waitcnt vmcnt(8)
  s_waitcnt lgkmcnt(0)
  s_barrier
  s_add_u32 s50, s66, 1048576
  s_add_u32 m0, s62, 12288
  ds_read_b64_tr_b16 v[72:73], v90 offset:10240
  buffer_load_dwordx4 v88, s[32:35], s50 offen lds
  s_add_u32 m0, s63, 13312
  ds_read_b64_tr_b16 v[74:75], v90 offset:10496
  buffer_load_dwordx4 v91, s[32:35], s50 offen lds
  s_add_u32 s50, s67, 1048576
  s_add_u32 m0, s62, 13312
  ds_read_b64_tr_b16 v[80:81], v90 offset:10272
  buffer_load_dwordx4 v88, s[32:35], s50 offen lds
  s_add_u32 m0, s63, 12288
  ds_read_b64_tr_b16 v[82:83], v90 offset:10528
  buffer_load_dwordx4 v91, s[32:35], s50 offen lds
  ds_read_b64_tr_b16 a[0:1], v90 offset:14336
  ds_read_b64_tr_b16 a[2:3], v90 offset:14592
  ds_read_b64_tr_b16 a[8:9], v90 offset:14368
  ds_read_b64_tr_b16 a[10:11], v90 offset:14624
  s_waitcnt lgkmcnt(0)
  ds_write_b128 v5, v[72:75] offset:10240
  ds_write_b128 v5, v[80:83] offset:28704
  s_waitcnt vmcnt(8)
  s_barrier
  ds_read_b64_tr_b16 a[20:21], v90 offset:15360
  ds_read_b64_tr_b16 a[22:23], v90 offset:15616
  ds_read_b64_tr_b16 a[28:29], v90 offset:15392
  ds_read_b64_tr_b16 a[30:31], v90 offset:15648
  ds_read_b64_tr_b16 a[36:37], v90 offset:16384
  ds_read_b64_tr_b16 a[38:39], v90 offset:16640
  ds_read_b64_tr_b16 a[44:45], v90 offset:16416
  ds_read_b64_tr_b16 a[46:47], v90 offset:16672
  s_waitcnt vmcnt(4)
  s_waitcnt lgkmcnt(0)
  s_barrier
  s_add_u32 s50, s64, 1048576
  s_add_u32 m0, s62, 14336
  ds_read_b64_tr_b16 v[76:77], v90 offset:11264
  buffer_load_dwordx4 v88, s[32:35], s50 offen lds
  s_add_u32 m0, s63, 15360
  ds_read_b64_tr_b16 v[78:79], v90 offset:11520
  buffer_load_dwordx4 v91, s[32:35], s50 offen lds
  s_add_u32 s50, s65, 1048576
  s_add_u32 m0, s62, 15360
  ds_read_b64_tr_b16 v[84:85], v90 offset:11296
  buffer_load_dwordx4 v88, s[32:35], s50 offen lds
  s_add_u32 m0, s63, 14336
  ds_read_b64_tr_b16 v[86:87], v90 offset:11552
  buffer_load_dwordx4 v91, s[32:35], s50 offen lds
  ds_read_b64_tr_b16 a[4:5], v90 offset:17408
  ds_read_b64_tr_b16 a[6:7], v90 offset:17664
  ds_read_b64_tr_b16 a[12:13], v90 offset:17440
  ds_read_b64_tr_b16 a[14:15], v90 offset:17696
  s_waitcnt lgkmcnt(0)
  ds_write_b128 v5, v[76:79] offset:11264
  ds_write_b128 v5, v[84:87] offset:29728
  s_waitcnt vmcnt(4)
  s_barrier
  s_add_u32 s50, s66, 1310720
  s_add_u32 m0, s62, 16384
  ds_read_b64_tr_b16 a[80:81], v90 offset:12288
  buffer_load_dwordx4 v88, s[32:35], s50 offen lds
  s_add_u32 m0, s63, 17408
  ds_read_b64_tr_b16 a[82:83], v90 offset:12544
  buffer_load_dwordx4 v91, s[32:35], s50 offen lds
  s_add_u32 s50, s67, 1310720
  s_add_u32 m0, s62, 17408
  ds_read_b64_tr_b16 a[88:89], v90 offset:12320
  buffer_load_dwordx4 v88, s[32:35], s50 offen lds
  s_add_u32 m0, s63, 16384
  ds_read_b64_tr_b16 a[90:91], v90 offset:12576
  buffer_load_dwordx4 v91, s[32:35], s50 offen lds
  ds_read_b64_tr_b16 a[96:97], v90 offset:13312
  ds_read_b64_tr_b16 a[98:99], v90 offset:13568
  ds_read_b64_tr_b16 a[104:105], v90 offset:13344
  ds_read_b64_tr_b16 a[106:107], v90 offset:13600
  s_waitcnt vmcnt(4)
  s_waitcnt lgkmcnt(0)
  s_barrier
  s_add_u32 s50, s64, 1310720
  s_add_u32 m0, s62, 12288
  ds_read_b64_tr_b16 a[48:49], v90 offset:14336
  buffer_load_dwordx4 v88, s[32:35], s50 offen lds
  s_add_u32 m0, s63, 13312
  ds_read_b64_tr_b16 a[50:51], v90 offset:14592
  buffer_load_dwordx4 v91, s[32:35], s50 offen lds
  s_add_u32 s50, s65, 1310720
  s_add_u32 m0, s62, 13312
  ds_read_b64_tr_b16 a[56:57], v90 offset:14368
  buffer_load_dwordx4 v88, s[32:35], s50 offen lds
  s_add_u32 m0, s63, 12288
  ds_read_b64_tr_b16 a[58:59], v90 offset:14624
  buffer_load_dwordx4 v91, s[32:35], s50 offen lds
  ds_read_b64_tr_b16 a[64:65], v90 offset:15360
  ds_read_b64_tr_b16 a[66:67], v90 offset:15616
  ds_read_b64_tr_b16 a[72:73], v90 offset:15392
  ds_read_b64_tr_b16 a[74:75], v90 offset:15648
  s_waitcnt vmcnt(4)
  s_waitcnt lgkmcnt(0)
  s_barrier
  s_mov_b32 s32, s46
  s_mov_b32 s33, s47
  s_lshl_b32 s64, s23, 15
  s_xor_b32 s65, s64, 32768
  s_xor_b32 s66, s64, 65536
  s_xor_b32 s67, s64, 98304
  s_add_u32 m0, s48, 14336
  ds_read_b64_tr_b16 a[84:85], v90 offset:16384
  buffer_load_dwordx4 v89, s[32:35], s64 offen lds
  s_add_u32 m0, s48, 32800
  ds_read_b64_tr_b16 a[86:87], v90 offset:16640
  buffer_load_dwordx4 v92, s[32:35], s64 offen lds
  s_add_u32 s50, s64, 128
  s_add_u32 m0, s48, 15360
  ds_read_b64_tr_b16 a[92:93], v90 offset:16416
  buffer_load_dwordx4 v89, s[32:35], s50 offen lds
  s_add_u32 m0, s48, 33824
  ds_read_b64_tr_b16 a[94:95], v90 offset:16672
  buffer_load_dwordx4 v92, s[32:35], s50 offen lds
  ds_read_b64_tr_b16 a[100:101], v90 offset:17408
  ds_read_b64_tr_b16 a[102:103], v90 offset:17664
  ds_read_b64_tr_b16 a[108:109], v90 offset:17440
  ds_read_b64_tr_b16 a[110:111], v90 offset:17696
  s_waitcnt vmcnt(4)
  s_waitcnt lgkmcnt(0)
  s_barrier
  s_add_u32 m0, s48, 16384
  ds_read_b64_tr_b16 a[52:53], v90 offset:12288
  buffer_load_dwordx4 v89, s[32:35], s65 offen lds
  s_add_u32 m0, s48, 34848
  ds_read_b64_tr_b16 a[54:55], v90 offset:12544
  buffer_load_dwordx4 v92, s[32:35], s65 offen lds
  s_add_u32 s50, s65, 128
  s_add_u32 m0, s48, 17408
  ds_read_b64_tr_b16 a[60:61], v90 offset:12320
  buffer_load_dwordx4 v89, s[32:35], s50 offen lds
  s_add_u32 m0, s48, 35872
  ds_read_b64_tr_b16 a[62:63], v90 offset:12576
  buffer_load_dwordx4 v92, s[32:35], s50 offen lds
  ds_read_b64_tr_b16 a[68:69], v90 offset:13312
  ds_read_b64_tr_b16 a[70:71], v90 offset:13568
  ds_read_b64_tr_b16 a[76:77], v90 offset:13344
  ds_read_b64_tr_b16 a[78:79], v90 offset:13600
  s_waitcnt vmcnt(4)
  s_waitcnt lgkmcnt(0)
  s_add_u32 m0, s48, 12288
  ds_read_b64_tr_b16 v[176:177], v90 offset:14336
  buffer_load_dwordx4 v89, s[32:35], s66 offen lds
  s_add_u32 m0, s48, 30752
  ds_read_b64_tr_b16 v[178:179], v90 offset:14592
  buffer_load_dwordx4 v92, s[32:35], s66 offen lds
  s_add_u32 s50, s64, 8192
  s_add_u32 m0, s48, 13312
  ds_read_b64_tr_b16 v[184:185], v90 offset:14368
  buffer_load_dwordx4 v89, s[32:35], s50 offen lds
  s_add_u32 m0, s48, 31776
  ds_read_b64_tr_b16 v[186:187], v90 offset:14624
  buffer_load_dwordx4 v92, s[32:35], s50 offen lds
  ds_read_b64_tr_b16 v[224:225], v90 offset:15360
  ds_read_b64_tr_b16 v[226:227], v90 offset:15616
  ds_read_b64_tr_b16 v[232:233], v90 offset:15392
  ds_read_b64_tr_b16 v[234:235], v90 offset:15648
  s_waitcnt vmcnt(4)
  s_waitcnt lgkmcnt(0)
  s_add_u32 s50, s64, 8320
  s_add_u32 m0, s48, 14336
  ds_read_b64_tr_b16 v[192:193], v90 offset:16384
  buffer_load_dwordx4 v89, s[32:35], s50 offen lds
  s_add_u32 m0, s48, 32800
  ds_read_b64_tr_b16 v[194:195], v90 offset:16640
  buffer_load_dwordx4 v92, s[32:35], s50 offen lds
  s_add_u32 s50, s65, 8192
  s_add_u32 m0, s48, 15360
  ds_read_b64_tr_b16 v[200:201], v90 offset:16416
  buffer_load_dwordx4 v89, s[32:35], s50 offen lds
  s_add_u32 m0, s48, 33824
  ds_read_b64_tr_b16 v[202:203], v90 offset:16672
  buffer_load_dwordx4 v92, s[32:35], s50 offen lds
  ds_read_b64_tr_b16 v[240:241], v90 offset:17408
  ds_read_b64_tr_b16 v[242:243], v90 offset:17664
  ds_read_b64_tr_b16 v[248:249], v90 offset:17440
  ds_read_b64_tr_b16 v[250:251], v90 offset:17696
  global_load_dword v32, v33, s[36:37] sc1
  s_waitcnt vmcnt(5)
  s_waitcnt lgkmcnt(0)
  s_add_u32 s50, s65, 8320
  s_add_u32 m0, s48, 16384
  ds_read_b64_tr_b16 v[208:209], v90 offset:12288
  buffer_load_dwordx4 v89, s[32:35], s50 offen lds
  s_add_u32 m0, s48, 34848
  ds_read_b64_tr_b16 v[210:211], v90 offset:12544
  buffer_load_dwordx4 v92, s[32:35], s50 offen lds
  s_add_u32 s50, s66, 8192
  s_add_u32 m0, s48, 17408
  ds_read_b64_tr_b16 v[216:217], v90 offset:12320
  buffer_load_dwordx4 v89, s[32:35], s50 offen lds
  s_add_u32 m0, s48, 35872
  ds_read_b64_tr_b16 v[218:219], v90 offset:12576
  buffer_load_dwordx4 v92, s[32:35], s50 offen lds
  ds_read_b64_tr_b16 v[180:181], v90 offset:13312
  ds_read_b64_tr_b16 v[182:183], v90 offset:13568
  ds_read_b64_tr_b16 v[188:189], v90 offset:13344
  ds_read_b64_tr_b16 v[190:191], v90 offset:13600
  s_waitcnt vmcnt(5)
  s_waitcnt lgkmcnt(0)
  s_add_u32 s50, s66, 128
  s_add_u32 m0, s48, 12288
  ds_read_b64_tr_b16 v[228:229], v90 offset:14336
  buffer_load_dwordx4 v89, s[32:35], s50 offen lds
  s_add_u32 m0, s48, 30752
  ds_read_b64_tr_b16 v[230:231], v90 offset:14592
  buffer_load_dwordx4 v92, s[32:35], s50 offen lds
  s_add_u32 m0, s48, 13312
  ds_read_b64_tr_b16 v[236:237], v90 offset:14368
  buffer_load_dwordx4 v89, s[32:35], s67 offen lds
  s_add_u32 m0, s48, 31776
  ds_read_b64_tr_b16 v[238:239], v90 offset:14624
  buffer_load_dwordx4 v92, s[32:35], s67 offen lds
  ds_read_b64_tr_b16 v[196:197], v90 offset:15360
  ds_read_b64_tr_b16 v[198:199], v90 offset:15616
  ds_read_b64_tr_b16 v[204:205], v90 offset:15392
  ds_read_b64_tr_b16 v[206:207], v90 offset:15648
  s_waitcnt vmcnt(8)
  v_and_b32 v36, 0x80808080, v32
  v_cmp_ne_u32 vcc, 0x80808080, v36
  v_cmp_ne_u32 s[78:79], s60, v32
  s_mov_b64 s[74:75], vcc
  buffer_load_dword v34, v35, s[8:11], s56 offen sc1
  s_waitcnt vmcnt(5)
  s_waitcnt lgkmcnt(0)
  s_add_u32 s50, s67, 128
  s_add_u32 m0, s48, 14336
  ds_read_b64_tr_b16 v[244:245], v90 offset:16384
  buffer_load_dwordx4 v89, s[32:35], s50 offen lds
  s_add_u32 m0, s48, 32800
  ds_read_b64_tr_b16 v[246:247], v90 offset:16640
  buffer_load_dwordx4 v92, s[32:35], s50 offen lds
  s_add_u32 s50, s66, 8320
  s_add_u32 m0, s48, 15360
  ds_read_b64_tr_b16 v[252:253], v90 offset:16416
  buffer_load_dwordx4 v89, s[32:35], s50 offen lds
  s_add_u32 m0, s48, 33824
  ds_read_b64_tr_b16 v[254:255], v90 offset:16672
  buffer_load_dwordx4 v92, s[32:35], s50 offen lds
  ds_read_b64_tr_b16 v[212:213], v90 offset:17408
  ds_read_b64_tr_b16 v[214:215], v90 offset:17664
  ds_read_b64_tr_b16 v[220:221], v90 offset:17440
  ds_read_b64_tr_b16 v[222:223], v90 offset:17696
  s_waitcnt vmcnt(5)
  s_waitcnt lgkmcnt(0)
  s_add_u32 s50, s67, 8192
  s_add_u32 m0, s48, 16384
  ds_read_b64_tr_b16 v[72:73], v90 offset:12288
  buffer_load_dwordx4 v89, s[32:35], s50 offen lds
  s_add_u32 m0, s48, 34848
  ds_read_b64_tr_b16 v[74:75], v90 offset:12544
  buffer_load_dwordx4 v92, s[32:35], s50 offen lds
  s_add_u32 s50, s67, 8320
  s_add_u32 m0, s48, 17408
  ds_read_b64_tr_b16 v[80:81], v90 offset:12320
  buffer_load_dwordx4 v89, s[32:35], s50 offen lds
  s_add_u32 m0, s48, 35872
  ds_read_b64_tr_b16 v[82:83], v90 offset:12576
  buffer_load_dwordx4 v92, s[32:35], s50 offen lds
  ds_read_b64_tr_b16 v[96:97], v90 offset:13312
  ds_read_b64_tr_b16 v[98:99], v90 offset:13568
  ds_read_b64_tr_b16 v[104:105], v90 offset:13344
  ds_read_b64_tr_b16 v[106:107], v90 offset:13600
  s_waitcnt lgkmcnt(0)
  ds_write_b128 v5, v[72:75] offset:12288
  ds_write_b128 v5, v[80:83] offset:30752
  ds_write_b128 v5, v[96:99] offset:13312
  ds_write_b128 v5, v[104:107] offset:31776
  s_waitcnt vmcnt(4)
  ds_read_b64_tr_b16 v[72:73], v90 offset:14336
  ds_read_b64_tr_b16 v[74:75], v90 offset:14592
  ds_read_b64_tr_b16 v[80:81], v90 offset:14368
  ds_read_b64_tr_b16 v[82:83], v90 offset:14624
  ds_read_b64_tr_b16 v[100:101], v90 offset:15360
  ds_read_b64_tr_b16 v[102:103], v90 offset:15616
  ds_read_b64_tr_b16 v[108:109], v90 offset:15392
  ds_read_b64_tr_b16 v[110:111], v90 offset:15648
  s_waitcnt lgkmcnt(0)
  ds_write_b128 v5, v[72:75] offset:14336
  ds_write_b128 v5, v[80:83] offset:32800
  ds_write_b128 v5, v[100:103] offset:15360
  ds_write_b128 v5, v[108:111] offset:33824
  v_cmp_gt_u32 vcc, 1, v34
  s_nop 4
  s_or_b64 s[74:75], s[74:75], vcc
  s_cmp_eq_u64 s[74:75], 0
  s_cselect_b32 s49, s18, 53477376
  s_cselect_b32 s51, s19, 53477376
  buffer_load_dwordx4 v[56:59], v4, s[8:11], s49 offen offset:0 sc1
  buffer_load_dwordx4 v[60:63], v4, s[8:11], s49 offen offset:1024 sc1
  buffer_load_dwordx4 v[64:67], v4, s[8:11], s49 offen offset:2048 sc1
  buffer_load_dwordx4 v[68:71], v4, s[8:11], s49 offen offset:3072 sc1
  buffer_load_dword v37, v14, s[8:11], s51 offen sc1
  s_lshl_b32 s50, s23, 13
  s_add_u32 s50, s50, 50331648
  s_or_b32 s79, s79, s82
  s_cselect_b32 s49, 53477376, s14
  s_cselect_b32 s50, 53477376, s50
  s_cselect_b32 s51, 0, -1
  v_lshlrev_b32 v24, 5, v0
  v_and_b32 v24, s51, v24
  v_lshlrev_b32 v25, 7, v0
  v_and_b32 v25, s51, v25
  buffer_load_dword v37, v24, s[8:11], s49 offen sc1
  buffer_load_dword v37, v25, s[8:11], s50 offen sc1
  s_waitcnt vmcnt(7)
  ds_read_b64_tr_b16 v[76:77], v90 offset:16384
  ds_read_b64_tr_b16 v[78:79], v90 offset:16640
  ds_read_b64_tr_b16 v[84:85], v90 offset:16416
  ds_read_b64_tr_b16 v[86:87], v90 offset:16672
  ds_read_b64_tr_b16 v[100:101], v90 offset:17408
  ds_read_b64_tr_b16 v[102:103], v90 offset:17664
  ds_read_b64_tr_b16 v[108:109], v90 offset:17440
  ds_read_b64_tr_b16 v[110:111], v90 offset:17696
  s_waitcnt lgkmcnt(0)
  ds_write_b128 v5, v[76:79] offset:16384
  ds_write_b128 v5, v[84:87] offset:34848
  ds_write_b128 v5, v[100:103] offset:17408
  ds_write_b128 v5, v[108:111] offset:35872
  s_waitcnt lgkmcnt(0)
  ds_read_b128 v[112:115], v5 offset:10240
  ds_read_b128 v[116:119], v5 offset:11264
  ds_read_b128 v[120:123], v5 offset:28704
  ds_read_b128 v[124:127], v5 offset:29728
  ds_read_b128 v[128:131], v5 offset:0
  ds_read_b128 v[132:135], v5 offset:2048
  ds_read_b128 v[136:139], v5 offset:18464
  ds_read_b128 v[140:143], v5 offset:20512
  v_mov_b64 v[72:73], 0
  v_mov_b64 v[74:75], 0
  v_mov_b64 v[76:77], 0
  v_mov_b64 v[78:79], 0
  v_mov_b64 v[80:81], 0
  v_mov_b64 v[82:83], 0
  v_mov_b64 v[84:85], 0
  v_mov_b64 v[86:87], 0
  v_mov_b64 v[88:89], 0
  v_mov_b64 v[90:91], 0
  v_mov_b64 v[92:93], 0
  v_mov_b64 v[94:95], 0
  v_mov_b64 v[96:97], 0
  v_mov_b64 v[98:99], 0
  v_mov_b64 v[100:101], 0
  v_mov_b64 v[102:103], 0
  v_mov_b64 v[104:105], 0
  v_mov_b64 v[106:107], 0
  v_mov_b64 v[108:109], 0
  v_mov_b64 v[110:111], 0
L_wj:
  s_cmp_eq_u64 s[74:75], 0
  s_cbranch_scc1 L_rdy
L_hs:
  s_add_u32 s24, s24, 1
  s_cmp_gt_u32 s24, 524288
  s_cbranch_scc1 L_end
  global_load_dword v32, v33, s[36:37] sc1
  s_waitcnt vmcnt(0)
  v_and_b32 v36, 0x80808080, v32
  v_cmp_ne_u32 vcc, 0x80808080, v36
  s_cbranch_vccnz L_hs
L_kv0:
  s_add_u32 s24, s24, 1
  s_cmp_gt_u32 s24, 524288
  s_cbranch_scc1 L_end
  buffer_load_dword v34, v35, s[8:11], s56 offen sc1
  s_waitcnt vmcnt(0)
  v_cmp_gt_u32 vcc, 1, v34
  s_cbranch_vccnz L_kv0
  buffer_load_dwordx4 v[56:59], v4, s[8:11], s18 offen offset:0 sc1
  buffer_load_dwordx4 v[60:63], v4, s[8:11], s18 offen offset:1024 sc1
  buffer_load_dwordx4 v[64:67], v4, s[8:11], s31 offen offset:2048 sc1
  buffer_load_dwordx4 v[68:71], v4, s[8:11], s31 offen offset:3072 sc1
  buffer_load_dword v37, v14, s[8:11], s19 offen sc1
L_rdy:
  v_cmp_ne_u32 vcc, s60, v32
  s_cmp_eq_u32 s82, 0
  s_cselect_b32 s49, 20, 8
  s_add_u32 s56, s56, s49
  s_mov_b32 s48, vcc_hi
  s_add_u32 s18, s18, 524288
  s_add_u32 s19, s18, 524288
  s_waitcnt lgkmcnt(0)
  s_add_u32 s64, s8, s54
  s_addc_u32 s65, s9, 0
  s_lshl_b32 s49, s23, 11
  s_lshl_b32 s50, s21, 13
  s_add_u32 s49, s49, s50
  s_add_u32 s49, s49, 33554432
  s_add_u32 s62, s8, s49
  s_addc_u32 s63, s9, 0
  s_add_u32 s72, s8, s13
  s_addc_u32 s73, s9, 0
  s_add_u32 s66, s8, s14
  s_addc_u32 s67, s9, 0
  s_mov_b32 s68, 0
  s_cmp_lg_u32 s82, 0
  s_cbranch_scc1 E_xs
  s_cmp_lg_u32 s48, 0
  s_cbranch_scc1 S_go
  s_branch F_go
.p2align 8
  s_nop 0
  s_nop 0
  s_nop 0
  s_nop 0
  s_nop 0
  s_nop 0
  s_nop 0
  s_nop 0
  s_nop 0
  s_nop 0
  s_nop 0
  s_nop 0
  s_nop 0
  s_nop 0
  s_nop 0
  s_endpgm
F_in:
  s_waitcnt vmcnt(3)
  v_mfma_f32_16x16x32_bf16 v[24:27], v[20:23], v[32:35], 0
  v_lshlrev_b32 v28, 1, v32
  v_and_b32 v28, 2, v28
  s_waitcnt vmcnt(2)
  v_mfma_f32_16x16x32_bf16 v[24:27], v[20:23], v[36:39], v[24:27]
  v_and_or_b32 v28, v36, 1, v28
  v_cmp_ne_u32 vcc, s69, v28
  s_nop 0
  s_nop 0
  s_nop 0
  s_nop 0
  s_nop 0
  s_nop 0
  v_add_f32_dpp v24, v24, v24 row_ror:8 row_mask:0xf bank_mask:0xf
  v_add_f32_dpp v25, v25, v25 row_ror:8 row_mask:0xf bank_mask:0xf
  s_cbranch_vccnz F_if1
  v_add_f32_dpp v24, v24, v24 row_ror:4 row_mask:0xf bank_mask:0xf
  v_add_f32_dpp v25, v25, v25 row_ror:4 row_mask:0xf bank_mask:0xf
  v_cvt_pk_bf16_f32 v24, v24, v25
  global_store_dword v11, v24, s[70:71]
F_pb:
  v_cmp_class_f32 vcc, v24, s25
  v_mov_b64 v[72:73], 0
  v_mov_b64 v[74:75], 0
  v_mov_b64 v[76:77], 0
  v_mov_b64 v[78:79], 0
  v_mov_b64 v[80:81], 0
  v_mov_b64 v[82:83], 0
  v_mov_b64 v[84:85], 0
  v_mov_b64 v[86:87], 0
  s_cbranch_vccnz F_il
F_ok:
  v_mov_b32 v111, v24
  s_cmp_eq_u32 s21, s83
  s_cbranch_scc1 L_fin
  v_lshlrev_b32 v14, 2, v4
F_go:
  v_mov_b32 v20, -1
  buffer_store_dword v20, v11, s[8:11], s59 offen
  s_nop 7
  s_nop 7
  s_nop 7
  s_nop 7
  s_nop 7
  s_nop 2
F_xs:
  global_load_dwordx4 v[24:27], v4, s[62:63] offset:0 sc1
  global_load_dwordx4 v[28:31], v4, s[62:63] offset:1024 sc1
  s_nop 7
  s_nop 7
  s_nop 7
  s_nop 7
  s_nop 6
  s_nop 0
  s_nop 7
  s_nop 0
  s_nop 0
  global_load_dwordx4 v[96:99], v4, s[62:63] offset:0 sc1
  global_load_dwordx4 v[100:103], v4, s[62:63] offset:1024 sc1
  buffer_load_dwordx4 v[64:67], v4, s[8:11], s31 offen offset:2048 sc1
  buffer_load_dwordx4 v[68:71], v4, s[8:11], s31 offen offset:3072 sc1
  s_waitcnt vmcnt(4)
F_x0:
  ds_write_b128 v6, v[24:27]
  v_smfmac_f32_16x16x64_bf16 v[72:75], v[24:27], v[112:119], v1
  ds_write_b128 v6, v[28:31] offset:1024
  v_smfmac_f32_16x16x64_bf16 v[76:79], v[24:27], v[120:127], v1
  v_fma_f32 v109, v25, v26, v27
  v_fma_f32 v110, v29, v30, v31
  v_smfmac_f32_16x16x64_bf16 v[80:83], v[24:27], v[128:135], v1
  v_fma_f32 v109, v24, v28, v109
  v_cmp_u_f32 vcc, v109, v110
  v_smfmac_f32_16x16x64_bf16 v[84:87], v[24:27], v[136:143], v1
  v_smfmac_f32_16x16x64_bf16 v[72:75], v[28:31], a[48:55], v1
  s_cbranch_vccnz F_xf1
  s_waitcnt lgkmcnt(0)
  s_barrier
  ds_read_b128 v[32:35], v7 offset:0
  v_smfmac_f32_16x16x64_bf16 v[76:79], v[28:31], a[56:63], v1
  ds_read_b128 v[36:39], v7 offset:1024
  buffer_store_dword v111, v11, s[8:11], s20 offen sc1
  ds_read_b128 v[40:43], v8 offset:0
  v_smfmac_f32_16x16x64_bf16 v[80:83], v[28:31], a[144:151], v1
  ds_read_b128 v[44:47], v8 offset:1024
  ds_read_b128 v[48:51], v9 offset:0
  v_smfmac_f32_16x16x64_bf16 v[84:87], v[28:31], a[152:159], v1
  ds_read_b128 v[52:55], v9 offset:1024
F_cm:
  s_waitcnt lgkmcnt(5)
  v_smfmac_f32_16x16x64_bf16 v[72:75], v[32:35], a[0:7], v1
  buffer_load_dword v14, v14, s[8:11], s19 offen sc1
  v_smfmac_f32_16x16x64_bf16 v[76:79], v[32:35], a[8:15], v1
  s_waitcnt lgkmcnt(4)
  v_smfmac_f32_16x16x64_bf16 v[72:75], v[36:39], a[64:71], v1
  ds_read_b128 v[112:115], v5 offset:1024
  v_smfmac_f32_16x16x64_bf16 v[76:79], v[36:39], a[72:79], v1
  ds_read_b128 v[116:119], v5 offset:3072
  s_waitcnt lgkmcnt(5)
  v_smfmac_f32_16x16x64_bf16 v[72:75], v[40:43], a[16:23], v1
  s_waitcnt lgkmcnt(4)
  v_smfmac_f32_16x16x64_bf16 v[72:75], v[44:47], a[80:87], v1
  ds_read_b128 v[128:131], v5 offset:4096
  s_waitcnt lgkmcnt(4)
  v_smfmac_f32_16x16x64_bf16 v[72:75], v[48:51], a[32:39], v1
  ds_read_b128 v[132:135], v5 offset:5120
  s_waitcnt lgkmcnt(4)
  v_smfmac_f32_16x16x64_bf16 v[72:75], v[52:55], a[96:103], v1
  buffer_load_dword v0, off, s[8:11], s56 sc1
  v_smfmac_f32_16x16x64_bf16 v[76:79], v[40:43], a[24:31], v1
  ds_read_b128 v[120:123], v5 offset:19488
  v_smfmac_f32_16x16x64_bf16 v[76:79], v[44:47], a[88:95], v1
  ds_read_b128 v[124:127], v5 offset:21536
  v_cvt_pk_bf16_f32 v72, v72, v73
  v_smfmac_f32_16x16x64_bf16 v[76:79], v[48:51], a[40:47], v1
  ds_read_b128 v[136:139], v5 offset:22560
  v_cvt_pk_bf16_f32 v73, v74, v75
  v_smfmac_f32_16x16x64_bf16 v[76:79], v[52:55], a[104:111], v1
  ds_read_b128 v[140:143], v5 offset:23584
  v_mfma_f32_16x16x16_bf16 v[72:75], v[72:73], v[2:3], 0
  s_waitcnt lgkmcnt(6)
  v_smfmac_f32_16x16x64_bf16 v[80:83], v[32:35], v[112:119], v1
  v_cvt_pk_bf16_f32 v76, v76, v77
  v_cvt_pk_bf16_f32 v77, v78, v79
  s_waitcnt lgkmcnt(4)
  v_smfmac_f32_16x16x64_bf16 v[80:83], v[36:39], v[128:135], v1
  ds_read_b128 v[112:115], v5 offset:6144
  v_mfma_f32_16x16x16_bf16 v[76:79], v[76:77], v[2:3], 0
  v_cvt_pk_bf16_f32 v72, v72, v73
  v_cvt_pk_bf16_f32 v73, v74, v75
  s_waitcnt lgkmcnt(3)
  v_smfmac_f32_16x16x64_bf16 v[84:87], v[32:35], v[120:127], v1
  ds_read_b128 v[116:119], v5 offset:7168
  s_waitcnt lgkmcnt(2)
  v_smfmac_f32_16x16x64_bf16 v[84:87], v[36:39], v[136:143], v1
  ds_read_b128 v[128:131], v5 offset:8192
  v_cvt_pk_bf16_f32 v74, v76, v77
  v_cvt_pk_bf16_f32 v75, v78, v79
  v_smfmac_f32_16x16x64_bf16 v[80:83], v[40:43], a[112:119], v1
  ds_read_b128 v[132:135], v5 offset:9216
  v_mov_b64_e64 v[104:105], 0
  v_mfma_f32_16x16x32_bf16 v[56:59], v[56:59], v[72:75], 0
  ds_read_b128 v[120:123], v5 offset:24608
  v_mov_b64 v[106:107], 0
  v_mfma_f32_16x16x32_bf16 v[60:63], v[60:63], v[72:75], 0
  ds_read_b128 v[124:127], v5 offset:25632
  v_mov_b64 v[108:109], 0
  v_smfmac_f32_16x16x64_bf16 v[80:83], v[44:47], a[160:167], v1
  ds_read_b128 v[136:139], v5 offset:26656
  v_mov_b64 v[110:111], 0
  v_smfmac_f32_16x16x64_bf16 v[80:83], v[48:51], a[128:135], v1
  ds_read_b128 v[140:143], v5 offset:27680
  v_cndmask_b32 v56, v60, v56, s[26:27]
  v_smfmac_f32_16x16x64_bf16 v[80:83], v[52:55], a[176:183], v1
  s_waitcnt vmcnt(3)
  ds_read_b128 v[28:31], v6 offset:1024
  v_cndmask_b32 v57, v61, v57, s[26:27]
  v_smfmac_f32_16x16x64_bf16 v[84:87], v[40:43], a[120:127], v1
  ds_read_b128 v[24:27], v6 offset:0
  v_cndmask_b32 v58, v62, v58, s[26:27]
  v_smfmac_f32_16x16x64_bf16 v[84:87], v[44:47], a[168:175], v1
  v_cndmask_b32 v59, v63, v59, s[26:27]
  v_smfmac_f32_16x16x64_bf16 v[84:87], v[48:51], a[136:143], v1
  ds_write_b128 v15, v[56:59]
  v_smfmac_f32_16x16x64_bf16 v[84:87], v[52:55], a[184:191], v1
  s_nop 1
  v_cvt_pk_bf16_f32 v80, v80, v81
  v_cvt_pk_bf16_f32 v81, v82, v83
  s_nop 1
  v_mfma_f32_16x16x16_bf16 v[80:83], v[80:81], v[2:3], 0
  s_nop 0
  v_cvt_pk_bf16_f32 v84, v84, v85
  v_cvt_pk_bf16_f32 v85, v86, v87
  s_nop 1
  v_mfma_f32_16x16x16_bf16 v[84:87], v[84:85], v[2:3], 0
  v_mov_b64 v[96:97], 0
  s_nop 0
  v_cvt_pk_bf16_f32 v80, v80, v81
  v_cvt_pk_bf16_f32 v81, v82, v83
  s_waitcnt lgkmcnt(9)
  v_smfmac_f32_16x16x64_bf16 v[88:91], v[32:35], v[112:119], v1
  s_nop 1
  v_cvt_pk_bf16_f32 v82, v84, v85
  v_cvt_pk_bf16_f32 v83, v86, v87
  s_nop 1
  v_mfma_f32_16x16x32_bf16 v[84:87], v[80:83], v[72:75], 0
  s_waitcnt lgkmcnt(5)
  v_smfmac_f32_16x16x64_bf16 v[92:95], v[32:35], v[120:127], v1
  v_smfmac_f32_16x16x64_bf16 v[88:91], v[36:39], v[128:135], v1
  ds_write_b64 v19, v[84:85]
  s_waitcnt lgkmcnt(4)
  v_smfmac_f32_16x16x64_bf16 v[92:95], v[36:39], v[136:143], v1
  buffer_load_dwordx4 v[60:63], v4, s[8:11], s18 offen offset:1024 sc1
  s_waitcnt lgkmcnt(2)
  v_smfmac_f32_16x16x64_bf16 v[88:91], v[24:27], a[192:199], v1
  ds_read_b128 v[112:115], v5 offset:12288
  v_mov_b64_e64 v[98:99], 0
  s_waitcnt lgkmcnt(1)
  s_barrier
  ds_read2st64_b32 v[20:21], v16 offset0:0 offset1:5
  ds_read2st64_b32 v[22:23], v16 offset0:10 offset1:15
  v_smfmac_f32_16x16x64_bf16 v[92:95], v[24:27], a[200:207], v1
  ds_read2st64_b32 v[80:81], v13 offset0:0 offset1:1
  ds_read2st64_b32 v[82:83], v13 offset0:2 offset1:3
  v_smfmac_f32_16x16x64_bf16 v[88:91], v[28:31], a[240:247], v1
  v_smfmac_f32_16x16x64_bf16 v[92:95], v[28:31], a[248:255], v1
  v_smfmac_f32_16x16x64_bf16 v[88:91], v[40:43], a[208:215], v1
  s_waitcnt lgkmcnt(3)
  v_add_f32 v20, v20, v21
  s_waitcnt lgkmcnt(2)
  v_add_f32 v22, v22, v23
  v_add_f32 v20, v20, v22
  s_waitcnt lgkmcnt(1)
  v_add_f32 v80, v80, v81
  v_mov_b64 v[100:101], 0
  v_max_f32_dpp v76, v20, v20 row_ror:4 row_mask:0xf bank_mask:0xf
  v_max_f32_dpp v21, v20, v20 row_ror:4 row_mask:0xf bank_mask:0xf
  s_waitcnt lgkmcnt(0)
  v_add_f32 v82, v82, v83
  v_add_f32 v80, v80, v82
  v_permlane16_swap_b32 v76, v21
  v_max3_f32 v76, v76, v21, v80
  v_mul_f32 v20, s30, v20
  v_mul_f32 v80, s30, v80
  v_max_f32_dpp v76, v76, v76 row_ror:8 row_mask:0xf bank_mask:0xf
  v_smfmac_f32_16x16x64_bf16 v[92:95], v[40:43], a[216:223], v1
  ds_read_b128 v[116:119], v5 offset:15360
  v_max_f32_dpp v76, v76, v76 row_ror:2 row_mask:0xf bank_mask:0xf
  v_mov_b64 v[102:103], 0
  v_mov_b64 v[72:73], s[28:29]
  v_max_f32_dpp v76, v76, v76 row_ror:1 row_mask:0xf bank_mask:0xf
  v_fma_f32 v20, -v76, s30, v20
  v_fma_f32 v80, -v76, s30, v80
  v_exp_f32_e64 v20, v20
  v_exp_f32_e64 v80, v80
  v_mov_b64_e64 v[74:75], s[28:29]
  v_cvt_pk_bf16_f32 v20, v20, v80
  ds_write_b16 v17, v20
  ds_write_b16_d16_hi v17, v20 offset:16
  v_smfmac_f32_16x16x64_bf16 v[88:91], v[44:47], v[144:151], v1
  buffer_load_dwordx4 v[56:59], v4, s[8:11], s18 offen offset:0 sc1
  v_smfmac_f32_16x16x64_bf16 v[92:95], v[44:47], v[152:159], v1
  ds_read_b128 v[120:123], v5 offset:30752
  v_mov_b64_e64 v[84:85], s[52:53]
  v_smfmac_f32_16x16x64_bf16 v[88:91], v[48:51], a[224:231], v1
  ds_read_b128 v[124:127], v5 offset:33824
  s_waitcnt lgkmcnt(2)
  s_barrier
  ds_read_b128 v[76:79], v18
  v_smfmac_f32_16x16x64_bf16 v[92:95], v[48:51], a[232:239], v1
  ds_read_b64 v[86:87], v18 offset:16
  v_smfmac_f32_16x16x64_bf16 v[88:91], v[52:55], v[160:167], v1
  v_smfmac_f32_16x16x64_bf16 v[92:95], v[52:55], v[168:175], v1
  ds_read_b128 v[128:131], v5 offset:14336
  s_waitcnt lgkmcnt(2)
  v_mfma_f32_16x16x32_bf16 v[72:75], v[72:75], v[76:79], 0
  ds_read_b128 v[132:135], v5 offset:17408
  v_cvt_pk_bf16_f32 v48, v88, v89
  v_mfma_f32_16x16x32_bf16 v[64:67], v[64:67], v[76:79], 0
  ds_read_b128 v[136:139], v5 offset:32800
  v_cvt_pk_bf16_f32 v49, v90, v91
  v_mfma_f32_16x16x32_bf16 v[68:71], v[68:71], v[76:79], 0
  ds_read_b128 v[140:143], v5 offset:35872
  v_cvt_pk_bf16_f32 v50, v92, v93
  s_waitcnt lgkmcnt(4)
  v_mfma_f32_16x16x16_bf16 v[72:75], v[84:85], v[86:87], v[72:75]
  v_cvt_pk_bf16_f32 v51, v94, v95
  ds_read_b128 v[32:35], v5 offset:31776
  v_mfma_f32_16x16x16_bf16 v[64:67], v[48:49], v[86:87], v[64:67]
  ds_read_b128 v[36:39], v5 offset:34848
  v_mfma_f32_16x16x16_bf16 v[68:71], v[50:51], v[86:87], v[68:71]
  v_rcp_f32 v81, v72
  s_nop 0
  s_nop 0
  s_nop 0
  v_pk_mul_f32 v[64:65], v[64:65], v[80:81] op_sel:[0,1] op_sel_hi:[1,1]
  v_pk_mul_f32 v[66:67], v[66:67], v[80:81] op_sel:[0,1] op_sel_hi:[1,1]
  v_cvt_pk_bf16_f32 v72, v64, v65
  v_cvt_pk_bf16_f32 v73, v66, v67
  v_pk_mul_f32 v[68:69], v[68:69], v[80:81] op_sel:[0,1] op_sel_hi:[1,1]
  v_pk_mul_f32 v[70:71], v[70:71], v[80:81] op_sel:[0,1] op_sel_hi:[1,1]
  v_cvt_pk_bf16_f32 v74, v68, v69
  v_cvt_pk_bf16_f32 v75, v70, v71
  ds_write_b128 v6, v[72:75]
  s_nop 0
  v_smfmac_f32_16x16x64_bf16 v[96:99], v[72:75], v[176:183], v1
  ds_read_b128 v[24:27], v5 offset:13312
  v_mov_b64 v[88:89], 0
  v_smfmac_f32_16x16x64_bf16 v[100:103], v[72:75], v[184:191], v1
  ds_read_b128 v[28:31], v5 offset:16384
  v_mov_b64 v[90:91], 0
  v_mov_b64 v[92:93], 0
  s_waitcnt lgkmcnt(2)
  s_barrier
  ds_read_b128 v[76:79], v7
  v_smfmac_f32_16x16x64_bf16 v[104:107], v[72:75], v[224:231], v1
  ds_read_b128 v[80:83], v8
  ds_read_b128 v[84:87], v9
  v_smfmac_f32_16x16x64_bf16 v[108:111], v[72:75], v[232:239], v1
  v_mov_b64 v[94:95], 0
  s_waitcnt lgkmcnt(2)
  v_smfmac_f32_16x16x64_bf16 v[96:99], v[76:79], v[192:199], v1
  v_smfmac_f32_16x16x64_bf16 v[100:103], v[76:79], v[200:207], v1
  s_waitcnt lgkmcnt(1)
  v_smfmac_f32_16x16x64_bf16 v[96:99], v[80:83], v[208:215], v1
  s_waitcnt lgkmcnt(0)
  v_smfmac_f32_16x16x64_bf16 v[96:99], v[84:87], v[24:31], v1
  v_smfmac_f32_16x16x64_bf16 v[100:103], v[80:83], v[216:223], v1
  v_smfmac_f32_16x16x64_bf16 v[100:103], v[84:87], v[32:39], v1
  v_cvt_pk_bf16_f32 v96, v96, v97
  v_smfmac_f32_16x16x64_bf16 v[104:107], v[76:79], v[240:247], v1
  v_cvt_pk_bf16_f32 v97, v98, v99
  v_smfmac_f32_16x16x64_bf16 v[104:107], v[80:83], v[112:119], v1
  v_cvt_pk_bf16_f32 v98, v100, v101
  v_smfmac_f32_16x16x64_bf16 v[104:107], v[84:87], v[128:135], v1
  v_cvt_pk_bf16_f32 v99, v102, v103
  v_and_or_b32 v96, v96, -2, s68
  v_smfmac_f32_16x16x64_bf16 v[108:111], v[76:79], v[248:255], v1
  buffer_store_dwordx4 v[96:99], v10, s[8:11], s16 offen
  v_smfmac_f32_16x16x64_bf16 v[108:111], v[80:83], v[120:127], v1
  v_cvt_pk_bf16_f32 v104, v104, v105
  v_smfmac_f32_16x16x64_bf16 v[108:111], v[84:87], v[136:143], v1
  s_nop 0
  s_nop 0
  v_cvt_pk_bf16_f32 v105, v106, v107
  v_and_or_b32 v104, v104, -2, s68
  s_nop 0
  s_nop 0
  s_nop 0
  s_nop 0
  v_cvt_pk_bf16_f32 v106, v108, v109
  v_cvt_pk_bf16_f32 v107, v110, v111
  buffer_store_dwordx4 v[104:107], v10, s[8:11], s17 offen
  v_mov_b64 v[20:21], 0
  v_mov_b64 v[22:23], 0
  ds_read_b128 v[112:115], v5 offset:10240
  ds_read_b128 v[116:119], v5 offset:11264
  ds_read_b128 v[120:123], v5 offset:28704
  ds_read_b128 v[124:127], v5 offset:29728
  v_mov_b32_dpp v20, v12 quad_perm:[0,1,2,3] row_mask:0xf bank_mask:3
  v_mov_b32_dpp v21, v12 quad_perm:[0,1,2,3] row_mask:0xf bank_mask:12
  v_mov_b32_dpp v22, v12 quad_perm:[1,0,3,2] row_mask:0xf bank_mask:3
  v_mov_b32_dpp v23, v12 quad_perm:[1,0,3,2] row_mask:0xf bank_mask:12
  ds_read_b128 v[128:131], v5 offset:0
  ds_read_b128 v[132:135], v5 offset:2048
  ds_read_b128 v[136:139], v5 offset:18464
  ds_read_b128 v[140:143], v5 offset:20512
  s_mul_i32 s69, s68, 3
  s_xor_b32 s68, s68, 1
  s_add_u32 s18, s18, 524288
  s_add_u32 s19, s19, 524288
  s_min_u32 s19, s19, 33026048
  s_add_u32 s31, s31, 524288
  s_add_u32 s20, s20, s81
  s_mov_b32 s81, 8192
  s_add_u32 s55, s55, 8192
  s_and_b32 s55, s55, 24576
  s_add_u32 s62, s64, s55
  s_addc_u32 s63, s65, 0
  s_add_u32 s70, s72, s55
  s_addc_u32 s71, s73, 0
  s_xor_b32 s59, s55, 0x4000
  s_add_u32 s59, s59, s13
  s_add_u32 s21, s21, 1
  s_cmp_gt_u32 s21, s80
  s_cselect_b32 s57, 0, s57
  s_waitcnt vmcnt(4)
  v_cmp_gt_u32 vcc, s57, v0
  s_cbranch_vccnz F_kv
F_kvr:
  s_add_u32 s56, s56, 4
  s_cmp_eq_u32 s56, s58
  s_addc_u32 s57, s57, 0
  s_cmp_eq_u32 s56, s58
  s_cselect_b32 s49, 24, 0
  s_sub_u32 s56, s56, s49
  s_waitcnt lgkmcnt(0)
  s_nop 7
  s_nop 3
  s_nop 0
  global_load_dwordx4 v[32:35], v4, s[66:67] offset:0 sc1
  global_load_dwordx4 v[36:39], v4, s[66:67] offset:1024 sc1
  s_nop 7
  s_nop 7
  s_nop 7
  s_nop 7
  s_nop 6
  s_nop 0
  global_load_dwordx4 v[40:43], v4, s[66:67] offset:0 sc1
  global_load_dwordx4 v[44:47], v4, s[66:67] offset:1024 sc1
  s_branch F_in
.p2align 6
F_if1:
  global_load_dwordx4 v[32:35], v4, s[66:67] offset:0 sc1
  global_load_dwordx4 v[36:39], v4, s[66:67] offset:1024 sc1
  s_waitcnt vmcnt(3)
  v_mfma_f32_16x16x32_bf16 v[24:27], v[20:23], v[40:43], 0
  v_lshlrev_b32 v28, 1, v40
  v_and_b32 v28, 2, v28
  s_waitcnt vmcnt(2)
  v_mfma_f32_16x16x32_bf16 v[24:27], v[20:23], v[44:47], v[24:27]
  v_and_or_b32 v28, v44, 1, v28
  v_cmp_ne_u32 vcc, s69, v28
  s_nop 2
  s_nop 0
  s_nop 0
  s_nop 0
  v_add_f32_dpp v24, v24, v24 row_ror:8 row_mask:0xf bank_mask:0xf
  v_add_f32_dpp v25, v25, v25 row_ror:8 row_mask:0xf bank_mask:0xf
  s_cbranch_vccnz F_if2
  v_add_f32_dpp v24, v24, v24 row_ror:4 row_mask:0xf bank_mask:0xf
  v_add_f32_dpp v25, v25, v25 row_ror:4 row_mask:0xf bank_mask:0xf
  v_cvt_pk_bf16_f32 v24, v24, v25
  global_store_dword v11, v24, s[70:71]
  s_branch F_pb
F_if2:
  global_load_dwordx4 v[40:43], v4, s[66:67] offset:0 sc1
  global_load_dwordx4 v[44:47], v4, s[66:67] offset:1024 sc1
  s_add_u32 s24, s24, 1
  s_cmp_gt_u32 s24, 524288
  s_cbranch_scc1 L_end
  s_waitcnt vmcnt(3)
  v_mfma_f32_16x16x32_bf16 v[24:27], v[20:23], v[32:35], 0
  v_lshlrev_b32 v28, 1, v32
  v_and_b32_e64 v28, 2, v28
  s_waitcnt vmcnt(2)
  v_mfma_f32_16x16x32_bf16 v[24:27], v[20:23], v[36:39], v[24:27]
  v_and_or_b32 v28, v36, 1, v28
  v_cmp_ne_u32 vcc, s69, v28
  s_nop 0
  s_nop 0
  s_nop 0
  s_nop 0
  s_nop 0
  s_nop 0
  v_add_f32_dpp v24, v24, v24 row_ror:8 row_mask:0xf bank_mask:0xf
  v_add_f32_dpp v25, v25, v25 row_ror:8 row_mask:0xf bank_mask:0xf
  s_cbranch_vccnz F_if1
  v_add_f32_dpp v24, v24, v24 row_ror:4 row_mask:0xf bank_mask:0xf
  v_add_f32_dpp v25, v25, v25 row_ror:4 row_mask:0xf bank_mask:0xf
  v_cvt_pk_bf16_f32 v24, v24, v25
  global_store_dword v11, v24, s[70:71]
  s_branch F_pb
F_il:
  v_mov_b32 v28, 32704
  v_cndmask_b32 v24, v24, v28, vcc
  global_store_dword v11, v24, s[70:71]
  s_branch F_ok
.p2align 6
F_xf1:
  global_load_dwordx4 v[24:27], v4, s[62:63] offset:0 sc1
  global_load_dwordx4 v[28:31], v4, s[62:63] offset:1024 sc1
  s_nop 3
  s_nop 0
  s_nop 0
  v_mov_b64 v[72:73], 0
  v_mov_b64 v[74:75], 0
  v_mov_b64 v[76:77], 0
  v_mov_b64 v[78:79], 0
  v_mov_b64 v[80:81], 0
  v_mov_b64 v[82:83], 0
  v_mov_b64 v[84:85], 0
  v_mov_b64 v[86:87], 0
  s_waitcnt vmcnt(2)
  ds_write_b128 v6, v[96:99]
  v_smfmac_f32_16x16x64_bf16 v[72:75], v[96:99], v[112:119], v1
  ds_write_b128 v6, v[100:103] offset:1024
  v_smfmac_f32_16x16x64_bf16 v[76:79], v[96:99], v[120:127], v1
  v_fma_f32 v109, v97, v98, v99
  v_fma_f32 v110, v101, v102, v103
  v_smfmac_f32_16x16x64_bf16 v[80:83], v[96:99], v[128:135], v1
  v_fma_f32 v109, v96, v100, v109
  v_cmp_u_f32 vcc, v109, v110
  v_smfmac_f32_16x16x64_bf16 v[84:87], v[96:99], v[136:143], v1
  v_smfmac_f32_16x16x64_bf16 v[72:75], v[100:103], a[48:55], v1
  s_cbranch_vccnz F_xf0
  s_waitcnt lgkmcnt(0)
  s_barrier
  ds_read_b128 v[32:35], v7 offset:0
  v_smfmac_f32_16x16x64_bf16 v[76:79], v[100:103], a[56:63], v1
  ds_read_b128 v[36:39], v7 offset:1024
  buffer_store_dword v111, v11, s[8:11], s20 offen sc1
  ds_read_b128 v[40:43], v8 offset:0
  v_smfmac_f32_16x16x64_bf16 v[80:83], v[100:103], a[144:151], v1
  ds_read_b128 v[44:47], v8 offset:1024
  ds_read_b128 v[48:51], v9 offset:0
  v_smfmac_f32_16x16x64_bf16 v[84:87], v[100:103], a[152:159], v1
  ds_read_b128 v[52:55], v9 offset:1024
  s_branch F_cm
.p2align 6
F_xf0:
  global_load_dwordx4 v[96:99], v4, s[62:63] offset:0 sc1
  global_load_dwordx4 v[100:103], v4, s[62:63] offset:1024 sc1
  s_add_u32 s24, s24, 1
  s_cmp_gt_u32 s24, 524288
  s_cbranch_scc1 L_end
  s_nop 1
  s_nop 0
  v_mov_b64 v[72:73], 0
  v_mov_b64 v[74:75], 0
  v_mov_b64 v[76:77], 0
  v_mov_b64 v[78:79], 0
  v_mov_b64 v[80:81], 0
  v_mov_b64 v[82:83], 0
  v_mov_b64 v[84:85], 0
  v_mov_b64 v[86:87], 0
  s_waitcnt vmcnt(2)
  s_branch F_x0
F_kv:
  s_add_u32 s24, s24, 1
  s_cmp_gt_u32 s24, 524288
  s_cbranch_scc1 L_end
  buffer_load_dword v0, off, s[8:11], s56 sc1
  s_waitcnt vmcnt(0)
  v_cmp_gt_u32 vcc, s57, v0
  s_cbranch_vccnz F_kv
  s_branch F_kvr
S_in:
  s_waitcnt vmcnt(3)
  v_mfma_f32_16x16x32_bf16 v[24:27], v[20:23], v[32:35], 0
  v_lshlrev_b32 v28, 1, v32
  v_and_b32 v28, 2, v28
  s_waitcnt vmcnt(2)
  v_mfma_f32_16x16x32_bf16 v[24:27], v[20:23], v[36:39], v[24:27]
  v_and_or_b32 v28, v36, 1, v28
  v_cmp_ne_u32 vcc, s69, v28
  s_nop 5
  v_add_f32_dpp v24, v24, v24 row_ror:8 row_mask:0xf bank_mask:0xf
  v_add_f32_dpp v25, v25, v25 row_ror:8 row_mask:0xf bank_mask:0xf
  s_cbranch_vccnz S_if1
  v_add_f32_dpp v24, v24, v24 row_ror:4 row_mask:0xf bank_mask:0xf
  v_add_f32_dpp v25, v25, v25 row_ror:4 row_mask:0xf bank_mask:0xf
  v_cvt_pk_bf16_f32 v24, v24, v25
  global_store_dword v11, v24, s[70:71] sc1
S_pb:
  v_cmp_class_f32 vcc, v24, s25
  v_mov_b64 v[72:73], 0
  v_mov_b64 v[74:75], 0
  v_mov_b64 v[76:77], 0
  v_mov_b64 v[78:79], 0
  v_mov_b64 v[80:81], 0
  v_mov_b64 v[82:83], 0
  v_mov_b64 v[84:85], 0
  v_mov_b64 v[86:87], 0
  s_cbranch_vccnz S_il
S_ok:
  v_mov_b32 v111, v24
  s_cmp_eq_u32 s21, s83
  s_cbranch_scc1 L_fin
  v_lshlrev_b32 v14, 2, v4
S_go:
  v_mov_b32 v20, -1
  buffer_store_dword v20, v11, s[8:11], s59 offen sc1
  s_nop 7
  s_nop 7
  s_nop 7
  s_nop 7
  s_nop 7
  s_nop 7
  s_nop 7
  s_nop 7
  s_nop 7
  s_nop 7
  s_nop 7
  s_nop 7
  s_nop 7
  s_nop 7
  s_nop 7
  s_nop 7
  s_nop 7
  s_nop 7
  s_nop 7
  s_nop 7
  s_nop 7
  s_nop 7
  s_nop 7
  s_nop 7
  s_nop 7
  s_nop 7
  s_nop 1
S_xs:
  global_load_dwordx4 v[24:27], v4, s[62:63] offset:0 sc1
  global_load_dwordx4 v[28:31], v4, s[62:63] offset:1024 sc1
  s_nop 7
  s_nop 7
  s_nop 7
  s_nop 7
  s_nop 7
  s_nop 7
  s_nop 7
  s_nop 7
  s_nop 7
  s_nop 7
  s_nop 7
  s_nop 7
  s_nop 3
  global_load_dwordx4 v[96:99], v4, s[62:63] offset:0 sc1
  global_load_dwordx4 v[100:103], v4, s[62:63] offset:1024 sc1
  buffer_load_dwordx4 v[64:67], v4, s[8:11], s31 offen offset:2048 sc1
  buffer_load_dwordx4 v[68:71], v4, s[8:11], s31 offen offset:3072 sc1
  s_waitcnt vmcnt(4)
S_x0:
  ds_write_b128 v6, v[24:27]
  v_smfmac_f32_16x16x64_bf16 v[72:75], v[24:27], v[112:119], v1
  ds_write_b128 v6, v[28:31] offset:1024
  v_smfmac_f32_16x16x64_bf16 v[76:79], v[24:27], v[120:127], v1
  v_fma_f32 v109, v25, v26, v27
  v_fma_f32 v110, v29, v30, v31
  v_smfmac_f32_16x16x64_bf16 v[80:83], v[24:27], v[128:135], v1
  v_fma_f32 v109, v24, v28, v109
  v_cmp_u_f32 vcc, v109, v110
  v_smfmac_f32_16x16x64_bf16 v[84:87], v[24:27], v[136:143], v1
  v_smfmac_f32_16x16x64_bf16 v[72:75], v[28:31], a[48:55], v1
  s_cbranch_vccnz S_xf1
  s_waitcnt lgkmcnt(0)
  s_barrier
  ds_read_b128 v[32:35], v7 offset:0
  v_smfmac_f32_16x16x64_bf16 v[76:79], v[28:31], a[56:63], v1
  ds_read_b128 v[36:39], v7 offset:1024
  buffer_store_dword v111, v11, s[8:11], s20 offen sc1
  ds_read_b128 v[40:43], v8 offset:0
  v_smfmac_f32_16x16x64_bf16 v[80:83], v[28:31], a[144:151], v1
  ds_read_b128 v[44:47], v8 offset:1024
  ds_read_b128 v[48:51], v9 offset:0
  v_smfmac_f32_16x16x64_bf16 v[84:87], v[28:31], a[152:159], v1
  ds_read_b128 v[52:55], v9 offset:1024
S_cm:
  s_waitcnt lgkmcnt(5)
  v_smfmac_f32_16x16x64_bf16 v[72:75], v[32:35], a[0:7], v1
  v_smfmac_f32_16x16x64_bf16 v[76:79], v[32:35], a[8:15], v1
  s_waitcnt lgkmcnt(4)
  v_smfmac_f32_16x16x64_bf16 v[72:75], v[36:39], a[64:71], v1
  ds_read_b128 v[112:115], v5 offset:1024
  v_smfmac_f32_16x16x64_bf16 v[76:79], v[36:39], a[72:79], v1
  ds_read_b128 v[116:119], v5 offset:3072
  s_waitcnt lgkmcnt(5)
  v_smfmac_f32_16x16x64_bf16 v[72:75], v[40:43], a[16:23], v1
  s_waitcnt lgkmcnt(4)
  v_smfmac_f32_16x16x64_bf16 v[72:75], v[44:47], a[80:87], v1
  ds_read_b128 v[128:131], v5 offset:4096
  s_waitcnt lgkmcnt(4)
  v_smfmac_f32_16x16x64_bf16 v[72:75], v[48:51], a[32:39], v1
  ds_read_b128 v[132:135], v5 offset:5120
  s_waitcnt lgkmcnt(4)
  v_smfmac_f32_16x16x64_bf16 v[72:75], v[52:55], a[96:103], v1
  buffer_load_dword v0, off, s[8:11], s56 sc1
  v_smfmac_f32_16x16x64_bf16 v[76:79], v[40:43], a[24:31], v1
  ds_read_b128 v[120:123], v5 offset:19488
  v_smfmac_f32_16x16x64_bf16 v[76:79], v[44:47], a[88:95], v1
  ds_read_b128 v[124:127], v5 offset:21536
  v_cvt_pk_bf16_f32 v72, v72, v73
  v_smfmac_f32_16x16x64_bf16 v[76:79], v[48:51], a[40:47], v1
  ds_read_b128 v[136:139], v5 offset:22560
  v_cvt_pk_bf16_f32 v73, v74, v75
  v_smfmac_f32_16x16x64_bf16 v[76:79], v[52:55], a[104:111], v1
  ds_read_b128 v[140:143], v5 offset:23584
  v_mfma_f32_16x16x16_bf16 v[72:75], v[72:73], v[2:3], 0
  s_waitcnt lgkmcnt(6)
  v_smfmac_f32_16x16x64_bf16 v[80:83], v[32:35], v[112:119], v1
  v_cvt_pk_bf16_f32 v76, v76, v77
  v_cvt_pk_bf16_f32 v77, v78, v79
  s_waitcnt lgkmcnt(4)
  v_smfmac_f32_16x16x64_bf16 v[80:83], v[36:39], v[128:135], v1
  ds_read_b128 v[112:115], v5 offset:6144
  v_mfma_f32_16x16x16_bf16 v[76:79], v[76:77], v[2:3], 0
  v_cvt_pk_bf16_f32 v72, v72, v73
  v_cvt_pk_bf16_f32 v73, v74, v75
  s_waitcnt lgkmcnt(3)
  v_smfmac_f32_16x16x64_bf16 v[84:87], v[32:35], v[120:127], v1
  ds_read_b128 v[116:119], v5 offset:7168
  s_waitcnt lgkmcnt(2)
  v_smfmac_f32_16x16x64_bf16 v[84:87], v[36:39], v[136:143], v1
  ds_read_b128 v[128:131], v5 offset:8192
  v_cvt_pk_bf16_f32 v74, v76, v77
  v_cvt_pk_bf16_f32 v75, v78, v79
  v_smfmac_f32_16x16x64_bf16 v[80:83], v[40:43], a[112:119], v1
  ds_read_b128 v[132:135], v5 offset:9216
  v_mov_b64 v[104:105], 0
  v_mfma_f32_16x16x32_bf16 v[56:59], v[56:59], v[72:75], 0
  ds_read_b128 v[120:123], v5 offset:24608
  v_mov_b64 v[106:107], 0
  v_mfma_f32_16x16x32_bf16 v[60:63], v[60:63], v[72:75], 0
  ds_read_b128 v[124:127], v5 offset:25632
  v_mov_b64 v[108:109], 0
  v_smfmac_f32_16x16x64_bf16 v[80:83], v[44:47], a[160:167], v1
  ds_read_b128 v[136:139], v5 offset:26656
  v_mov_b64 v[110:111], 0
  v_smfmac_f32_16x16x64_bf16 v[80:83], v[48:51], a[128:135], v1
  ds_read_b128 v[140:143], v5 offset:27680
  v_cndmask_b32 v56, v60, v56, s[26:27]
  v_smfmac_f32_16x16x64_bf16 v[80:83], v[52:55], a[176:183], v1
  s_waitcnt vmcnt(2)
  ds_read_b128 v[28:31], v6 offset:1024
  v_cndmask_b32 v57, v61, v57, s[26:27]
  v_smfmac_f32_16x16x64_bf16 v[84:87], v[40:43], a[120:127], v1
  ds_read_b128 v[24:27], v6 offset:0
  v_cndmask_b32 v58, v62, v58, s[26:27]
  v_smfmac_f32_16x16x64_bf16 v[84:87], v[44:47], a[168:175], v1
  v_cndmask_b32 v59, v63, v59, s[26:27]
  v_smfmac_f32_16x16x64_bf16 v[84:87], v[48:51], a[136:143], v1
  ds_write_b128 v15, v[56:59]
  v_smfmac_f32_16x16x64_bf16 v[84:87], v[52:55], a[184:191], v1
  s_nop 1
  v_cvt_pk_bf16_f32 v80, v80, v81
  v_cvt_pk_bf16_f32 v81, v82, v83
  s_nop 1
  v_mfma_f32_16x16x16_bf16 v[80:83], v[80:81], v[2:3], 0
  s_nop 0
  v_cvt_pk_bf16_f32 v84, v84, v85
  v_cvt_pk_bf16_f32 v85, v86, v87
  s_nop 1
  v_mfma_f32_16x16x16_bf16 v[84:87], v[84:85], v[2:3], 0
  v_mov_b64 v[96:97], 0
  s_nop 0
  v_cvt_pk_bf16_f32 v80, v80, v81
  v_cvt_pk_bf16_f32 v81, v82, v83
  s_waitcnt lgkmcnt(9)
  v_smfmac_f32_16x16x64_bf16 v[88:91], v[32:35], v[112:119], v1
  s_nop 1
  v_cvt_pk_bf16_f32 v82, v84, v85
  v_cvt_pk_bf16_f32 v83, v86, v87
  s_nop 1
  v_mfma_f32_16x16x32_bf16 v[84:87], v[80:83], v[72:75], 0
  s_waitcnt lgkmcnt(5)
  v_smfmac_f32_16x16x64_bf16 v[92:95], v[32:35], v[120:127], v1
  v_smfmac_f32_16x16x64_bf16 v[88:91], v[36:39], v[128:135], v1
  ds_write_b64 v19, v[84:85]
  s_waitcnt lgkmcnt(4)
  v_smfmac_f32_16x16x64_bf16 v[92:95], v[36:39], v[136:143], v1
  buffer_load_dwordx4 v[60:63], v4, s[8:11], s18 offen offset:1024 sc1
  s_waitcnt lgkmcnt(2)
  v_smfmac_f32_16x16x64_bf16 v[88:91], v[24:27], a[192:199], v1
  ds_read_b128 v[112:115], v5 offset:12288
  v_mov_b64 v[98:99], 0
  s_waitcnt lgkmcnt(1)
  s_barrier
  ds_read2st64_b32 v[20:21], v16 offset0:0 offset1:5
  ds_read2st64_b32 v[22:23], v16 offset0:10 offset1:15
  v_smfmac_f32_16x16x64_bf16 v[92:95], v[24:27], a[200:207], v1
  ds_read2st64_b32 v[80:81], v13 offset0:0 offset1:1
  ds_read2st64_b32 v[82:83], v13 offset0:2 offset1:3
  v_smfmac_f32_16x16x64_bf16 v[88:91], v[28:31], a[240:247], v1
  v_smfmac_f32_16x16x64_bf16 v[92:95], v[28:31], a[248:255], v1
  v_smfmac_f32_16x16x64_bf16 v[88:91], v[40:43], a[208:215], v1
  s_waitcnt lgkmcnt(3)
  v_add_f32 v20, v20, v21
  s_waitcnt lgkmcnt(2)
  v_add_f32 v22, v22, v23
  v_add_f32 v20, v20, v22
  s_waitcnt lgkmcnt(1)
  v_add_f32 v80, v80, v81
  v_mov_b64 v[100:101], 0
  v_max_f32_dpp v76, v20, v20 row_ror:4 row_mask:0xf bank_mask:0xf
  v_max_f32_dpp v21, v20, v20 row_ror:4 row_mask:0xf bank_mask:0xf
  s_waitcnt lgkmcnt(0)
  v_add_f32 v82, v82, v83
  v_add_f32 v80, v80, v82
  v_permlane16_swap_b32 v76, v21
  v_max3_f32 v76, v76, v21, v80
  v_mul_f32 v20, s30, v20
  v_mul_f32 v80, s30, v80
  v_max_f32_dpp v76, v76, v76 row_ror:8 row_mask:0xf bank_mask:0xf
  v_smfmac_f32_16x16x64_bf16 v[92:95], v[40:43], a[216:223], v1
  ds_read_b128 v[116:119], v5 offset:15360
  v_max_f32_dpp v76, v76, v76 row_ror:2 row_mask:0xf bank_mask:0xf
  v_mov_b64 v[102:103], 0
  v_mov_b64 v[72:73], s[28:29]
  v_max_f32_dpp v76, v76, v76 row_ror:1 row_mask:0xf bank_mask:0xf
  v_fma_f32 v20, -v76, s30, v20
  v_fma_f32 v80, -v76, s30, v80
  v_exp_f32 v20, v20
  v_exp_f32 v80, v80
  v_mov_b64 v[74:75], s[28:29]
  v_cvt_pk_bf16_f32 v20, v20, v80
  ds_write_b16 v17, v20
  ds_write_b16_d16_hi v17, v20 offset:16
  v_smfmac_f32_16x16x64_bf16 v[88:91], v[44:47], v[144:151], v1
  buffer_load_dwordx4 v[56:59], v4, s[8:11], s18 offen offset:0 sc1
  v_smfmac_f32_16x16x64_bf16 v[92:95], v[44:47], v[152:159], v1
  ds_read_b128 v[120:123], v5 offset:30752
  v_mov_b64 v[84:85], s[52:53]
  v_smfmac_f32_16x16x64_bf16 v[88:91], v[48:51], a[224:231], v1
  ds_read_b128 v[124:127], v5 offset:33824
  s_waitcnt lgkmcnt(2)
  s_barrier
  ds_read_b128 v[76:79], v18
  v_smfmac_f32_16x16x64_bf16 v[92:95], v[48:51], a[232:239], v1
  ds_read_b64 v[86:87], v18 offset:16
  v_smfmac_f32_16x16x64_bf16 v[88:91], v[52:55], v[160:167], v1
  v_smfmac_f32_16x16x64_bf16 v[92:95], v[52:55], v[168:175], v1
  ds_read_b128 v[128:131], v5 offset:14336
  s_waitcnt lgkmcnt(2)
  v_mfma_f32_16x16x32_bf16 v[72:75], v[72:75], v[76:79], 0
  ds_read_b128 v[132:135], v5 offset:17408
  v_cvt_pk_bf16_f32 v48, v88, v89
  v_mfma_f32_16x16x32_bf16 v[64:67], v[64:67], v[76:79], 0
  ds_read_b128 v[136:139], v5 offset:32800
  v_cvt_pk_bf16_f32 v49, v90, v91
  v_mfma_f32_16x16x32_bf16 v[68:71], v[68:71], v[76:79], 0
  ds_read_b128 v[140:143], v5 offset:35872
  v_cvt_pk_bf16_f32 v50, v92, v93
  s_waitcnt lgkmcnt(4)
  v_mfma_f32_16x16x16_bf16 v[72:75], v[84:85], v[86:87], v[72:75]
  v_cvt_pk_bf16_f32 v51, v94, v95
  ds_read_b128 v[32:35], v5 offset:31776
  v_mfma_f32_16x16x16_bf16 v[64:67], v[48:49], v[86:87], v[64:67]
  ds_read_b128 v[36:39], v5 offset:34848
  v_mfma_f32_16x16x16_bf16 v[68:71], v[50:51], v[86:87], v[68:71]
  v_rcp_f32 v81, v72
  s_nop 2
  v_pk_mul_f32 v[64:65], v[64:65], v[80:81] op_sel:[0,1] op_sel_hi:[1,1]
  v_pk_mul_f32 v[66:67], v[66:67], v[80:81] op_sel:[0,1] op_sel_hi:[1,1]
  v_cvt_pk_bf16_f32 v72, v64, v65
  v_cvt_pk_bf16_f32 v73, v66, v67
  v_pk_mul_f32 v[68:69], v[68:69], v[80:81] op_sel:[0,1] op_sel_hi:[1,1]
  v_pk_mul_f32 v[70:71], v[70:71], v[80:81] op_sel:[0,1] op_sel_hi:[1,1]
  v_cvt_pk_bf16_f32 v74, v68, v69
  v_cvt_pk_bf16_f32 v75, v70, v71
  ds_write_b128 v6, v[72:75]
  s_nop 0
  v_smfmac_f32_16x16x64_bf16 v[96:99], v[72:75], v[176:183], v1
  ds_read_b128 v[24:27], v5 offset:13312
  v_mov_b64 v[88:89], 0
  v_smfmac_f32_16x16x64_bf16 v[100:103], v[72:75], v[184:191], v1
  ds_read_b128 v[28:31], v5 offset:16384
  v_mov_b64 v[90:91], 0
  v_mov_b64 v[92:93], 0
  s_waitcnt lgkmcnt(2)
  s_barrier
  ds_read_b128 v[76:79], v7
  v_smfmac_f32_16x16x64_bf16 v[104:107], v[72:75], v[224:231], v1
  ds_read_b128 v[80:83], v8
  ds_read_b128 v[84:87], v9
  v_smfmac_f32_16x16x64_bf16 v[108:111], v[72:75], v[232:239], v1
  v_mov_b64 v[94:95], 0
  s_waitcnt lgkmcnt(2)
  v_smfmac_f32_16x16x64_bf16 v[96:99], v[76:79], v[192:199], v1
  v_smfmac_f32_16x16x64_bf16 v[100:103], v[76:79], v[200:207], v1
  s_waitcnt lgkmcnt(1)
  v_smfmac_f32_16x16x64_bf16 v[96:99], v[80:83], v[208:215], v1
  s_waitcnt lgkmcnt(0)
  v_smfmac_f32_16x16x64_bf16 v[96:99], v[84:87], v[24:31], v1
  v_smfmac_f32_16x16x64_bf16 v[100:103], v[80:83], v[216:223], v1
  v_smfmac_f32_16x16x64_bf16 v[100:103], v[84:87], v[32:39], v1
  v_cvt_pk_bf16_f32 v96, v96, v97
  v_smfmac_f32_16x16x64_bf16 v[104:107], v[76:79], v[240:247], v1
  v_cvt_pk_bf16_f32 v97, v98, v99
  v_smfmac_f32_16x16x64_bf16 v[104:107], v[80:83], v[112:119], v1
  v_cvt_pk_bf16_f32 v98, v100, v101
  v_smfmac_f32_16x16x64_bf16 v[104:107], v[84:87], v[128:135], v1
  v_cvt_pk_bf16_f32 v99, v102, v103
  v_and_or_b32 v96, v96, -2, s68
  v_smfmac_f32_16x16x64_bf16 v[108:111], v[76:79], v[248:255], v1
  buffer_store_dwordx4 v[96:99], v10, s[8:11], s16 offen sc1
  v_smfmac_f32_16x16x64_bf16 v[108:111], v[80:83], v[120:127], v1
  v_cvt_pk_bf16_f32 v104, v104, v105
  v_smfmac_f32_16x16x64_bf16 v[108:111], v[84:87], v[136:143], v1
  s_nop 1
  v_cvt_pk_bf16_f32 v105, v106, v107
  v_and_or_b32 v104, v104, -2, s68
  s_nop 3
  v_cvt_pk_bf16_f32 v106, v108, v109
  v_cvt_pk_bf16_f32 v107, v110, v111
  buffer_store_dwordx4 v[104:107], v10, s[8:11], s17 offen sc1
  v_mov_b64 v[20:21], 0
  v_mov_b64 v[22:23], 0
  ds_read_b128 v[112:115], v5 offset:10240
  ds_read_b128 v[116:119], v5 offset:11264
  ds_read_b128 v[120:123], v5 offset:28704
  ds_read_b128 v[124:127], v5 offset:29728
  v_mov_b32_dpp v20, v12 quad_perm:[0,1,2,3] row_mask:0xf bank_mask:3
  v_mov_b32_dpp v21, v12 quad_perm:[0,1,2,3] row_mask:0xf bank_mask:12
  v_mov_b32_dpp v22, v12 quad_perm:[1,0,3,2] row_mask:0xf bank_mask:3
  v_mov_b32_dpp v23, v12 quad_perm:[1,0,3,2] row_mask:0xf bank_mask:12
  ds_read_b128 v[128:131], v5 offset:0
  ds_read_b128 v[132:135], v5 offset:2048
  ds_read_b128 v[136:139], v5 offset:18464
  ds_read_b128 v[140:143], v5 offset:20512
  s_mul_i32 s69, s68, 3
  s_xor_b32 s68, s68, 1
  s_add_u32 s18, s18, 524288
  s_add_u32 s19, s19, 524288
  s_min_u32 s19, s19, 33026048
  s_add_u32 s31, s31, 524288
  s_add_u32 s20, s20, s81
  s_mov_b32 s81, 8192
  s_add_u32 s55, s55, 8192
  s_and_b32 s55, s55, 24576
  s_add_u32 s62, s64, s55
  s_addc_u32 s63, s65, 0
  s_add_u32 s70, s72, s55
  s_addc_u32 s71, s73, 0
  s_xor_b32 s59, s55, 0x4000
  s_add_u32 s59, s59, s13
  s_add_u32 s21, s21, 1
  s_cmp_gt_u32 s21, s80
  s_cselect_b32 s57, 0, s57
  s_waitcnt vmcnt(4)
  v_cmp_gt_u32 vcc, s57, v0
  s_cbranch_vccnz S_kv
S_kvr:
  s_add_u32 s56, s56, 4
  s_cmp_eq_u32 s56, s58
  s_addc_u32 s57, s57, 0
  s_cmp_eq_u32 s56, s58
  s_cselect_b32 s49, 24, 0
  s_sub_u32 s56, s56, s49
  s_waitcnt lgkmcnt(0)
  s_nop 7
  s_nop 7
  s_nop 7
  s_nop 7
  s_nop 7
  s_nop 7
  s_nop 7
  s_nop 7
  s_nop 7
  s_nop 7
  s_nop 7
  s_nop 7
  s_nop 7
  s_nop 7
  s_nop 7
  s_nop 7
  s_nop 7
  s_nop 7
  s_nop 7
  s_nop 7
  s_nop 7
  s_nop 7
  s_nop 7
  s_nop 7
  s_nop 7
  s_nop 7
  s_nop 7
  s_nop 7
  s_nop 7
  s_nop 4
  global_load_dwordx4 v[32:35], v4, s[66:67] offset:0 sc1
  global_load_dwordx4 v[36:39], v4, s[66:67] offset:1024 sc1
  s_nop 7
  s_nop 7
  s_nop 7
  s_nop 7
  s_nop 7
  s_nop 7
  s_nop 7
  s_nop 7
  s_nop 7
  s_nop 7
  s_nop 7
  s_nop 7
  s_nop 3
  global_load_dwordx4 v[40:43], v4, s[66:67] offset:0 sc1
  global_load_dwordx4 v[44:47], v4, s[66:67] offset:1024 sc1
  s_branch S_in
S_if1:
  global_load_dwordx4 v[32:35], v4, s[66:67] offset:0 sc1
  global_load_dwordx4 v[36:39], v4, s[66:67] offset:1024 sc1
  s_waitcnt vmcnt(3)
  v_mfma_f32_16x16x32_bf16 v[24:27], v[20:23], v[40:43], 0
  v_lshlrev_b32 v28, 1, v40
  v_and_b32 v28, 2, v28
  s_waitcnt vmcnt(2)
  v_mfma_f32_16x16x32_bf16 v[24:27], v[20:23], v[44:47], v[24:27]
  v_and_or_b32 v28, v44, 1, v28
  v_cmp_ne_u32 vcc, s69, v28
  s_nop 5
  v_add_f32_dpp v24, v24, v24 row_ror:8 row_mask:0xf bank_mask:0xf
  v_add_f32_dpp v25, v25, v25 row_ror:8 row_mask:0xf bank_mask:0xf
  s_cbranch_vccnz S_if2
  v_add_f32_dpp v24, v24, v24 row_ror:4 row_mask:0xf bank_mask:0xf
  v_add_f32_dpp v25, v25, v25 row_ror:4 row_mask:0xf bank_mask:0xf
  v_cvt_pk_bf16_f32 v24, v24, v25
  global_store_dword v11, v24, s[70:71] sc1
  s_branch S_pb
S_if2:
  global_load_dwordx4 v[40:43], v4, s[66:67] offset:0 sc1
  global_load_dwordx4 v[44:47], v4, s[66:67] offset:1024 sc1
  s_add_u32 s24, s24, 1
  s_cmp_gt_u32 s24, 524288
  s_cbranch_scc1 L_end
  s_waitcnt vmcnt(3)
  v_mfma_f32_16x16x32_bf16 v[24:27], v[20:23], v[32:35], 0
  v_lshlrev_b32 v28, 1, v32
  v_and_b32 v28, 2, v28
  s_waitcnt vmcnt(2)
  v_mfma_f32_16x16x32_bf16 v[24:27], v[20:23], v[36:39], v[24:27]
  v_and_or_b32 v28, v36, 1, v28
  v_cmp_ne_u32 vcc, s69, v28
  s_nop 5
  v_add_f32_dpp v24, v24, v24 row_ror:8 row_mask:0xf bank_mask:0xf
  v_add_f32_dpp v25, v25, v25 row_ror:8 row_mask:0xf bank_mask:0xf
  s_cbranch_vccnz S_if1
  v_add_f32_dpp v24, v24, v24 row_ror:4 row_mask:0xf bank_mask:0xf
  v_add_f32_dpp v25, v25, v25 row_ror:4 row_mask:0xf bank_mask:0xf
  v_cvt_pk_bf16_f32 v24, v24, v25
  global_store_dword v11, v24, s[70:71] sc1
  s_branch S_pb
S_il:
  v_mov_b32 v28, 32704
  v_cndmask_b32 v24, v24, v28, vcc
  global_store_dword v11, v24, s[70:71] sc1
  s_branch S_ok
S_xf1:
  global_load_dwordx4 v[24:27], v4, s[62:63] offset:0 sc1
  global_load_dwordx4 v[28:31], v4, s[62:63] offset:1024 sc1
  s_nop 5
  v_mov_b64 v[72:73], 0
  v_mov_b64 v[74:75], 0
  v_mov_b64 v[76:77], 0
  v_mov_b64 v[78:79], 0
  v_mov_b64 v[80:81], 0
  v_mov_b64 v[82:83], 0
  v_mov_b64 v[84:85], 0
  v_mov_b64 v[86:87], 0
  s_waitcnt vmcnt(2)
  ds_write_b128 v6, v[96:99]
  v_smfmac_f32_16x16x64_bf16 v[72:75], v[96:99], v[112:119], v1
  ds_write_b128 v6, v[100:103] offset:1024
  v_smfmac_f32_16x16x64_bf16 v[76:79], v[96:99], v[120:127], v1
  v_fma_f32 v109, v97, v98, v99
  v_fma_f32 v110, v101, v102, v103
  v_smfmac_f32_16x16x64_bf16 v[80:83], v[96:99], v[128:135], v1
  v_fma_f32 v109, v96, v100, v109
  v_cmp_u_f32 vcc, v109, v110
  v_smfmac_f32_16x16x64_bf16 v[84:87], v[96:99], v[136:143], v1
  v_smfmac_f32_16x16x64_bf16 v[72:75], v[100:103], a[48:55], v1
  s_cbranch_vccnz S_xf0
  s_waitcnt lgkmcnt(0)
  s_barrier
  ds_read_b128 v[32:35], v7 offset:0
  v_smfmac_f32_16x16x64_bf16 v[76:79], v[100:103], a[56:63], v1
  ds_read_b128 v[36:39], v7 offset:1024
  buffer_store_dword v111, v11, s[8:11], s20 offen sc1
  ds_read_b128 v[40:43], v8 offset:0
  v_smfmac_f32_16x16x64_bf16 v[80:83], v[100:103], a[144:151], v1
  ds_read_b128 v[44:47], v8 offset:1024
  ds_read_b128 v[48:51], v9 offset:0
  v_smfmac_f32_16x16x64_bf16 v[84:87], v[100:103], a[152:159], v1
  ds_read_b128 v[52:55], v9 offset:1024
  s_branch S_cm
S_xf0:
  global_load_dwordx4 v[96:99], v4, s[62:63] offset:0 sc1
  global_load_dwordx4 v[100:103], v4, s[62:63] offset:1024 sc1
  s_add_u32 s24, s24, 1
  s_cmp_gt_u32 s24, 524288
  s_cbranch_scc1 L_end
  s_nop 2
  v_mov_b64 v[72:73], 0
  v_mov_b64 v[74:75], 0
  v_mov_b64 v[76:77], 0
  v_mov_b64 v[78:79], 0
  v_mov_b64 v[80:81], 0
  v_mov_b64 v[82:83], 0
  v_mov_b64 v[84:85], 0
  v_mov_b64 v[86:87], 0
  s_waitcnt vmcnt(2)
  s_branch S_x0
S_kv:
  s_add_u32 s24, s24, 1
  s_cmp_gt_u32 s24, 524288
  s_cbranch_scc1 L_end
  buffer_load_dword v0, off, s[8:11], s56 sc1
  s_waitcnt vmcnt(0)
  v_cmp_gt_u32 vcc, s57, v0
  s_cbranch_vccnz S_kv
  s_branch S_kvr
E_in:
  s_waitcnt vmcnt(3)
  v_mfma_f32_16x16x32_bf16 v[24:27], v[20:23], v[32:35], 0
  v_lshlrev_b32 v28, 1, v32
  v_and_b32 v28, 2, v28
  s_waitcnt vmcnt(2)
  v_mfma_f32_16x16x32_bf16 v[24:27], v[20:23], v[36:39], v[24:27]
  v_and_or_b32 v28, v36, 1, v28
  v_cmp_ne_u32 vcc, s69, v28
  s_nop 5
  v_add_f32_dpp v24, v24, v24 row_ror:8 row_mask:0xf bank_mask:0xf
  v_add_f32_dpp v25, v25, v25 row_ror:8 row_mask:0xf bank_mask:0xf
  s_cbranch_vccnz E_if1
  v_add_f32_dpp v24, v24, v24 row_ror:4 row_mask:0xf bank_mask:0xf
  v_add_f32_dpp v25, v25, v25 row_ror:4 row_mask:0xf bank_mask:0xf
  v_cvt_pk_bf16_f32 v24, v24, v25
  global_store_dword v11, v24, s[70:71] sc1
E_pb:
  v_cmp_class_f32 vcc, v24, s25
  v_mov_b64 v[72:73], 0
  v_mov_b64 v[74:75], 0
  v_mov_b64 v[76:77], 0
  v_mov_b64 v[78:79], 0
  v_mov_b64 v[80:81], 0
  v_mov_b64 v[82:83], 0
  v_mov_b64 v[84:85], 0
  v_mov_b64 v[86:87], 0
  s_cbranch_vccnz E_il
E_ok:
  v_mov_b32 v111, v24
  s_cmp_eq_u32 s21, s83
  s_cbranch_scc1 E_fin
  s_add_u32 s66, s66, 262144
  s_addc_u32 s67, s67, 0
  v_lshlrev_b32 v14, 2, v4
E_go:
  v_mov_b32 v20, -1
  s_nop 7
  s_nop 7
  s_nop 7
  s_nop 7
  s_nop 7
  s_nop 7
  s_nop 7
  s_nop 7
  s_nop 7
  s_nop 7
  s_nop 7
  s_nop 7
  s_nop 7
  s_nop 7
  s_nop 7
  s_nop 7
  s_nop 7
  s_nop 7
  s_nop 5
E_xs:
  global_load_dwordx4 v[24:27], v4, s[62:63] offset:0 sc1
  global_load_dwordx4 v[28:31], v4, s[62:63] offset:1024 sc1
  s_nop 7
  s_nop 7
  s_nop 7
  s_nop 7
  s_nop 7
  s_nop 7
  s_nop 7
  s_nop 7
  s_nop 7
  s_nop 7
  s_nop 7
  s_nop 7
  s_nop 7
  s_nop 7
  s_nop 7
  s_nop 7
  s_nop 7
  s_nop 7
  s_nop 7
  s_nop 7
  s_nop 7
  s_nop 7
  s_nop 7
  s_nop 7
  s_nop 7
  global_load_dwordx4 v[96:99], v4, s[62:63] offset:0 sc1
  global_load_dwordx4 v[100:103], v4, s[62:63] offset:1024 sc1
  buffer_load_dwordx4 v[64:67], v4, s[8:11], s31 offen offset:2048 sc1
  buffer_load_dwordx4 v[68:71], v4, s[8:11], s31 offen offset:3072 sc1
  s_waitcnt vmcnt(4)
E_x0:
  ds_write_b128 v6, v[24:27]
  v_smfmac_f32_16x16x64_bf16 v[72:75], v[24:27], v[112:119], v1
  ds_write_b128 v6, v[28:31] offset:1024
  v_smfmac_f32_16x16x64_bf16 v[76:79], v[24:27], v[120:127], v1
  v_fma_f32 v109, v25, v26, v27
  v_fma_f32 v110, v29, v30, v31
  v_smfmac_f32_16x16x64_bf16 v[80:83], v[24:27], v[128:135], v1
  v_fma_f32 v109, v24, v28, v109
  v_cmp_u_f32 vcc, v109, v110
  v_smfmac_f32_16x16x64_bf16 v[84:87], v[24:27], v[136:143], v1
  v_smfmac_f32_16x16x64_bf16 v[72:75], v[28:31], a[48:55], v1
  s_cbranch_vccnz E_xf1
  s_waitcnt lgkmcnt(0)
  s_barrier
  ds_read_b128 v[32:35], v7 offset:0
  v_smfmac_f32_16x16x64_bf16 v[76:79], v[28:31], a[56:63], v1
  ds_read_b128 v[36:39], v7 offset:1024
  ds_read_b128 v[40:43], v8 offset:0
  v_smfmac_f32_16x16x64_bf16 v[80:83], v[28:31], a[144:151], v1
  ds_read_b128 v[44:47], v8 offset:1024
  ds_read_b128 v[48:51], v9 offset:0
  v_smfmac_f32_16x16x64_bf16 v[84:87], v[28:31], a[152:159], v1
  ds_read_b128 v[52:55], v9 offset:1024
E_cm:
  s_waitcnt lgkmcnt(5)
  v_smfmac_f32_16x16x64_bf16 v[72:75], v[32:35], a[0:7], v1
  v_smfmac_f32_16x16x64_bf16 v[76:79], v[32:35], a[8:15], v1
  s_waitcnt lgkmcnt(4)
  v_smfmac_f32_16x16x64_bf16 v[72:75], v[36:39], a[64:71], v1
  ds_read_b128 v[112:115], v5 offset:1024
  v_smfmac_f32_16x16x64_bf16 v[76:79], v[36:39], a[72:79], v1
  ds_read_b128 v[116:119], v5 offset:3072
  s_waitcnt lgkmcnt(5)
  v_smfmac_f32_16x16x64_bf16 v[72:75], v[40:43], a[16:23], v1
  s_waitcnt lgkmcnt(4)
  v_smfmac_f32_16x16x64_bf16 v[72:75], v[44:47], a[80:87], v1
  ds_read_b128 v[128:131], v5 offset:4096
  s_waitcnt lgkmcnt(4)
  v_smfmac_f32_16x16x64_bf16 v[72:75], v[48:51], a[32:39], v1
  ds_read_b128 v[132:135], v5 offset:5120
  s_waitcnt lgkmcnt(4)
  v_smfmac_f32_16x16x64_bf16 v[72:75], v[52:55], a[96:103], v1
  buffer_load_dword v0, off, s[8:11], s56 sc1
  v_smfmac_f32_16x16x64_bf16 v[76:79], v[40:43], a[24:31], v1
  ds_read_b128 v[120:123], v5 offset:19488
  v_smfmac_f32_16x16x64_bf16 v[76:79], v[44:47], a[88:95], v1
  ds_read_b128 v[124:127], v5 offset:21536
  v_cvt_pk_bf16_f32 v72, v72, v73
  v_smfmac_f32_16x16x64_bf16 v[76:79], v[48:51], a[40:47], v1
  ds_read_b128 v[136:139], v5 offset:22560
  v_cvt_pk_bf16_f32 v73, v74, v75
  v_smfmac_f32_16x16x64_bf16 v[76:79], v[52:55], a[104:111], v1
  ds_read_b128 v[140:143], v5 offset:23584
  v_mfma_f32_16x16x16_bf16 v[72:75], v[72:73], v[2:3], 0
  s_waitcnt lgkmcnt(6)
  v_smfmac_f32_16x16x64_bf16 v[80:83], v[32:35], v[112:119], v1
  v_cvt_pk_bf16_f32 v76, v76, v77
  v_cvt_pk_bf16_f32 v77, v78, v79
  s_waitcnt lgkmcnt(4)
  v_smfmac_f32_16x16x64_bf16 v[80:83], v[36:39], v[128:135], v1
  ds_read_b128 v[112:115], v5 offset:6144
  v_mfma_f32_16x16x16_bf16 v[76:79], v[76:77], v[2:3], 0
  v_cvt_pk_bf16_f32 v72, v72, v73
  v_cvt_pk_bf16_f32 v73, v74, v75
  s_waitcnt lgkmcnt(3)
  v_smfmac_f32_16x16x64_bf16 v[84:87], v[32:35], v[120:127], v1
  ds_read_b128 v[116:119], v5 offset:7168
  s_waitcnt lgkmcnt(2)
  v_smfmac_f32_16x16x64_bf16 v[84:87], v[36:39], v[136:143], v1
  ds_read_b128 v[128:131], v5 offset:8192
  v_cvt_pk_bf16_f32 v74, v76, v77
  v_cvt_pk_bf16_f32 v75, v78, v79
  v_smfmac_f32_16x16x64_bf16 v[80:83], v[40:43], a[112:119], v1
  ds_read_b128 v[132:135], v5 offset:9216
  v_mov_b64 v[104:105], 0
  v_mfma_f32_16x16x32_bf16 v[56:59], v[56:59], v[72:75], 0
  ds_read_b128 v[120:123], v5 offset:24608
  v_mov_b64 v[106:107], 0
  v_mfma_f32_16x16x32_bf16 v[60:63], v[60:63], v[72:75], 0
  ds_read_b128 v[124:127], v5 offset:25632
  v_mov_b64 v[108:109], 0
  v_smfmac_f32_16x16x64_bf16 v[80:83], v[44:47], a[160:167], v1
  ds_read_b128 v[136:139], v5 offset:26656
  v_mov_b64 v[110:111], 0
  v_smfmac_f32_16x16x64_bf16 v[80:83], v[48:51], a[128:135], v1
  ds_read_b128 v[140:143], v5 offset:27680
  v_cndmask_b32 v56, v60, v56, s[26:27]
  v_smfmac_f32_16x16x64_bf16 v[80:83], v[52:55], a[176:183], v1
  s_waitcnt vmcnt(1)
  ds_read_b128 v[28:31], v6 offset:1024
  v_cndmask_b32 v57, v61, v57, s[26:27]
  v_smfmac_f32_16x16x64_bf16 v[84:87], v[40:43], a[120:127], v1
  ds_read_b128 v[24:27], v6 offset:0
  v_cndmask_b32 v58, v62, v58, s[26:27]
  v_smfmac_f32_16x16x64_bf16 v[84:87], v[44:47], a[168:175], v1
  v_cndmask_b32 v59, v63, v59, s[26:27]
  v_smfmac_f32_16x16x64_bf16 v[84:87], v[48:51], a[136:143], v1
  ds_write_b128 v15, v[56:59]
  v_smfmac_f32_16x16x64_bf16 v[84:87], v[52:55], a[184:191], v1
  s_nop 1
  v_cvt_pk_bf16_f32 v80, v80, v81
  v_cvt_pk_bf16_f32 v81, v82, v83
  s_nop 1
  v_mfma_f32_16x16x16_bf16 v[80:83], v[80:81], v[2:3], 0
  s_nop 0
  v_cvt_pk_bf16_f32 v84, v84, v85
  v_cvt_pk_bf16_f32 v85, v86, v87
  s_nop 1
  v_mfma_f32_16x16x16_bf16 v[84:87], v[84:85], v[2:3], 0
  v_mov_b64 v[96:97], 0
  s_nop 0
  v_cvt_pk_bf16_f32 v80, v80, v81
  v_cvt_pk_bf16_f32 v81, v82, v83
  s_waitcnt lgkmcnt(9)
  v_smfmac_f32_16x16x64_bf16 v[88:91], v[32:35], v[112:119], v1
  s_nop 1
  v_cvt_pk_bf16_f32 v82, v84, v85
  v_cvt_pk_bf16_f32 v83, v86, v87
  s_nop 1
  v_mfma_f32_16x16x32_bf16 v[84:87], v[80:83], v[72:75], 0
  s_waitcnt lgkmcnt(5)
  v_smfmac_f32_16x16x64_bf16 v[92:95], v[32:35], v[120:127], v1
  v_smfmac_f32_16x16x64_bf16 v[88:91], v[36:39], v[128:135], v1
  ds_write_b64 v19, v[84:85]
  s_waitcnt lgkmcnt(4)
  v_smfmac_f32_16x16x64_bf16 v[92:95], v[36:39], v[136:143], v1
  buffer_load_dwordx4 v[60:63], v4, s[8:11], s18 offen offset:1024 sc1
  s_waitcnt lgkmcnt(2)
  v_smfmac_f32_16x16x64_bf16 v[88:91], v[24:27], a[192:199], v1
  ds_read_b128 v[112:115], v5 offset:12288
  v_mov_b64 v[98:99], 0
  s_waitcnt lgkmcnt(1)
  s_barrier
  ds_read2st64_b32 v[20:21], v16 offset0:0 offset1:5
  ds_read2st64_b32 v[22:23], v16 offset0:10 offset1:15
  v_smfmac_f32_16x16x64_bf16 v[92:95], v[24:27], a[200:207], v1
  ds_read2st64_b32 v[80:81], v13 offset0:0 offset1:1
  ds_read2st64_b32 v[82:83], v13 offset0:2 offset1:3
  v_smfmac_f32_16x16x64_bf16 v[88:91], v[28:31], a[240:247], v1
  v_smfmac_f32_16x16x64_bf16 v[92:95], v[28:31], a[248:255], v1
  v_smfmac_f32_16x16x64_bf16 v[88:91], v[40:43], a[208:215], v1
  s_waitcnt lgkmcnt(3)
  v_add_f32 v20, v20, v21
  s_waitcnt lgkmcnt(2)
  v_add_f32 v22, v22, v23
  v_add_f32 v20, v20, v22
  s_waitcnt lgkmcnt(1)
  v_add_f32 v80, v80, v81
  v_mov_b64 v[100:101], 0
  v_max_f32_dpp v76, v20, v20 row_ror:4 row_mask:0xf bank_mask:0xf
  v_max_f32_dpp v21, v20, v20 row_ror:4 row_mask:0xf bank_mask:0xf
  s_waitcnt lgkmcnt(0)
  v_add_f32 v82, v82, v83
  v_add_f32 v80, v80, v82
  v_permlane16_swap_b32 v76, v21
  v_max3_f32 v76, v76, v21, v80
  v_mul_f32 v20, s30, v20
  v_mul_f32 v80, s30, v80
  v_max_f32_dpp v76, v76, v76 row_ror:8 row_mask:0xf bank_mask:0xf
  v_smfmac_f32_16x16x64_bf16 v[92:95], v[40:43], a[216:223], v1
  ds_read_b128 v[116:119], v5 offset:15360
  v_max_f32_dpp v76, v76, v76 row_ror:2 row_mask:0xf bank_mask:0xf
  v_mov_b64 v[102:103], 0
  v_mov_b64 v[72:73], s[28:29]
  v_max_f32_dpp v76, v76, v76 row_ror:1 row_mask:0xf bank_mask:0xf
  v_fma_f32 v20, -v76, s30, v20
  v_fma_f32 v80, -v76, s30, v80
  v_exp_f32 v20, v20
  v_exp_f32 v80, v80
  v_mov_b64 v[74:75], s[28:29]
  v_cvt_pk_bf16_f32 v20, v20, v80
  ds_write_b16 v17, v20
  ds_write_b16_d16_hi v17, v20 offset:16
  v_smfmac_f32_16x16x64_bf16 v[88:91], v[44:47], v[144:151], v1
  buffer_load_dwordx4 v[56:59], v4, s[8:11], s18 offen offset:0 sc1
  v_smfmac_f32_16x16x64_bf16 v[92:95], v[44:47], v[152:159], v1
  ds_read_b128 v[120:123], v5 offset:30752
  v_mov_b64 v[84:85], s[52:53]
  v_smfmac_f32_16x16x64_bf16 v[88:91], v[48:51], a[224:231], v1
  ds_read_b128 v[124:127], v5 offset:33824
  s_waitcnt lgkmcnt(2)
  s_barrier
  ds_read_b128 v[76:79], v18
  v_smfmac_f32_16x16x64_bf16 v[92:95], v[48:51], a[232:239], v1
  ds_read_b64 v[86:87], v18 offset:16
  v_smfmac_f32_16x16x64_bf16 v[88:91], v[52:55], v[160:167], v1
  v_smfmac_f32_16x16x64_bf16 v[92:95], v[52:55], v[168:175], v1
  ds_read_b128 v[128:131], v5 offset:14336
  s_waitcnt lgkmcnt(2)
  v_mfma_f32_16x16x32_bf16 v[72:75], v[72:75], v[76:79], 0
  ds_read_b128 v[132:135], v5 offset:17408
  v_cvt_pk_bf16_f32 v48, v88, v89
  v_mfma_f32_16x16x32_bf16 v[64:67], v[64:67], v[76:79], 0
  ds_read_b128 v[136:139], v5 offset:32800
  v_cvt_pk_bf16_f32 v49, v90, v91
  v_mfma_f32_16x16x32_bf16 v[68:71], v[68:71], v[76:79], 0
  ds_read_b128 v[140:143], v5 offset:35872
  v_cvt_pk_bf16_f32 v50, v92, v93
  s_waitcnt lgkmcnt(4)
  v_mfma_f32_16x16x16_bf16 v[72:75], v[84:85], v[86:87], v[72:75]
  v_cvt_pk_bf16_f32 v51, v94, v95
  ds_read_b128 v[32:35], v5 offset:31776
  v_mfma_f32_16x16x16_bf16 v[64:67], v[48:49], v[86:87], v[64:67]
  ds_read_b128 v[36:39], v5 offset:34848
  v_mfma_f32_16x16x16_bf16 v[68:71], v[50:51], v[86:87], v[68:71]
  v_rcp_f32 v81, v72
  s_nop 2
  v_pk_mul_f32 v[64:65], v[64:65], v[80:81] op_sel:[0,1] op_sel_hi:[1,1]
  v_pk_mul_f32 v[66:67], v[66:67], v[80:81] op_sel:[0,1] op_sel_hi:[1,1]
  v_cvt_pk_bf16_f32 v72, v64, v65
  v_cvt_pk_bf16_f32 v73, v66, v67
  v_pk_mul_f32 v[68:69], v[68:69], v[80:81] op_sel:[0,1] op_sel_hi:[1,1]
  v_pk_mul_f32 v[70:71], v[70:71], v[80:81] op_sel:[0,1] op_sel_hi:[1,1]
  v_cvt_pk_bf16_f32 v74, v68, v69
  v_cvt_pk_bf16_f32 v75, v70, v71
  ds_write_b128 v6, v[72:75]
  s_nop 0
  v_smfmac_f32_16x16x64_bf16 v[96:99], v[72:75], v[176:183], v1
  ds_read_b128 v[24:27], v5 offset:13312
  v_mov_b64 v[88:89], 0
  v_smfmac_f32_16x16x64_bf16 v[100:103], v[72:75], v[184:191], v1
  ds_read_b128 v[28:31], v5 offset:16384
  v_mov_b64 v[90:91], 0
  v_mov_b64 v[92:93], 0
  s_waitcnt lgkmcnt(2)
  s_barrier
  ds_read_b128 v[76:79], v7
  v_smfmac_f32_16x16x64_bf16 v[104:107], v[72:75], v[224:231], v1
  ds_read_b128 v[80:83], v8
  ds_read_b128 v[84:87], v9
  v_smfmac_f32_16x16x64_bf16 v[108:111], v[72:75], v[232:239], v1
  v_mov_b64 v[94:95], 0
  s_waitcnt lgkmcnt(2)
  v_smfmac_f32_16x16x64_bf16 v[96:99], v[76:79], v[192:199], v1
  v_smfmac_f32_16x16x64_bf16 v[100:103], v[76:79], v[200:207], v1
  s_waitcnt lgkmcnt(1)
  v_smfmac_f32_16x16x64_bf16 v[96:99], v[80:83], v[208:215], v1
  s_waitcnt lgkmcnt(0)
  v_smfmac_f32_16x16x64_bf16 v[96:99], v[84:87], v[24:31], v1
  v_smfmac_f32_16x16x64_bf16 v[100:103], v[80:83], v[216:223], v1
  v_smfmac_f32_16x16x64_bf16 v[100:103], v[84:87], v[32:39], v1
  v_cvt_pk_bf16_f32 v96, v96, v97
  v_smfmac_f32_16x16x64_bf16 v[104:107], v[76:79], v[240:247], v1
  v_cvt_pk_bf16_f32 v97, v98, v99
  v_smfmac_f32_16x16x64_bf16 v[104:107], v[80:83], v[112:119], v1
  v_cvt_pk_bf16_f32 v98, v100, v101
  v_smfmac_f32_16x16x64_bf16 v[104:107], v[84:87], v[128:135], v1
  v_cvt_pk_bf16_f32 v99, v102, v103
  v_and_or_b32 v96, v96, -2, s68
  v_smfmac_f32_16x16x64_bf16 v[108:111], v[76:79], v[248:255], v1
  buffer_store_dwordx4 v[96:99], v10, s[8:11], s16 offen sc1
  v_smfmac_f32_16x16x64_bf16 v[108:111], v[80:83], v[120:127], v1
  v_cvt_pk_bf16_f32 v104, v104, v105
  v_smfmac_f32_16x16x64_bf16 v[108:111], v[84:87], v[136:143], v1
  s_nop 1
  v_cvt_pk_bf16_f32 v105, v106, v107
  v_and_or_b32 v104, v104, -2, s68
  s_nop 3
  v_cvt_pk_bf16_f32 v106, v108, v109
  v_cvt_pk_bf16_f32 v107, v110, v111
  buffer_store_dwordx4 v[104:107], v10, s[8:11], s17 offen sc1
  v_mov_b64 v[20:21], 0
  v_mov_b64 v[22:23], 0
  ds_read_b128 v[112:115], v5 offset:10240
  ds_read_b128 v[116:119], v5 offset:11264
  ds_read_b128 v[120:123], v5 offset:28704
  ds_read_b128 v[124:127], v5 offset:29728
  v_mov_b32_dpp v20, v12 quad_perm:[0,1,2,3] row_mask:0xf bank_mask:3
  v_mov_b32_dpp v21, v12 quad_perm:[0,1,2,3] row_mask:0xf bank_mask:12
  v_mov_b32_dpp v22, v12 quad_perm:[1,0,3,2] row_mask:0xf bank_mask:3
  v_mov_b32_dpp v23, v12 quad_perm:[1,0,3,2] row_mask:0xf bank_mask:12
  ds_read_b128 v[128:131], v5 offset:0
  ds_read_b128 v[132:135], v5 offset:2048
  ds_read_b128 v[136:139], v5 offset:18464
  ds_read_b128 v[140:143], v5 offset:20512
  s_mul_i32 s69, s68, 3
  s_add_u32 s16, s16, 262144
  s_add_u32 s17, s17, 262144
  s_add_u32 s18, s18, 524288
  s_add_u32 s19, s19, 524288
  s_min_u32 s19, s19, 33026048
  s_add_u32 s31, s31, 524288
  s_add_u32 s20, s20, s81
  s_mov_b32 s81, 8192
  s_add_u32 s55, s55, 8192
  s_and_b32 s55, s55, -1
  s_add_u32 s62, s64, s55
  s_addc_u32 s63, s65, 0
  s_add_u32 s70, s72, s55
  s_addc_u32 s71, s73, 0
  s_xor_b32 s59, s55, 0x4000
  s_add_u32 s59, s59, s13
  s_add_u32 s21, s21, 1
  s_cmp_gt_u32 s21, s80
  s_cselect_b32 s57, 0, s57
  s_waitcnt vmcnt(4)
  v_cmp_gt_u32 vcc, s57, v0
  s_cbranch_vccnz E_kv
E_kvr:
  s_add_u32 s56, s56, 4
  s_cmp_eq_u32 s56, s58
  s_addc_u32 s57, s57, 0
  s_cmp_eq_u32 s56, s58
  s_cselect_b32 s49, 24, 0
  s_sub_u32 s56, s56, s49
  s_waitcnt lgkmcnt(0)
  s_nop 7
  s_nop 7
  s_nop 7
  s_nop 7
  s_nop 7
  s_nop 7
  s_nop 7
  s_nop 7
  s_nop 7
  s_nop 7
  s_nop 7
  s_nop 7
  s_nop 7
  s_nop 7
  s_nop 3
  global_load_dwordx4 v[32:35], v4, s[66:67] offset:0 sc1
  global_load_dwordx4 v[36:39], v4, s[66:67] offset:1024 sc1
  s_nop 7
  s_nop 7
  s_nop 7
  s_nop 7
  s_nop 7
  s_nop 7
  s_nop 7
  s_nop 7
  s_nop 7
  s_nop 7
  s_nop 7
  s_nop 7
  s_nop 7
  s_nop 7
  s_nop 7
  s_nop 7
  s_nop 7
  s_nop 7
  s_nop 7
  s_nop 7
  s_nop 7
  s_nop 7
  s_nop 7
  s_nop 7
  s_nop 7
  global_load_dwordx4 v[40:43], v4, s[66:67] offset:0 sc1
  global_load_dwordx4 v[44:47], v4, s[66:67] offset:1024 sc1
  s_branch E_in
E_if1:
  global_load_dwordx4 v[32:35], v4, s[66:67] offset:0 sc1
  global_load_dwordx4 v[36:39], v4, s[66:67] offset:1024 sc1
  s_waitcnt vmcnt(3)
  v_mfma_f32_16x16x32_bf16 v[24:27], v[20:23], v[40:43], 0
  v_lshlrev_b32 v28, 1, v40
  v_and_b32 v28, 2, v28
  s_waitcnt vmcnt(2)
  v_mfma_f32_16x16x32_bf16 v[24:27], v[20:23], v[44:47], v[24:27]
  v_and_or_b32 v28, v44, 1, v28
  v_cmp_ne_u32 vcc, s69, v28
  s_nop 5
  v_add_f32_dpp v24, v24, v24 row_ror:8 row_mask:0xf bank_mask:0xf
  v_add_f32_dpp v25, v25, v25 row_ror:8 row_mask:0xf bank_mask:0xf
  s_cbranch_vccnz E_if2
  v_add_f32_dpp v24, v24, v24 row_ror:4 row_mask:0xf bank_mask:0xf
  v_add_f32_dpp v25, v25, v25 row_ror:4 row_mask:0xf bank_mask:0xf
  v_cvt_pk_bf16_f32 v24, v24, v25
  global_store_dword v11, v24, s[70:71] sc1
  s_branch E_pb
E_if2:
  global_load_dwordx4 v[40:43], v4, s[66:67] offset:0 sc1
  global_load_dwordx4 v[44:47], v4, s[66:67] offset:1024 sc1
  s_add_u32 s24, s24, 1
  s_cmp_gt_u32 s24, 524288
  s_cbranch_scc1 L_end
  s_waitcnt vmcnt(3)
  v_mfma_f32_16x16x32_bf16 v[24:27], v[20:23], v[32:35], 0
  v_lshlrev_b32 v28, 1, v32
  v_and_b32 v28, 2, v28
  s_waitcnt vmcnt(2)
  v_mfma_f32_16x16x32_bf16 v[24:27], v[20:23], v[36:39], v[24:27]
  v_and_or_b32 v28, v36, 1, v28
  v_cmp_ne_u32 vcc, s69, v28
  s_nop 5
  v_add_f32_dpp v24, v24, v24 row_ror:8 row_mask:0xf bank_mask:0xf
  v_add_f32_dpp v25, v25, v25 row_ror:8 row_mask:0xf bank_mask:0xf
  s_cbranch_vccnz E_if1
  v_add_f32_dpp v24, v24, v24 row_ror:4 row_mask:0xf bank_mask:0xf
  v_add_f32_dpp v25, v25, v25 row_ror:4 row_mask:0xf bank_mask:0xf
  v_cvt_pk_bf16_f32 v24, v24, v25
  global_store_dword v11, v24, s[70:71] sc1
  s_branch E_pb
E_il:
  v_mov_b32 v28, 32704
  v_cndmask_b32 v24, v24, v28, vcc
  global_store_dword v11, v24, s[70:71] sc1
  s_branch E_ok
E_xf1:
  global_load_dwordx4 v[24:27], v4, s[62:63] offset:0 sc1
  global_load_dwordx4 v[28:31], v4, s[62:63] offset:1024 sc1
  s_nop 5
  v_mov_b64 v[72:73], 0
  v_mov_b64 v[74:75], 0
  v_mov_b64 v[76:77], 0
  v_mov_b64 v[78:79], 0
  v_mov_b64 v[80:81], 0
  v_mov_b64 v[82:83], 0
  v_mov_b64 v[84:85], 0
  v_mov_b64 v[86:87], 0
  s_waitcnt vmcnt(2)
  ds_write_b128 v6, v[96:99]
  v_smfmac_f32_16x16x64_bf16 v[72:75], v[96:99], v[112:119], v1
  ds_write_b128 v6, v[100:103] offset:1024
  v_smfmac_f32_16x16x64_bf16 v[76:79], v[96:99], v[120:127], v1
  v_fma_f32 v109, v97, v98, v99
  v_fma_f32 v110, v101, v102, v103
  v_smfmac_f32_16x16x64_bf16 v[80:83], v[96:99], v[128:135], v1
  v_fma_f32 v109, v96, v100, v109
  v_cmp_u_f32 vcc, v109, v110
  v_smfmac_f32_16x16x64_bf16 v[84:87], v[96:99], v[136:143], v1
  v_smfmac_f32_16x16x64_bf16 v[72:75], v[100:103], a[48:55], v1
  s_cbranch_vccnz E_xf0
  s_waitcnt lgkmcnt(0)
  s_barrier
  ds_read_b128 v[32:35], v7 offset:0
  v_smfmac_f32_16x16x64_bf16 v[76:79], v[100:103], a[56:63], v1
  ds_read_b128 v[36:39], v7 offset:1024
  ds_read_b128 v[40:43], v8 offset:0
  v_smfmac_f32_16x16x64_bf16 v[80:83], v[100:103], a[144:151], v1
  ds_read_b128 v[44:47], v8 offset:1024
  ds_read_b128 v[48:51], v9 offset:0
  v_smfmac_f32_16x16x64_bf16 v[84:87], v[100:103], a[152:159], v1
  ds_read_b128 v[52:55], v9 offset:1024
  s_branch E_cm
E_xf0:
  global_load_dwordx4 v[96:99], v4, s[62:63] offset:0 sc1
  global_load_dwordx4 v[100:103], v4, s[62:63] offset:1024 sc1
  s_add_u32 s24, s24, 1
  s_cmp_gt_u32 s24, 524288
  s_cbranch_scc1 L_end
  s_nop 2
  v_mov_b64 v[72:73], 0
  v_mov_b64 v[74:75], 0
  v_mov_b64 v[76:77], 0
  v_mov_b64 v[78:79], 0
  v_mov_b64 v[80:81], 0
  v_mov_b64 v[82:83], 0
  v_mov_b64 v[84:85], 0
  v_mov_b64 v[86:87], 0
  s_waitcnt vmcnt(2)
  s_branch E_x0
E_kv:
  s_add_u32 s24, s24, 1
  s_cmp_gt_u32 s24, 524288
  s_cbranch_scc1 L_end
  buffer_load_dword v0, off, s[8:11], s56 sc1
  s_waitcnt vmcnt(0)
  v_cmp_gt_u32 vcc, s57, v0
  s_cbranch_vccnz E_kv
  s_branch E_kvr
E_fin:
  s_waitcnt vmcnt(0) lgkmcnt(0)
  s_barrier
  v_mbcnt_lo_u32_b32 v0, -1, 0
  v_mbcnt_hi_u32_b32 v0, -1, v0
  s_lshl_b32 s49, s23, 6
  v_add_u32 v0, s49, v0
  s_mov_b32 s3, 1
  s_branch L_par
L_fin:
  buffer_store_dword v111, v11, s[8:11], s20 offen sc1
L_end:
  s_endpgm
.section .rodata,"a"
.p2align 6
.amdhsa_kernel gated_mix__memory_aug_recurrent_mem_tr__glu_gated_bilinear__prompt_kernel
  .amdhsa_next_free_vgpr 512
  .amdhsa_next_free_sgpr 102
  .amdhsa_accum_offset 256
  .amdhsa_group_segment_fixed_size 0
  .amdhsa_kernarg_size 120
  .amdhsa_user_sgpr_count 2
  .amdhsa_user_sgpr_kernarg_segment_ptr 1
  .amdhsa_system_sgpr_workgroup_id_x 1
.end_amdhsa_kernel
.text
```
